```python
import torch

def _softmax(x, axis=-1):
    return torch.softmax(x, dim=axis)
def _gelu(x):
    return torch.nn.functional.gelu(x, approximate="tanh")
def _silu(x):
    return torch.nn.functional.silu(x)
def _sigmoid(x):
    return torch.sigmoid(x)
def _layernorm(x, axis=-1, eps=1e-5):
    m = x.mean(dim=axis, keepdim=True)
    v = x.var(dim=axis, keepdim=True, unbiased=False)
    return (x - m) / torch.sqrt(v + eps)
def _scatter_add(tgt, idx, src, axis=0):
    return tgt.clone().index_add_(axis, idx, src)
def _segment_sum(src, seg, n):
    out = torch.zeros((n,) + src.shape[1:], dtype=src.dtype)
    return out.index_add_(0, seg, src)
def _pad(x, pw):
    flat = tuple(v for pair in reversed(pw) for v in pair)
    return torch.nn.functional.pad(x, flat)

kernel_name = 'concat_heads__gqa_block_cached__gqa_block_cached__near_ridge'

def setup_inputs():

    _w = (lambda a: (lambda t: t.to(torch.bfloat16) if t.is_floating_point() else t)(torch.as_tensor(a)))
    def _A_setup():
        B, Sq, D = 16, 80, 640
        Hq, Hkv, Sk, Dh = 32, 32, 80, 128
        assert Hq % Hkv == 0, (Hq, Hkv)
        return {
            "x": _w((lambda *s: torch.randn(*s, dtype=torch.bfloat16) * 0.8)(B, Sq, D)),
            "k_cache": _w((lambda *s: torch.randn(*s, dtype=torch.bfloat16) * 0.8)(B, Hkv, Sk, Dh)),
            "v_cache": _w((lambda *s: torch.randn(*s, dtype=torch.bfloat16) * 0.05)(B, Hkv, Sk, Dh)),
            "wq": _w((lambda *s: torch.randn(*s, dtype=torch.bfloat16) * 0.8)(D, Hq * Dh) * (D ** -0.5)),
            "wo": _w((lambda *s: torch.randn(*s, dtype=torch.bfloat16) * 0.05)(Hq * Dh, D) * ((Hq * Dh) ** -0.5)),
        }
    _A_in = _A_setup()

    def _B_setup():
        B, Sq, D = 16, 80, 640
        Hq, Hkv, Sk, Dh = 32, 32, 80, 128
        assert Hq % Hkv == 0, (Hq, Hkv)
        return {
            "x": _w((lambda *s: torch.randn(*s, dtype=torch.bfloat16) * 0.8)(B, Sq, D)),
            "k_cache": _w((lambda *s: torch.randn(*s, dtype=torch.bfloat16) * 0.8)(B, Hkv, Sk, Dh)),
            "v_cache": _w((lambda *s: torch.randn(*s, dtype=torch.bfloat16) * 0.05)(B, Hkv, Sk, Dh)),
            "wq": _w((lambda *s: torch.randn(*s, dtype=torch.bfloat16) * 0.8)(D, Hq * Dh) * (D ** -0.5)),
            "wo": _w((lambda *s: torch.randn(*s, dtype=torch.bfloat16) * 0.05)(Hq * Dh, D) * ((Hq * Dh) ** -0.5)),
        }
    _B_in = _B_setup()

    return {
        "A_x": _A_in["x"],
        "A_k_cache": _A_in["k_cache"],
        "A_v_cache": _A_in["v_cache"],
        "A_wq": _A_in["wq"],
        "A_wo": _A_in["wo"],
        "B_x": _B_in["x"],
        "B_k_cache": _B_in["k_cache"],
        "B_v_cache": _B_in["v_cache"],
        "B_wq": _B_in["wq"],
        "B_wo": _B_in["wo"],
    }

def reference(A_x, A_k_cache, A_v_cache, A_wq, A_wo, B_x, B_k_cache, B_v_cache, B_wq, B_wo):
    def _A_ref(x, k_cache, v_cache, wq, wo):
        B, Sq, D = x.shape
        Hq, Dh = 32, 128
        Hkv = k_cache.shape[1]
        rep = Hq // Hkv
        q = (lambda x, *d: x.permute(*d))((x @ wq).reshape(B, Sq, Hq, Dh), 0, 2, 1, 3)
        k = (lambda x, n, axis: torch.repeat_interleave(x, n, dim=axis))(k_cache, rep, axis=1)
        v = (lambda x, n, axis: torch.repeat_interleave(x, n, dim=axis))(v_cache, rep, axis=1)
        scores = torch.einsum("bhqd,bhkd->bhqk", q, k) * (Dh ** -0.5)
        p = _softmax(scores, axis=-1)
        o = torch.einsum("bhqk,bhkd->bhqd", p, v)
        return (lambda x, *d: x.permute(*d))(o, 0, 2, 1, 3).reshape(B, Sq, Hq * Dh) @ wo

    def _B_ref(x, k_cache, v_cache, wq, wo):
        B, Sq, D = x.shape
        Hq, Dh = 32, 128
        Hkv = k_cache.shape[1]
        rep = Hq // Hkv
        q = (lambda x, *d: x.permute(*d))((x @ wq).reshape(B, Sq, Hq, Dh), 0, 2, 1, 3)
        k = (lambda x, n, axis: torch.repeat_interleave(x, n, dim=axis))(k_cache, rep, axis=1)
        v = (lambda x, n, axis: torch.repeat_interleave(x, n, dim=axis))(v_cache, rep, axis=1)
        scores = torch.einsum("bhqd,bhkd->bhqk", q, k) * (Dh ** -0.5)
        p = _softmax(scores, axis=-1)
        o = torch.einsum("bhqk,bhkd->bhqd", p, v)
        return (lambda x, *d: x.permute(*d))(o, 0, 2, 1, 3).reshape(B, Sq, Hq * Dh) @ wo

    a = _A_ref(A_x, A_k_cache, A_v_cache, A_wq, A_wo)
    b = _B_ref(B_x, B_k_cache, B_v_cache, B_wq, B_wo)
    return torch.concatenate([a, b], axis=-1)
```

```asm
; @launch grid=(256,1,1) block=(256,1,1) lds=163840
.amdgcn_target "amdgcn-amd-amdhsa--gfx950"
.text
.p2align 12
.globl concat_heads__gqa_block_cached__gqa_block_cached__near_ridge_kernel
.p2align 8
.type concat_heads__gqa_block_cached__gqa_block_cached__near_ridge_kernel,@function
concat_heads__gqa_block_cached__gqa_block_cached__near_ridge_kernel:
    s_cmp_ge_u32 s2, 256
    s_cbranch_scc1 L_end
    s_load_dwordx16 s[4:19], s[0:1], 0
    s_load_dwordx8 s[20:27], s[0:1], 64
    s_load_dwordx2 s[28:29], s[0:1], 96
    v_lshrrev_b32_e32 v69, 6, v0
    v_and_b32_e32 v64, 63, v0
    v_readfirstlane_b32 s3, v69
    s_and_b32 s68, s2, 7
    s_lshr_b32 s69, s2, 3
    s_lshr_b32 s64, s68, 2
    s_and_b32 s65, s68, 3
    s_lshr_b32 s66, s69, 2
    s_and_b32 s67, s69, 3
    v_lshrrev_b32_e32 v65, 4, v64
    v_and_b32_e32 v66, 15, v64
    v_lshrrev_b32_e64 v67, 3, v64
    v_and_b32_e32 v68, 7, v64
    s_lshl_b32 s68, s65, 3
    s_lshl_b32 s69, s67, 1
    s_add_u32 s68, s68, s69
    s_and_b32 s82, s3, 1
    s_add_u32 s81, s68, s82
    s_lshr_b32 s69, s3, 1
    s_lshl_b32 s68, s69, 17
    s_lshl_b32 s80, s81, 8
    s_add_u32 s68, s68, s80
    v_lshl_add_u32 v69, v65, 13, s68
    v_lshlrev_b32_e32 v70, 1, v65
    v_xor_b32_e32 v70, v70, v66
    v_xor_b32_e64 v71, 8, v70
    v_lshl_add_u32 v44, v70, 4, v69
    v_lshl_add_u32 v73, v71, 4, v69
    v_add_u32 v45, 31744, v44
    v_add_u32 v46, 63488, v73
    v_add_u32 v47, 95232, v73
    s_lshl_b32 s68, s82, 13
    s_lshl_b32 s80, s69, 12
    s_add_u32 s73, s68, s80
    s_lshr_b32 s80, s67, 1
    s_add_u32 s68, s80, s66
    s_and_b32 s68, s68, 1
    s_mul_i32 s71, s68, 640
    s_lshl_b32 s70, s71, 12
    s_mov_b32 s86, 5242880
    s_movk_i32 s87, 1280
    s_waitcnt lgkmcnt(0)
    s_cmp_eq_u32 s64, 0
    s_cselect_b32 s36, s10, s20
    s_cselect_b32 s37, s11, s21
    s_mov_b32 s38, 5242880
    s_mov_b32 s39, 0x20000
    s_add_u32 m0, s73, 122880
    s_nop 0
    s_nop 0
    buffer_load_dwordx4 v44, s[36:39], s70 offen offset:0 lds
    buffer_load_dwordx4 v45, s[36:39], s70 offen offset:1024 lds
    buffer_load_dwordx4 v46, s[36:39], s70 offen offset:2048 lds
    buffer_load_dwordx4 v47, s[36:39], s70 offen offset:3072 lds
    s_add_u32 s70, s70, 0x40000
    s_getpc_b64 s[0:1]
L_pc:
    s_lshr_b32 s68, s2, 3
    s_lshl_b32 s68, s68, 2
    s_add_u32 s68, s68, s3
    s_lshl_b32 s91, s68, 6
    s_load_dword s101, s[0:1], s91
    s_mul_i32 s68, s66, 160
    s_mul_i32 s80, s3, 40
    s_add_u32 s68, s68, s80
    v_add_u32_e32 v69, s68, v67
    v_mul_u32_u24 v69, 1280, v69
    s_lshl_b32 s80, s82, 2
    v_xor_b32_e32 v72, v68, v65
    v_xor_b32_e32 v72, s80, v72
    v_xor_b32_e32 v73, 4, v72
    v_lshl_add_u32 v48, v72, 4, v69
    v_lshl_add_u32 v73, v73, 4, v69
    v_add_u32 v49, 9216, v73
    v_add_u32 v50, 18432, v48
    v_add_u32 v51, 27648, v73
    v_add_u32 v52, 40960, v48
    s_mul_i32 s68, s3, 5120
    s_sub_u32 s88, s68, 128
    s_cmp_eq_u32 s64, 0
    s_cselect_b32 s32, s4, s14
    s_cselect_b32 s33, s5, s15
    s_mov_b32 s34, 1638400
    s_mov_b32 s35, 0x20000
    s_add_u32 m0, s88, 102528
    s_nop 0
    buffer_load_dwordx4 v48, s[32:35], s71 offen offset:0 lds
    buffer_load_dwordx4 v49, s[32:35], s71 offen offset:1024 lds
    buffer_load_dwordx4 v50, s[32:35], s71 offen offset:2048 lds
    buffer_load_dwordx4 v51, s[32:35], s71 offen offset:3072 lds
    s_add_u32 m0, s88, 106624
    s_nop 0
    s_nop 0
    buffer_load_dwordx4 v52, s[32:35], s71 offen offset:0 lds
    s_add_u32 s71, s71, 128
    s_load_dword s101, s[0:1], s91 offset:8192
    s_load_dword s101, s[0:1], s91 offset:16384
    s_load_dword s101, s[0:1], s91 offset:24576
    s_add_u32 s91, s91, 32768
    s_min_u32 s91, s91, L_end-L_pc
    s_load_dword s101, s[0:1], s91
    v_lshlrev_b32_e64 v75, 8, v65
    v_lshl_add_u32 v57, v70, 4, v75
    v_lshl_add_u32 v58, v71, 4, v75
    v_bfe_u32 v69, v64, 2, 2
    v_and_b32_e64 v70, 3, v64
    v_bfe_u32 v71, v64, 2, 3
    s_lshl_b32 s68, s82, 13
    s_add_u32 s68, s68, 65536
    v_lshl_add_u32 v72, v65, 3, v69
    v_lshlrev_b32_e32 v72, 8, v72
    v_lshl_add_u32 v72, v70, 3, v72
    v_add_u32_e64 v72, s68, v72
    v_lshl_add_u32 v24, v71, 5, v72
    v_xor_b32_e32 v25, 32, v24
    v_xor_b32_e32 v26, 64, v24
    v_xor_b32 v27, 96, v24
    v_xor_b32 v28, 128, v24
    v_xor_b32 v29, 160, v24
    v_xor_b32 v30, 192, v24
    v_xor_b32 v31, 224, v24
    s_mul_i32 s68, s69, 10240
    s_add_u32 s68, s68, 102400
    v_lshrrev_b32_e32 v72, 1, v66
    v_xor_b32_e32 v72, v72, v65
    v_lshlrev_b32_e64 v72, 4, v72
    v_lshl_add_u32 v72, v66, 7, v72
    v_add_u32_e32 v32, s68, v72
    v_xor_b32_e32 v33, 64, v32
    s_add_u32 m0, s73, 65536
    s_nop 0
    s_nop 0
    buffer_load_dwordx4 v44, s[36:39], s70 offen offset:0 lds
    buffer_load_dwordx4 v45, s[36:39], s70 offen offset:1024 lds
    buffer_load_dwordx4 v46, s[36:39], s70 offen offset:2048 lds
    buffer_load_dwordx4 v47, s[36:39], s70 offen offset:3072 lds
    s_add_u32 s70, s70, 0x40000
    s_add_u32 m0, s73, 81920
    s_nop 0
    s_nop 0
    buffer_load_dwordx4 v44, s[36:39], s70 offen offset:0 lds
    buffer_load_dwordx4 v45, s[36:39], s70 offen offset:1024 lds
    buffer_load_dwordx4 v46, s[36:39], s70 offen offset:2048 lds
    buffer_load_dwordx4 v47, s[36:39], s70 offen offset:3072 lds
    s_add_u32 s70, s70, 0x40000
    s_waitcnt vmcnt(8)
    s_barrier
    ds_read_b64_tr_b16 a[0:1], v24 offset:57344
    ds_read_b128 a[96:99], v32 offset:0
    ds_read_b64_tr_b16 a[2:3], v24 offset:58368
    ds_read_b64_tr_b16 a[4:5], v25 offset:57344
    ds_read_b64_tr_b16 a[6:7], v25 offset:58368
    ds_read_b128 a[100:103], v32 offset:2048
    ds_read_b64_tr_b16 a[8:9], v26 offset:57344
    ds_read_b64_tr_b16 a[10:11], v26 offset:58368
    ds_read_b64_tr_b16 a[12:13], v27 offset:57344
    ds_read_b128 a[104:107], v32 offset:4096
    ds_read_b64_tr_b16 a[14:15], v27 offset:58368
    ds_read_b64_tr_b16 a[16:17], v28 offset:57344
    ds_read_b64_tr_b16 a[18:19], v28 offset:58368
    ds_read_b128 a[108:111], v32 offset:6144
    ds_read_b64_tr_b16 a[20:21], v29 offset:57344
    ds_read_b64_tr_b16 a[22:23], v29 offset:58368
    ds_read_b64_tr_b16 a[24:25], v30 offset:57344
    ds_read_b128 a[112:115], v32 offset:8192
    ds_read_b64_tr_b16 a[26:27], v30 offset:58368
    ds_read_b64_tr_b16 a[28:29], v31 offset:57344
    ds_read_b64_tr_b16 a[30:31], v31 offset:58368
    s_add_u32 m0, s88, 143488
    s_cmp_eq_u32 s64, 0
    s_cselect_b32 s40, s6, s16
    s_cselect_b32 s41, s7, s17
    s_mov_b32 s42, 10485760
    s_mov_b32 s43, 0x20000
    s_cselect_b32 s44, s8, s18
    s_cselect_b32 s45, s9, s19
    s_mov_b32 s46, 10485760
    s_mov_b32 s47, 0x20000
    s_cselect_b32 s52, s12, s22
    s_cselect_b32 s53, s13, s23
    s_nop 0
    s_mov_b32 s54, 5242880
    s_mov_b32 s55, 0x20000
    buffer_load_dwordx4 v48, s[32:35], s71 offen offset:0 lds
    buffer_load_dwordx4 v49, s[32:35], s71 offen offset:1024 lds
    s_mov_b32 s48, s28
    s_mov_b32 s49, s29
    s_mov_b32 s50, 268435456
    s_mov_b32 s51, 0x20000
    s_mov_b32 s56, s24
    s_mov_b32 s57, s25
    s_mov_b32 s58, 3276800
    s_mov_b32 s59, 0x20000
    buffer_load_dwordx4 v50, s[32:35], s71 offen offset:2048 lds
    buffer_load_dwordx4 v51, s[32:35], s71 offen offset:3072 lds
    s_mov_b32 s60, s26
    s_mov_b32 s61, s27
    s_mov_b32 s62, 256
    s_mov_b32 s63, 0x20000
    s_lshl_b32 s68, s66, 1
    s_add_u32 s68, s68, s69
    s_lshl_b32 s68, s68, 5
    s_add_u32 s68, s68, s81
    s_add_u32 m0, s88, 147584
    s_nop 0
    buffer_load_dwordx4 v52, s[32:35], s71 offen offset:0 lds
    s_mul_i32 s6, s68, 20480
    s_sub_u32 s72, s6, 128
    s_lshl_b32 s5, s3, 14
    s_sub_u32 s75, s5, 128
    v_xor_b32_e64 v72, v65, v66
    v_lshl_add_u32 v53, v72, 4, v75
    v_xor_b32_e64 v54, 64, v53
    v_xor_b32 v55, 128, v53
    v_xor_b32 v56, 192, v53
    s_add_u32 s71, s71, 128
    s_waitcnt vmcnt(9) lgkmcnt(0)
    s_barrier
    v_mfma_f32_16x16x32_bf16 v[96:99], a[0:3], a[96:99], 0
    s_add_u32 m0, s73, 122880
    ds_read_b64_tr_b16 a[32:33], v24 offset:0
    v_lshrrev_b32_e64 v74, 1, v65
    v_mfma_f32_16x16x32_bf16 v[100:103], a[4:7], a[96:99], 0
    buffer_load_dwordx4 v44, s[36:39], s70 offen offset:0 lds
    ds_read_b128 a[116:119], v33 offset:0
    v_mfma_f32_16x16x32_bf16 v[104:107], a[8:11], a[96:99], 0
    v_xor_b32_e64 v74, v74, v66
    v_mfma_f32_16x16x32_bf16 v[108:111], a[12:15], a[96:99], 0
    buffer_load_dwordx4 v45, s[36:39], s70 offen offset:1024 lds
    ds_read_b64_tr_b16 a[34:35], v24 offset:1024
    v_mfma_f32_16x16x32_bf16 v[112:115], a[16:19], a[96:99], 0
    v_and_b32_e64 v72, 1, v65
    v_mfma_f32_16x16x32_bf16 v[116:119], a[20:23], a[96:99], 0
    buffer_load_dwordx4 v46, s[36:39], s70 offen offset:2048 lds
    ds_read_b64_tr_b16 a[36:37], v25 offset:0
    v_mfma_f32_16x16x32_bf16 v[120:123], a[24:27], a[96:99], 0
    buffer_load_dwordx4 v47, s[36:39], s70 offen offset:3072 lds
    v_lshlrev_b32_e64 v72, 3, v72
    v_mfma_f32_16x16x32_bf16 v[124:127], a[28:31], a[96:99], 0
    ds_read_b64_tr_b16 a[38:39], v25 offset:1024
    v_mfma_f32_16x16x32_bf16 v[128:131], a[0:3], a[100:103], 0
    s_add_u32 s70, s70, 0x40000
    v_lshl_add_u32 v72, v66, 8, v72
    v_mfma_f32_16x16x32_bf16 v[132:135], a[4:7], a[100:103], 0
    ds_read_b128 a[120:123], v33 offset:2048
    v_mfma_f32_16x16x32_bf16 v[136:139], a[8:11], a[100:103], 0
    s_add_u32 m0, s75, 128
    v_add_u32_e64 v72, s5, v72
    v_mfma_f32_16x16x32_bf16 v[140:143], a[12:15], a[100:103], 0
    ds_read_b64_tr_b16 a[40:41], v26 offset:0
    v_mfma_f32_16x16x32_bf16 v[144:147], a[16:19], a[100:103], 0
    s_add_u32 s68, s72, 128
    ds_read_b64_tr_b16 a[42:43], v26 offset:1024
    v_lshl_add_u32 v34, v74, 4, v72
    v_mfma_f32_16x16x32_bf16 v[148:151], a[20:23], a[100:103], 0
    buffer_load_dwordx4 v53, s[40:43], s68 offen offset:0 nt lds
    ds_read_b64_tr_b16 a[44:45], v27 offset:0
    v_mfma_f32_16x16x32_bf16 v[152:155], a[24:27], a[100:103], 0
    v_xor_b32_e64 v35, 32, v34
    v_mfma_f32_16x16x32_bf16 v[156:159], a[28:31], a[100:103], 0
    buffer_load_dwordx4 v54, s[40:43], s68 offen offset:1024 nt lds
    ds_read_b128 a[124:127], v33 offset:4096
    v_mfma_f32_16x16x32_bf16 v[160:163], a[0:3], a[104:107], 0
    v_xor_b32_e64 v36, 64, v34
    v_mfma_f32_16x16x32_bf16 v[164:167], a[4:7], a[104:107], 0
    buffer_load_dwordx4 v55, s[40:43], s68 offen offset:2048 nt lds
    ds_read_b64_tr_b16 a[46:47], v27 offset:1024
    v_mfma_f32_16x16x32_bf16 v[168:171], a[8:11], a[104:107], 0
    v_xor_b32 v37, 96, v34
    v_mfma_f32_16x16x32_bf16 v[172:175], a[12:15], a[104:107], 0
    ds_read_b64_tr_b16 a[48:49], v28 offset:0
    v_mfma_f32_16x16x32_bf16 v[176:179], a[16:19], a[104:107], 0
    v_xor_b32 v38, 128, v34
    v_mfma_f32_16x16x32_bf16 v[180:183], a[20:23], a[104:107], 0
    ds_read_b64_tr_b16 a[50:51], v28 offset:1024
    v_mfma_f32_16x16x32_bf16 v[184:187], a[24:27], a[104:107], 0
    v_xor_b32 v39, 160, v34
    v_mfma_f32_16x16x32_bf16 v[188:191], a[28:31], a[104:107], 0
    ds_read_b128 a[128:131], v33 offset:6144
    v_mfma_f32_16x16x32_bf16 v[192:195], a[0:3], a[108:111], 0
    ds_read_b64_tr_b16 a[52:53], v29 offset:0
    v_xor_b32 v40, 192, v34
    v_mfma_f32_16x16x32_bf16 v[196:199], a[4:7], a[108:111], 0
    ds_read_b64_tr_b16 a[54:55], v29 offset:1024
    v_mfma_f32_16x16x32_bf16 v[200:203], a[8:11], a[108:111], 0
    v_xor_b32 v41, 224, v34
    v_mfma_f32_16x16x32_bf16 v[204:207], a[12:15], a[108:111], 0
    ds_read_b64_tr_b16 a[56:57], v30 offset:0
    v_mfma_f32_16x16x32_bf16 v[208:211], a[16:19], a[108:111], 0
    v_lshlrev_b32_e64 v0, 2, v64
    v_mfma_f32_16x16x32_bf16 v[212:215], a[20:23], a[108:111], 0
    ds_read_b128 a[132:135], v33 offset:8192
    v_mfma_f32_16x16x32_bf16 v[216:219], a[24:27], a[108:111], 0
    v_lshlrev_b32_e64 v1, 4, v64
    v_mfma_f32_16x16x32_bf16 v[220:223], a[28:31], a[108:111], 0
    ds_read_b64_tr_b16 a[58:59], v30 offset:1024
    v_mfma_f32_16x16x32_bf16 v[224:227], a[0:3], a[112:115], 0
    v_add_u32 v2, 4096, v1
    v_mfma_f32_16x16x32_bf16 v[228:231], a[4:7], a[112:115], 0
    ds_read_b64_tr_b16 a[60:61], v31 offset:0
    v_mfma_f32_16x16x32_bf16 v[232:235], a[8:11], a[112:115], 0
    s_lshl_b32 s10, s64, 2
    s_nop 0
    v_mfma_f32_16x16x32_bf16 v[236:239], a[12:15], a[112:115], 0
    ds_read_b64_tr_b16 a[62:63], v31 offset:1024
    v_mfma_f32_16x16x32_bf16 v[240:243], a[16:19], a[112:115], 0
    v_mfma_f32_16x16x32_bf16 v[244:247], a[20:23], a[112:115], 0
    v_mfma_f32_16x16x32_bf16 v[248:251], a[24:27], a[112:115], 0
    v_mfma_f32_16x16x32_bf16 v[252:255], a[28:31], a[112:115], 0
    s_waitcnt vmcnt(7) lgkmcnt(0)
    s_barrier
    v_mfma_f32_16x16x32_bf16 v[96:99], a[32:35], a[116:119], v[96:99]
    s_add_u32 m0, s73, 65536
    ds_read_b64_tr_b16 a[64:65], v24 offset:16384
    s_add_u32 s10, s10, s65
    s_nop 0
    v_mfma_f32_16x16x32_bf16 v[100:103], a[36:39], a[116:119], v[100:103]
    buffer_load_dwordx4 v44, s[36:39], s70 offen offset:0 lds
    ds_read_b128 a[136:139], v32 offset:40960
    v_mfma_f32_16x16x32_bf16 v[104:107], a[40:43], a[116:119], v[104:107]
    s_lshl_b32 s4, s10, 2
    s_nop 0
    v_mfma_f32_16x16x32_bf16 v[108:111], a[44:47], a[116:119], v[108:111]
    buffer_load_dwordx4 v45, s[36:39], s70 offen offset:1024 lds
    ds_read_b64_tr_b16 a[66:67], v24 offset:17408
    v_mfma_f32_16x16x32_bf16 v[112:115], a[48:51], a[116:119], v[112:115]
    s_lshl_b32 s10, s10, 3
    s_nop 0
    v_mfma_f32_16x16x32_bf16 v[116:119], a[52:55], a[116:119], v[116:119]
    buffer_load_dwordx4 v46, s[36:39], s70 offen offset:2048 lds
    ds_read_b64_tr_b16 a[68:69], v25 offset:16384
    v_mfma_f32_16x16x32_bf16 v[120:123], a[56:59], a[116:119], v[120:123]
    s_lshl_b32 s14, s10, 10
    s_nop 0
    v_mfma_f32_16x16x32_bf16 v[124:127], a[60:63], a[116:119], v[124:127]
    buffer_load_dwordx4 v47, s[36:39], s70 offen offset:3072 lds
    ds_read_b64_tr_b16 a[70:71], v25 offset:17408
    v_mfma_f32_16x16x32_bf16 v[128:131], a[32:35], a[120:123], v[128:131]
    s_add_u32 s70, s70, 0x40000
    s_add_u32 s14, s14, 25165824
    v_mfma_f32_16x16x32_bf16 v[132:135], a[36:39], a[120:123], v[132:135]
    ds_read_b128 a[140:143], v32 offset:43008
    v_mfma_f32_16x16x32_bf16 v[136:139], a[40:43], a[120:123], v[136:139]
    s_add_u32 m0, s88, 102528
    s_lshl_b32 s10, s66, 10
    s_nop 0
    v_mfma_f32_16x16x32_bf16 v[140:143], a[44:47], a[120:123], v[140:143]
    ds_read_b64_tr_b16 a[72:73], v26 offset:16384
    v_mfma_f32_16x16x32_bf16 v[144:147], a[48:51], a[120:123], v[144:147]
    buffer_load_dwordx4 v48, s[32:35], s71 offen offset:0 lds
    ds_read_b64_tr_b16 a[74:75], v26 offset:17408
    s_add_u32 s90, s10, s14
    s_nop 0
    v_mfma_f32_16x16x32_bf16 v[148:151], a[52:55], a[120:123], v[148:151]
    ds_read_b64_tr_b16 a[76:77], v27 offset:16384
    v_mfma_f32_16x16x32_bf16 v[152:155], a[56:59], a[120:123], v[152:155]
    buffer_load_dwordx4 v49, s[32:35], s71 offen offset:1024 lds
    v_mov_b32 v75, 0x7ffffff0
    v_mfma_f32_16x16x32_bf16 v[156:159], a[60:63], a[120:123], v[156:159]
    buffer_load_dwordx4 v50, s[32:35], s71 offen offset:2048 lds
    ds_read_b128 a[144:147], v32 offset:45056
    v_mfma_f32_16x16x32_bf16 v[160:163], a[32:35], a[124:127], v[160:163]
    s_xor_b32 s10, s67, 0
    s_nop 0
    v_mfma_f32_16x16x32_bf16 v[164:167], a[36:39], a[124:127], v[164:167]
    buffer_load_dwordx4 v51, s[32:35], s71 offen offset:3072 lds
    ds_read_b64_tr_b16 a[78:79], v27 offset:17408
    v_mfma_f32_16x16x32_bf16 v[168:171], a[40:43], a[124:127], v[168:171]
    s_or_b32 s10, s10, s66
    s_nop 0
    v_mfma_f32_16x16x32_bf16 v[172:175], a[44:47], a[124:127], v[172:175]
    s_add_u32 m0, s88, 106624
    ds_read_b64_tr_b16 a[80:81], v28 offset:16384
    v_mfma_f32_16x16x32_bf16 v[176:179], a[48:51], a[124:127], v[176:179]
    s_lshl_b32 s11, s3, 11
    s_nop 0
    v_mfma_f32_16x16x32_bf16 v[180:183], a[52:55], a[124:127], v[180:183]
    buffer_load_dwordx4 v52, s[32:35], s71 offen offset:0 lds
    ds_read_b64_tr_b16 a[82:83], v28 offset:17408
    v_mfma_f32_16x16x32_bf16 v[184:187], a[56:59], a[124:127], v[184:187]
    s_add_u32 s71, s71, 128
    v_mov_b32_e64 v74, s10
    v_mfma_f32_16x16x32_bf16 v[188:191], a[60:63], a[124:127], v[188:191]
    ds_read_b128 a[148:151], v32 offset:47104
    v_mfma_f32_16x16x32_bf16 v[192:195], a[32:35], a[128:131], v[192:195]
    s_add_u32 m0, s75, 128
    ds_read_b64_tr_b16 a[84:85], v29 offset:16384
    v_cmp_eq_u32 vcc, 0, v74
    s_nop 0
    v_mfma_f32_16x16x32_bf16 v[196:199], a[36:39], a[128:131], v[196:199]
    ds_read_b64_tr_b16 a[86:87], v29 offset:17408
    v_mfma_f32_16x16x32_bf16 v[200:203], a[40:43], a[128:131], v[200:203]
    s_add_u32 s68, s72, 128
    v_add_u32_e64 v72, s11, v1
    v_mfma_f32_16x16x32_bf16 v[204:207], a[44:47], a[128:131], v[204:207]
    ds_read_b64_tr_b16 a[88:89], v30 offset:16384
    v_mfma_f32_16x16x32_bf16 v[208:211], a[48:51], a[128:131], v[208:211]
    buffer_load_dwordx4 v56, s[40:43], s68 offen offset:3072 nt lds
    v_mov_b32_e64 v76, 0
    v_mfma_f32_16x16x32_bf16 v[212:215], a[52:55], a[128:131], v[212:215]
    s_add_u32 m0, s75, 4224
    ds_read_b128 a[152:155], v32 offset:49152
    v_mfma_f32_16x16x32_bf16 v[216:219], a[56:59], a[128:131], v[216:219]
    v_cndmask_b32 v80, v75, v72, vcc
    s_nop 0
    v_mfma_f32_16x16x32_bf16 v[220:223], a[60:63], a[128:131], v[220:223]
    s_add_u32 s68, s72, 4224
    ds_read_b64_tr_b16 a[90:91], v30 offset:17408
    v_mfma_f32_16x16x32_bf16 v[224:227], a[32:35], a[132:135], v[224:227]
    s_or_b32 s10, s10, s3
    s_nop 0
    v_mfma_f32_16x16x32_bf16 v[228:231], a[36:39], a[132:135], v[228:231]
    buffer_load_dwordx4 v53, s[40:43], s68 offen offset:0 nt lds
    ds_read_b64_tr_b16 a[92:93], v31 offset:16384
    v_mfma_f32_16x16x32_bf16 v[232:235], a[40:43], a[132:135], v[232:235]
    v_or_b32_e64 v74, s10, v64
    v_mfma_f32_16x16x32_bf16 v[236:239], a[44:47], a[132:135], v[236:239]
    buffer_load_dwordx4 v54, s[40:43], s68 offen offset:1024 nt lds
    ds_read_b64_tr_b16 a[94:95], v31 offset:17408
    v_mfma_f32_16x16x32_bf16 v[240:243], a[48:51], a[132:135], v[240:243]
    v_mfma_f32_16x16x32_bf16 v[244:247], a[52:55], a[132:135], v[244:247]
    v_mfma_f32_16x16x32_bf16 v[248:251], a[56:59], a[132:135], v[248:251]
    v_mfma_f32_16x16x32_bf16 v[252:255], a[60:63], a[132:135], v[252:255]
    s_waitcnt vmcnt(15) lgkmcnt(0)
    s_barrier
    v_mfma_f32_16x16x32_bf16 v[96:99], a[64:67], a[136:139], v[96:99]
    s_add_u32 m0, s73, 81920
    ds_read_b64_tr_b16 a[0:1], v24 offset:57344
    v_cmp_eq_u32 vcc, 0, v74
    s_nop 0
    v_mfma_f32_16x16x32_bf16 v[100:103], a[68:71], a[136:139], v[100:103]
    buffer_load_dwordx4 v44, s[36:39], s70 offen offset:0 lds
    ds_read_b128 a[96:99], v33 offset:40960
    v_mfma_f32_16x16x32_bf16 v[104:107], a[72:75], a[136:139], v[104:107]
    v_mov_b32_e64 v77, 0
    v_mfma_f32_16x16x32_bf16 v[108:111], a[76:79], a[136:139], v[108:111]
    buffer_load_dwordx4 v45, s[36:39], s70 offen offset:1024 lds
    ds_read_b64_tr_b16 a[2:3], v24 offset:58368
    v_mfma_f32_16x16x32_bf16 v[112:115], a[80:83], a[136:139], v[112:115]
    v_mov_b32_e64 v78, 0
    v_mfma_f32_16x16x32_bf16 v[116:119], a[84:87], a[136:139], v[116:119]
    buffer_load_dwordx4 v46, s[36:39], s70 offen offset:2048 lds
    ds_read_b64_tr_b16 a[4:5], v25 offset:57344
    v_mfma_f32_16x16x32_bf16 v[120:123], a[88:91], a[136:139], v[120:123]
    v_mov_b32_e64 v79, 0
    v_mfma_f32_16x16x32_bf16 v[124:127], a[92:95], a[136:139], v[124:127]
    buffer_load_dwordx4 v47, s[36:39], s70 offen offset:3072 lds
    ds_read_b64_tr_b16 a[6:7], v25 offset:58368
    v_mfma_f32_16x16x32_bf16 v[128:131], a[64:67], a[140:143], v[128:131]
    s_add_u32 s70, s70, 0x40000
    v_mov_b32_e64 v6, 1
    v_mfma_f32_16x16x32_bf16 v[132:135], a[68:71], a[140:143], v[132:135]
    ds_read_b128 a[100:103], v33 offset:43008
    v_mfma_f32_16x16x32_bf16 v[136:139], a[72:75], a[140:143], v[136:139]
    s_add_u32 m0, s75, 4224
    v_cndmask_b32 v81, v75, v0, vcc
    s_nop 0
    v_mfma_f32_16x16x32_bf16 v[140:143], a[76:79], a[140:143], v[140:143]
    ds_read_b64_tr_b16 a[8:9], v26 offset:57344
    v_mfma_f32_16x16x32_bf16 v[144:147], a[80:83], a[140:143], v[144:147]
    s_add_u32 s68, s72, 4224
    ds_read_b64_tr_b16 a[10:11], v26 offset:58368
    s_mov_b32 s83, 0x3e0293ee
    v_mfma_f32_16x16x32_bf16 v[148:151], a[84:87], a[140:143], v[148:151]
    ds_read_b64_tr_b16 a[12:13], v27 offset:57344
    v_mfma_f32_16x16x32_bf16 v[152:155], a[88:91], a[140:143], v[152:155]
    buffer_load_dwordx4 v55, s[40:43], s68 offen offset:2048 nt lds
    s_and_b32 s7, s66, 4
    s_nop 0
    v_mfma_f32_16x16x32_bf16 v[156:159], a[92:95], a[140:143], v[156:159]
    buffer_load_dwordx4 v56, s[40:43], s68 offen offset:3072 nt lds
    ds_read_b128 a[104:107], v33 offset:45056
    v_mfma_f32_16x16x32_bf16 v[160:163], a[64:67], a[144:147], v[160:163]
    v_lshl_add_u32 v73, v65, 2, v69
    v_mfma_f32_16x16x32_bf16 v[164:167], a[68:71], a[144:147], v[164:167]
    s_add_u32 m0, s75, 8320
    ds_read_b64_tr_b16 a[14:15], v27 offset:58368
    v_mfma_f32_16x16x32_bf16 v[168:171], a[72:75], a[144:147], v[168:171]
    v_lshlrev_b32_e64 v73, 8, v73
    v_mfma_f32_16x16x32_bf16 v[172:175], a[76:79], a[144:147], v[172:175]
    s_add_u32 s68, s72, 8320
    ds_read_b64_tr_b16 a[16:17], v28 offset:57344
    v_mfma_f32_16x16x32_bf16 v[176:179], a[80:83], a[144:147], v[176:179]
    v_lshl_add_u32 v73, v70, 3, v73
    v_mfma_f32_16x16x32_bf16 v[180:183], a[84:87], a[144:147], v[180:183]
    buffer_load_dwordx4 v53, s[40:43], s68 offen offset:0 nt lds
    ds_read_b64_tr_b16 a[18:19], v28 offset:58368
    v_mfma_f32_16x16x32_bf16 v[184:187], a[88:91], a[144:147], v[184:187]
    v_add_u32_e64 v73, s5, v73
    v_mfma_f32_16x16x32_bf16 v[188:191], a[92:95], a[144:147], v[188:191]
    ds_read_b128 a[108:111], v33 offset:47104
    v_mfma_f32_16x16x32_bf16 v[192:195], a[64:67], a[148:151], v[192:195]
    ds_read_b64_tr_b16 a[20:21], v29 offset:57344
    v_xor_b32_e64 v71, s7, v71
    v_mfma_f32_16x16x32_bf16 v[196:199], a[68:71], a[148:151], v[196:199]
    ds_read_b64_tr_b16 a[22:23], v29 offset:58368
    v_mfma_f32_16x16x32_bf16 v[200:203], a[72:75], a[148:151], v[200:203]
    v_lshl_add_u32 v16, v71, 5, v73
    v_mfma_f32_16x16x32_bf16 v[204:207], a[76:79], a[148:151], v[204:207]
    ds_read_b64_tr_b16 a[24:25], v30 offset:57344
    v_mfma_f32_16x16x32_bf16 v[208:211], a[80:83], a[148:151], v[208:211]
    v_xor_b32_e64 v17, 32, v16
    v_mfma_f32_16x16x32_bf16 v[212:215], a[84:87], a[148:151], v[212:215]
    ds_read_b128 a[112:115], v33 offset:49152
    v_mfma_f32_16x16x32_bf16 v[216:219], a[88:91], a[148:151], v[216:219]
    v_xor_b32_e64 v18, 64, v16
    v_mfma_f32_16x16x32_bf16 v[220:223], a[92:95], a[148:151], v[220:223]
    ds_read_b64_tr_b16 a[26:27], v30 offset:58368
    v_mfma_f32_16x16x32_bf16 v[224:227], a[64:67], a[152:155], v[224:227]
    v_xor_b32 v19, 96, v16
    v_mfma_f32_16x16x32_bf16 v[228:231], a[68:71], a[152:155], v[228:231]
    ds_read_b64_tr_b16 a[28:29], v31 offset:57344
    v_mfma_f32_16x16x32_bf16 v[232:235], a[72:75], a[152:155], v[232:235]
    v_xor_b32 v20, 128, v16
    v_mfma_f32_16x16x32_bf16 v[236:239], a[76:79], a[152:155], v[236:239]
    ds_read_b64_tr_b16 a[30:31], v31 offset:58368
    v_mfma_f32_16x16x32_bf16 v[240:243], a[80:83], a[152:155], v[240:243]
    v_mfma_f32_16x16x32_bf16 v[244:247], a[84:87], a[152:155], v[244:247]
    v_mfma_f32_16x16x32_bf16 v[248:251], a[88:91], a[152:155], v[248:251]
    v_mfma_f32_16x16x32_bf16 v[252:255], a[92:95], a[152:155], v[252:255]
    s_mov_b64 exec, 0
    s_cmp_eq_u32 s3, 0
    s_cbranch_scc1 L_pad0
    s_cmp_eq_u32 s3, 1
    s_cbranch_scc1 L_pad1
    s_cmp_eq_u32 s3, 2
    s_cbranch_scc1 L_pad2
    s_branch L_pad3
L_back:
    s_mov_b64 exec, -1
    s_waitcnt vmcnt(9) lgkmcnt(0)
    s_barrier
    s_nop 0
    v_mfma_f32_16x16x32_bf16 v[96:99], a[0:3], a[96:99], v[96:99]
    s_add_u32 m0, s73, 122880
    ds_read_b64_tr_b16 a[32:33], v24 offset:0
    v_xor_b32 v21, 160, v16
    v_mfma_f32_16x16x32_bf16 v[100:103], a[4:7], a[96:99], v[100:103]
    buffer_load_dwordx4 v44, s[36:39], s70 offen offset:0 lds
    ds_read_b128 a[116:119], v32 offset:0
    v_mfma_f32_16x16x32_bf16 v[104:107], a[8:11], a[96:99], v[104:107]
    v_xor_b32 v22, 192, v16
    v_mfma_f32_16x16x32_bf16 v[108:111], a[12:15], a[96:99], v[108:111]
    buffer_load_dwordx4 v45, s[36:39], s70 offen offset:1024 lds
    ds_read_b64_tr_b16 a[34:35], v24 offset:1024
    ds_read_b64_tr_b16 a[36:37], v25 offset:0
    v_mfma_f32_16x16x32_bf16 v[112:115], a[16:19], a[96:99], v[112:115]
    v_xor_b32 v23, 224, v16
    v_mfma_f32_16x16x32_bf16 v[116:119], a[20:23], a[96:99], v[116:119]
    buffer_load_dwordx4 v46, s[36:39], s70 offen offset:2048 lds
    ds_read_b64_tr_b16 a[38:39], v25 offset:1024
    v_mfma_f32_16x16x32_bf16 v[120:123], a[24:27], a[96:99], v[120:123]
    s_lshl_b32 s10, s67, 2
    s_nop 0
    ds_read_b128 a[120:123], v32 offset:2048
    v_mfma_f32_16x16x32_bf16 v[124:127], a[28:31], a[96:99], v[124:127]
    buffer_load_dwordx4 v47, s[36:39], s70 offen offset:3072 lds
    ds_read_b64_tr_b16 a[40:41], v26 offset:0
    v_mfma_f32_16x16x32_bf16 v[128:131], a[0:3], a[100:103], v[128:131]
    s_add_u32 s10, s10, s3
    s_nop 0
    v_mfma_f32_16x16x32_bf16 v[132:135], a[4:7], a[100:103], v[132:135]
    s_add_u32 s70, s70, 0x40000
    ds_read_b64_tr_b16 a[42:43], v26 offset:1024
    ds_read_b64_tr_b16 a[44:45], v27 offset:0
    v_mfma_f32_16x16x32_bf16 v[136:139], a[8:11], a[100:103], v[136:139]
    s_add_u32 m0, s88, 143488
    s_lshl_b32 s10, s10, 6
    s_nop 0
    v_mfma_f32_16x16x32_bf16 v[140:143], a[12:15], a[100:103], v[140:143]
    ds_read_b128 a[124:127], v32 offset:4096
    v_mfma_f32_16x16x32_bf16 v[144:147], a[16:19], a[100:103], v[144:147]
    buffer_load_dwordx4 v48, s[32:35], s71 offen offset:0 lds
    s_add_u32 s9, s10, s90
    s_nop 0
    v_mfma_f32_16x16x32_bf16 v[148:151], a[20:23], a[100:103], v[148:151]
    ds_read_b64_tr_b16 a[46:47], v27 offset:1024
    ds_read_b64_tr_b16 a[48:49], v28 offset:0
    v_mfma_f32_16x16x32_bf16 v[152:155], a[24:27], a[100:103], v[152:155]
    buffer_load_dwordx4 v49, s[32:35], s71 offen offset:1024 lds
    s_lshl_b32 s10, s82, 1
    s_nop 0
    v_mfma_f32_16x16x32_bf16 v[156:159], a[28:31], a[100:103], v[156:159]
    ds_read_b64_tr_b16 a[50:51], v28 offset:1024
    v_mfma_f32_16x16x32_bf16 v[160:163], a[0:3], a[104:107], v[160:163]
    buffer_load_dwordx4 v50, s[32:35], s71 offen offset:2048 lds
    s_add_u32 s10, s10, s69
    s_nop 0
    ds_read_b128 a[128:131], v32 offset:6144
    v_mfma_f32_16x16x32_bf16 v[164:167], a[4:7], a[104:107], v[164:167]
    ds_read_b64_tr_b16 a[52:53], v29 offset:0
    v_mfma_f32_16x16x32_bf16 v[168:171], a[8:11], a[104:107], v[168:171]
    buffer_load_dwordx4 v51, s[32:35], s71 offen offset:3072 lds
    s_lshl_b32 s10, s10, 6
    s_nop 0
    v_mfma_f32_16x16x32_bf16 v[172:175], a[12:15], a[104:107], v[172:175]
    s_add_u32 m0, s88, 147584
    ds_read_b64_tr_b16 a[54:55], v29 offset:1024
    ds_read_b64_tr_b16 a[56:57], v30 offset:0
    v_mfma_f32_16x16x32_bf16 v[176:179], a[16:19], a[104:107], v[176:179]
    s_add_u32 s10, s10, 32
    s_nop 0
    v_mfma_f32_16x16x32_bf16 v[180:183], a[20:23], a[104:107], v[180:183]
    buffer_load_dwordx4 v52, s[32:35], s71 offen offset:0 lds
    ds_read_b128 a[132:135], v32 offset:8192
    v_mfma_f32_16x16x32_bf16 v[184:187], a[24:27], a[104:107], v[184:187]
    v_sub_u32 v71, s67, v64
    s_nop 0
    ds_read_b64_tr_b16 a[58:59], v30 offset:1024
    v_mfma_f32_16x16x32_bf16 v[188:191], a[28:31], a[104:107], v[188:191]
    s_add_u32 s71, s71, 128
    ds_read_b64_tr_b16 a[60:61], v31 offset:0
    v_mfma_f32_16x16x32_bf16 v[192:195], a[0:3], a[108:111], v[192:195]
    v_and_b32_e64 v71, 3, v71
    v_mfma_f32_16x16x32_bf16 v[196:199], a[4:7], a[108:111], v[196:199]
    s_add_u32 m0, s75, 8320
    ds_read_b64_tr_b16 a[62:63], v31 offset:1024
    v_mfma_f32_16x16x32_bf16 v[200:203], a[8:11], a[108:111], v[200:203]
    v_lshl_add_u32 v71, v71, 2, s10
    ds_read_b64 a[156:157], v34 offset:0
    v_mfma_f32_16x16x32_bf16 v[204:207], a[12:15], a[108:111], v[204:207]
    s_add_u32 s68, s72, 8320
    ds_read_b64 a[158:159], v35 offset:0
    v_mfma_f32_16x16x32_bf16 v[208:211], a[16:19], a[108:111], v[208:211]
    buffer_load_dwordx4 v54, s[40:43], s68 offen offset:1024 nt lds
    v_cmp_gt_u32 vcc, 4, v64
    s_nop 0
    v_mfma_f32_16x16x32_bf16 v[212:215], a[20:23], a[108:111], v[212:215]
    ds_read_b64 a[160:161], v36 offset:0
    ds_read_b64 a[162:163], v37 offset:0
    v_mfma_f32_16x16x32_bf16 v[216:219], a[24:27], a[108:111], v[216:219]
    buffer_load_dwordx4 v55, s[40:43], s68 offen offset:2048 nt lds
    v_lshl_add_u32 v71, v64, 8, v71
    v_mfma_f32_16x16x32_bf16 v[220:223], a[28:31], a[108:111], v[220:223]
    ds_read_b64 a[164:165], v38 offset:0
    v_mfma_f32_16x16x32_bf16 v[224:227], a[0:3], a[112:115], v[224:227]
    buffer_store_dwordx4 v[76:79], v80, s[48:51], s14 offen offset:0 sc1
    s_nop 0
    s_nop 0
    ds_read_b64 a[166:167], v39 offset:0
    v_mfma_f32_16x16x32_bf16 v[228:231], a[4:7], a[112:115], v[228:231]
    ds_read_b64 a[168:169], v40 offset:0
    v_mfma_f32_16x16x32_bf16 v[232:235], a[8:11], a[112:115], v[232:235]
    buffer_store_dwordx4 v[76:79], v80, s[48:51], s14 offen offset:1024 sc1
    v_cndmask_b32 v4, v75, v71, vcc
    s_nop 0
    v_mfma_f32_16x16x32_bf16 v[236:239], a[12:15], a[112:115], v[236:239]
    ds_read_b64 a[170:171], v41 offset:0
    v_mfma_f32_16x16x32_bf16 v[240:243], a[16:19], a[112:115], v[240:243]
    v_mfma_f32_16x16x32_bf16 v[244:247], a[20:23], a[112:115], v[244:247]
    v_mfma_f32_16x16x32_bf16 v[248:251], a[24:27], a[112:115], v[248:251]
    v_mfma_f32_16x16x32_bf16 v[252:255], a[28:31], a[112:115], v[252:255]
    s_waitcnt vmcnt(14) lgkmcnt(0)
    s_barrier
    v_mfma_f32_16x16x32_bf16 v[96:99], a[32:35], a[116:119], v[96:99]
    s_add_u32 m0, s73, 65536
    ds_read_b64_tr_b16 a[64:65], v24 offset:16384
    s_mul_i32 s8, s64, 10485760
    v_mfma_f32_16x16x32_bf16 v[100:103], a[36:39], a[116:119], v[100:103]
    buffer_load_dwordx4 v44, s[36:39], s70 offen offset:0 lds
    ds_read_b128 a[136:139], v33 offset:0
    v_mfma_f32_16x16x32_bf16 v[104:107], a[40:43], a[116:119], v[104:107]
    s_add_u32 s92, s6, s8
    s_nop 0
    v_mfma_f32_16x16x32_bf16 v[108:111], a[44:47], a[116:119], v[108:111]
    buffer_load_dwordx4 v45, s[36:39], s70 offen offset:1024 lds
    ds_read_b64_tr_b16 a[66:67], v24 offset:17408
    ds_read_b64_tr_b16 a[68:69], v25 offset:16384
    v_mfma_f32_16x16x32_bf16 v[112:115], a[48:51], a[116:119], v[112:115]
    s_add_u32 s93, s92, 5120
    v_mfma_f32_16x16x32_bf16 v[116:119], a[52:55], a[116:119], v[116:119]
    buffer_load_dwordx4 v46, s[36:39], s70 offen offset:2048 lds
    ds_read_b64_tr_b16 a[70:71], v25 offset:17408
    v_mfma_f32_16x16x32_bf16 v[120:123], a[56:59], a[116:119], v[120:123]
    s_add_u32 s94, s92, 10240
    ds_read_b128 a[140:143], v33 offset:2048
    v_mfma_f32_16x16x32_bf16 v[124:127], a[60:63], a[116:119], v[124:127]
    buffer_load_dwordx4 v47, s[36:39], s70 offen offset:3072 lds
    ds_read_b64_tr_b16 a[72:73], v26 offset:16384
    v_mfma_f32_16x16x32_bf16 v[128:131], a[32:35], a[120:123], v[128:131]
    s_add_u32 s70, s70, 0x40000
    s_add_u32 s95, s92, 15360
    v_mfma_f32_16x16x32_bf16 v[132:135], a[36:39], a[120:123], v[132:135]
    ds_read_b64_tr_b16 a[74:75], v26 offset:17408
    ds_read_b64_tr_b16 a[76:77], v27 offset:16384
    v_mfma_f32_16x16x32_bf16 v[136:139], a[40:43], a[120:123], v[136:139]
    s_add_u32 m0, s75, 8320
    s_lshl_b32 s10, s66, 1
    s_nop 0
    v_mfma_f32_16x16x32_bf16 v[140:143], a[44:47], a[120:123], v[140:143]
    ds_read_b128 a[144:147], v33 offset:4096
    v_mfma_f32_16x16x32_bf16 v[144:147], a[48:51], a[120:123], v[144:147]
    s_add_u32 s68, s72, 8320
    s_add_u32 s10, s10, s82
    s_nop 0
    v_mfma_f32_16x16x32_bf16 v[148:151], a[52:55], a[120:123], v[148:151]
    ds_read_b64_tr_b16 a[78:79], v27 offset:17408
    ds_read_b64_tr_b16 a[80:81], v28 offset:16384
    v_mfma_f32_16x16x32_bf16 v[152:155], a[56:59], a[120:123], v[152:155]
    buffer_load_dwordx4 v56, s[40:43], s68 offen offset:3072 nt lds
    s_lshl_b32 s10, s10, 2
    s_nop 0
    v_mfma_f32_16x16x32_bf16 v[156:159], a[60:63], a[120:123], v[156:159]
    s_add_u32 m0, s75, 12416
    ds_read_b64_tr_b16 a[82:83], v28 offset:17408
    v_mfma_f32_16x16x32_bf16 v[160:163], a[32:35], a[124:127], v[160:163]
    s_add_u32 s10, s10, s65
    s_nop 0
    ds_read_b128 a[148:151], v33 offset:6144
    v_mfma_f32_16x16x32_bf16 v[164:167], a[36:39], a[124:127], v[164:167]
    s_add_u32 s68, s72, 12416
    ds_read_b64_tr_b16 a[84:85], v29 offset:16384
    v_mfma_f32_16x16x32_bf16 v[168:171], a[40:43], a[124:127], v[168:171]
    s_mul_i32 s10, s10, 163840
    v_mfma_f32_16x16x32_bf16 v[172:175], a[44:47], a[124:127], v[172:175]
    buffer_load_dwordx4 v53, s[40:43], s68 offen offset:0 nt lds
    ds_read_b64_tr_b16 a[86:87], v29 offset:17408
    ds_read_b64_tr_b16 a[88:89], v30 offset:16384
    v_mfma_f32_16x16x32_bf16 v[176:179], a[48:51], a[124:127], v[176:179]
    s_add_u32 s10, s10, s8
    s_nop 0
    v_mfma_f32_16x16x32_bf16 v[180:183], a[52:55], a[124:127], v[180:183]
    ds_read_b128 a[152:155], v33 offset:8192
    v_mfma_f32_16x16x32_bf16 v[184:187], a[56:59], a[124:127], v[184:187]
    s_mul_i32 s6, s69, 20480
    ds_read_b64_tr_b16 a[90:91], v30 offset:17408
    v_mfma_f32_16x16x32_bf16 v[188:191], a[60:63], a[124:127], v[188:191]
    ds_read_b64_tr_b16 a[92:93], v31 offset:16384
    v_mfma_f32_16x16x32_bf16 v[192:195], a[32:35], a[128:131], v[192:195]
    s_add_u32 s6, s6, s10
    s_nop 0
    v_mfma_f32_16x16x32_bf16 v[196:199], a[36:39], a[128:131], v[196:199]
    ds_read_b64_tr_b16 a[94:95], v31 offset:17408
    v_mfma_f32_16x16x32_bf16 v[200:203], a[40:43], a[128:131], v[200:203]
    s_sub_u32 s6, s6, 128
    ds_read_b64 a[172:173], v34 offset:4096
    v_mfma_f32_16x16x32_bf16 v[204:207], a[44:47], a[128:131], v[204:207]
    ds_read_b64 a[174:175], v35 offset:4096
    v_mfma_f32_16x16x32_bf16 v[208:211], a[48:51], a[128:131], v[208:211]
    s_mul_i32 s8, s65, 1310720
    v_mfma_f32_16x16x32_bf16 v[212:215], a[52:55], a[128:131], v[212:215]
    ds_read_b64 a[176:177], v36 offset:4096
    ds_read_b64 a[178:179], v37 offset:4096
    v_mfma_f32_16x16x32_bf16 v[216:219], a[56:59], a[128:131], v[216:219]
    s_mul_i32 s10, s69, 163840
    v_mfma_f32_16x16x32_bf16 v[220:223], a[60:63], a[128:131], v[220:223]
    ds_read_b64 a[180:181], v38 offset:4096
    v_mfma_f32_16x16x32_bf16 v[224:227], a[32:35], a[132:135], v[224:227]
    s_add_u32 s8, s8, s10
    s_nop 0
    ds_read_b64 a[182:183], v39 offset:4096
    v_mfma_f32_16x16x32_bf16 v[228:231], a[36:39], a[132:135], v[228:231]
    ds_read_b64 a[184:185], v40 offset:4096
    v_mfma_f32_16x16x32_bf16 v[232:235], a[40:43], a[132:135], v[232:235]
    s_xor_b32 s10, s7, 0
    s_nop 0
    v_mfma_f32_16x16x32_bf16 v[236:239], a[44:47], a[132:135], v[236:239]
    ds_read_b64 a[186:187], v41 offset:4096
    v_mfma_f32_16x16x32_bf16 v[240:243], a[48:51], a[132:135], v[240:243]
    v_mfma_f32_16x16x32_bf16 v[244:247], a[52:55], a[132:135], v[244:247]
    v_mfma_f32_16x16x32_bf16 v[248:251], a[56:59], a[132:135], v[248:251]
    v_mfma_f32_16x16x32_bf16 v[252:255], a[60:63], a[132:135], v[252:255]
    s_waitcnt vmcnt(10) lgkmcnt(0)
    s_barrier
    v_mfma_f32_16x16x32_bf16 v[96:99], a[64:67], a[136:139], v[96:99]
    s_add_u32 m0, s73, 81920
    ds_read_b64_tr_b16 a[0:1], v24 offset:57344
    s_mul_i32 s28, s10, 20480
    v_mfma_f32_16x16x32_bf16 v[100:103], a[68:71], a[136:139], v[100:103]
    buffer_load_dwordx4 v44, s[36:39], s70 offen offset:0 lds
    ds_read_b128 a[96:99], v32 offset:40960
    v_mfma_f32_16x16x32_bf16 v[104:107], a[72:75], a[136:139], v[104:107]
    s_xor_b32 s10, s7, 2
    s_nop 0
    v_mfma_f32_16x16x32_bf16 v[108:111], a[76:79], a[136:139], v[108:111]
    buffer_load_dwordx4 v45, s[36:39], s70 offen offset:1024 lds
    ds_read_b64_tr_b16 a[2:3], v24 offset:58368
    v_mfma_f32_16x16x32_bf16 v[112:115], a[80:83], a[136:139], v[112:115]
    s_mul_i32 s29, s10, 20480
    v_mfma_f32_16x16x32_bf16 v[116:119], a[84:87], a[136:139], v[116:119]
    buffer_load_dwordx4 v46, s[36:39], s70 offen offset:2048 lds
    ds_read_b64_tr_b16 a[4:5], v25 offset:57344
    v_mfma_f32_16x16x32_bf16 v[120:123], a[88:91], a[136:139], v[120:123]
    s_xor_b32 s10, s7, 4
    s_nop 0
    v_mfma_f32_16x16x32_bf16 v[124:127], a[92:95], a[136:139], v[124:127]
    buffer_load_dwordx4 v47, s[36:39], s70 offen offset:3072 lds
    ds_read_b64_tr_b16 a[6:7], v25 offset:58368
    v_mfma_f32_16x16x32_bf16 v[128:131], a[64:67], a[140:143], v[128:131]
    s_add_u32 s70, s70, 0x40000
    s_mul_i32 s78, s10, 20480
    v_mfma_f32_16x16x32_bf16 v[132:135], a[68:71], a[140:143], v[132:135]
    ds_read_b128 a[100:103], v32 offset:43008
    v_mfma_f32_16x16x32_bf16 v[136:139], a[72:75], a[140:143], v[136:139]
    s_add_u32 m0, s88, 102528
    s_xor_b32 s10, s7, 6
    s_nop 0
    v_mfma_f32_16x16x32_bf16 v[140:143], a[76:79], a[140:143], v[140:143]
    ds_read_b64_tr_b16 a[8:9], v26 offset:57344
    v_mfma_f32_16x16x32_bf16 v[144:147], a[80:83], a[140:143], v[144:147]
    buffer_load_dwordx4 v48, s[32:35], s71 offen offset:0 lds
    ds_read_b64_tr_b16 a[10:11], v26 offset:58368
    s_mul_i32 s79, s10, 20480
    v_mfma_f32_16x16x32_bf16 v[148:151], a[84:87], a[140:143], v[148:151]
    ds_read_b64_tr_b16 a[12:13], v27 offset:57344
    v_mfma_f32_16x16x32_bf16 v[152:155], a[88:91], a[140:143], v[152:155]
    buffer_load_dwordx4 v49, s[32:35], s71 offen offset:1024 lds
    s_add_u32 s10, s67, 0
    s_nop 0
    v_mfma_f32_16x16x32_bf16 v[156:159], a[92:95], a[140:143], v[156:159]
    ds_read_b128 a[104:107], v32 offset:45056
    v_mfma_f32_16x16x32_bf16 v[160:163], a[64:67], a[144:147], v[160:163]
    buffer_load_dwordx4 v50, s[32:35], s71 offen offset:2048 lds
    s_and_b32 s10, s10, 3
    s_nop 0
    v_mfma_f32_16x16x32_bf16 v[164:167], a[68:71], a[144:147], v[164:167]
    buffer_load_dwordx4 v51, s[32:35], s71 offen offset:3072 lds
    ds_read_b64_tr_b16 a[14:15], v27 offset:58368
    v_mfma_f32_16x16x32_bf16 v[168:171], a[72:75], a[144:147], v[168:171]
    s_mul_i32 s11, s10, 327680
    v_mfma_f32_16x16x32_bf16 v[172:175], a[76:79], a[144:147], v[172:175]
    s_add_u32 m0, s88, 106624
    ds_read_b64_tr_b16 a[16:17], v28 offset:57344
    v_mfma_f32_16x16x32_bf16 v[176:179], a[80:83], a[144:147], v[176:179]
    s_add_u32 s97, s11, s8
    s_nop 0
    v_mfma_f32_16x16x32_bf16 v[180:183], a[84:87], a[144:147], v[180:183]
    buffer_load_dwordx4 v52, s[32:35], s71 offen offset:0 lds
    ds_read_b64_tr_b16 a[18:19], v28 offset:58368
    v_mfma_f32_16x16x32_bf16 v[184:187], a[88:91], a[144:147], v[184:187]
    s_add_u32 s10, s67, 1
    s_nop 0
    v_mfma_f32_16x16x32_bf16 v[188:191], a[92:95], a[144:147], v[188:191]
    s_add_u32 s71, s71, 128
    ds_read_b128 a[108:111], v32 offset:47104
    v_mfma_f32_16x16x32_bf16 v[192:195], a[64:67], a[148:151], v[192:195]
    s_cmp_eq_u32 s71, s87
    s_cselect_b32 s71, 0, s71
    ds_read_b64_tr_b16 a[20:21], v29 offset:57344
    s_and_b32 s10, s10, 3
    s_nop 0
    v_mfma_f32_16x16x32_bf16 v[196:199], a[68:71], a[148:151], v[196:199]
    ds_read_b64_tr_b16 a[22:23], v29 offset:58368
    v_mfma_f32_16x16x32_bf16 v[200:203], a[72:75], a[148:151], v[200:203]
    s_add_u32 m0, s75, 12416
    s_mul_i32 s11, s10, 327680
    v_mfma_f32_16x16x32_bf16 v[204:207], a[76:79], a[148:151], v[204:207]
    ds_read_b64_tr_b16 a[24:25], v30 offset:57344
    v_mfma_f32_16x16x32_bf16 v[208:211], a[80:83], a[148:151], v[208:211]
    s_add_u32 s68, s72, 12416
    s_add_u32 s98, s11, s8
    s_nop 0
    v_mfma_f32_16x16x32_bf16 v[212:215], a[84:87], a[148:151], v[212:215]
    ds_read_b128 a[112:115], v32 offset:49152
    v_mfma_f32_16x16x32_bf16 v[216:219], a[88:91], a[148:151], v[216:219]
    buffer_load_dwordx4 v54, s[40:43], s68 offen offset:1024 nt lds
    s_mul_i32 s11, s10, 40960
    v_mfma_f32_16x16x32_bf16 v[220:223], a[92:95], a[148:151], v[220:223]
    ds_read_b64_tr_b16 a[26:27], v30 offset:58368
    v_mfma_f32_16x16x32_bf16 v[224:227], a[64:67], a[152:155], v[224:227]
    s_add_u32 s30, s11, s6
    v_mfma_f32_16x16x32_bf16 v[228:231], a[68:71], a[152:155], v[228:231]
    ds_read_b64_tr_b16 a[28:29], v31 offset:57344
    v_mfma_f32_16x16x32_bf16 v[232:235], a[72:75], a[152:155], v[232:235]
    s_add_u32 s10, s67, 2
    v_mfma_f32_16x16x32_bf16 v[236:239], a[76:79], a[152:155], v[236:239]
    ds_read_b64_tr_b16 a[30:31], v31 offset:58368
    v_mfma_f32_16x16x32_bf16 v[240:243], a[80:83], a[152:155], v[240:243]
    v_mfma_f32_16x16x32_bf16 v[244:247], a[84:87], a[152:155], v[244:247]
    v_mfma_f32_16x16x32_bf16 v[248:251], a[88:91], a[152:155], v[248:251]
    v_mfma_f32_16x16x32_bf16 v[252:255], a[92:95], a[152:155], v[252:255]
    s_waitcnt vmcnt(11) lgkmcnt(0)
    s_barrier
    v_mfma_f32_16x16x32_bf16 v[96:99], a[0:3], a[96:99], v[96:99]
    s_add_u32 m0, s73, 122880
    ds_read_b64_tr_b16 a[32:33], v24 offset:0
    s_and_b32 s10, s10, 3
    s_nop 0
    v_mfma_f32_16x16x32_bf16 v[100:103], a[4:7], a[96:99], v[100:103]
    buffer_load_dwordx4 v44, s[36:39], s70 offen offset:0 lds
    ds_read_b128 a[116:119], v33 offset:40960
    v_mfma_f32_16x16x32_bf16 v[104:107], a[8:11], a[96:99], v[104:107]
    s_mul_i32 s11, s10, 327680
    v_mfma_f32_16x16x32_bf16 v[108:111], a[12:15], a[96:99], v[108:111]
    buffer_load_dwordx4 v45, s[36:39], s70 offen offset:1024 lds
    ds_read_b64_tr_b16 a[34:35], v24 offset:1024
    ds_read_b64_tr_b16 a[36:37], v25 offset:0
    v_mfma_f32_16x16x32_bf16 v[112:115], a[16:19], a[96:99], v[112:115]
    s_add_u32 s99, s11, s8
    s_nop 0
    v_mfma_f32_16x16x32_bf16 v[116:119], a[20:23], a[96:99], v[116:119]
    buffer_load_dwordx4 v46, s[36:39], s70 offen offset:2048 lds
    ds_read_b64_tr_b16 a[38:39], v25 offset:1024
    v_mfma_f32_16x16x32_bf16 v[120:123], a[24:27], a[96:99], v[120:123]
    s_mul_i32 s11, s10, 40960
    ds_read_b128 a[120:123], v33 offset:43008
    v_mfma_f32_16x16x32_bf16 v[124:127], a[28:31], a[96:99], v[124:127]
    buffer_load_dwordx4 v47, s[36:39], s70 offen offset:3072 lds
    ds_read_b64_tr_b16 a[40:41], v26 offset:0
    v_mfma_f32_16x16x32_bf16 v[128:131], a[0:3], a[100:103], v[128:131]
    s_add_u32 s70, s70, 0x40000
    s_add_u32 s31, s11, s6
    s_nop 0
    v_mfma_f32_16x16x32_bf16 v[132:135], a[4:7], a[100:103], v[132:135]
    ds_read_b64_tr_b16 a[42:43], v26 offset:1024
    ds_read_b64_tr_b16 a[44:45], v27 offset:0
    v_mfma_f32_16x16x32_bf16 v[136:139], a[8:11], a[100:103], v[136:139]
    s_cmp_eq_u32 s70, s86
    s_cselect_b32 s70, 0, s70
    s_add_u32 s10, s67, 3
    s_nop 0
    v_mfma_f32_16x16x32_bf16 v[140:143], a[12:15], a[100:103], v[140:143]
    ds_read_b128 a[124:127], v33 offset:45056
    v_mfma_f32_16x16x32_bf16 v[144:147], a[16:19], a[100:103], v[144:147]
    s_add_u32 m0, s75, 12416
    s_and_b32 s10, s10, 3
    s_nop 0
    v_mfma_f32_16x16x32_bf16 v[148:151], a[20:23], a[100:103], v[148:151]
    ds_read_b64_tr_b16 a[46:47], v27 offset:1024
    ds_read_b64_tr_b16 a[48:49], v28 offset:0
    v_mfma_f32_16x16x32_bf16 v[152:155], a[24:27], a[100:103], v[152:155]
    s_add_u32 s68, s72, 12416
    s_mul_i32 s11, s10, 327680
    v_mfma_f32_16x16x32_bf16 v[156:159], a[28:31], a[100:103], v[156:159]
    buffer_load_dwordx4 v55, s[40:43], s68 offen offset:2048 nt lds
    ds_read_b64_tr_b16 a[50:51], v28 offset:1024
    v_mfma_f32_16x16x32_bf16 v[160:163], a[0:3], a[104:107], v[160:163]
    s_add_u32 s100, s11, s8
    s_nop 0
    ds_read_b128 a[128:131], v33 offset:47104
    v_mfma_f32_16x16x32_bf16 v[164:167], a[4:7], a[104:107], v[164:167]
    buffer_load_dwordx4 v56, s[40:43], s68 offen offset:3072 nt lds
    ds_read_b64_tr_b16 a[52:53], v29 offset:0
    v_mfma_f32_16x16x32_bf16 v[168:171], a[8:11], a[104:107], v[168:171]
    s_mul_i32 s11, s10, 40960
    v_mfma_f32_16x16x32_bf16 v[172:175], a[12:15], a[104:107], v[172:175]
    buffer_store_dword v6, v81, s[60:63], s4 offen sc1
    ds_read_b64_tr_b16 a[54:55], v29 offset:1024
    ds_read_b64_tr_b16 a[56:57], v30 offset:0
    v_mfma_f32_16x16x32_bf16 v[176:179], a[16:19], a[104:107], v[176:179]
    s_add_u32 s96, s11, s6
    s_nop 0
    v_mfma_f32_16x16x32_bf16 v[180:183], a[20:23], a[104:107], v[180:183]
    ds_read_b128 a[132:135], v33 offset:49152
    v_mfma_f32_16x16x32_bf16 v[184:187], a[24:27], a[104:107], v[184:187]
    s_mul_i32 s10, s82, 10240
    ds_read_b64_tr_b16 a[58:59], v30 offset:1024
    v_mfma_f32_16x16x32_bf16 v[188:191], a[28:31], a[104:107], v[188:191]
    ds_read_b64_tr_b16 a[60:61], v31 offset:0
    v_mfma_f32_16x16x32_bf16 v[192:195], a[0:3], a[108:111], v[192:195]
    s_mul_i32 s11, s69, 5120
    v_mfma_f32_16x16x32_bf16 v[196:199], a[4:7], a[108:111], v[196:199]
    ds_read_b64_tr_b16 a[62:63], v31 offset:1024
    v_mfma_f32_16x16x32_bf16 v[200:203], a[8:11], a[108:111], v[200:203]
    s_add_u32 s10, s10, s11
    s_nop 0
    ds_read_b64 a[188:189], v34 offset:8192
    v_mfma_f32_16x16x32_bf16 v[204:207], a[12:15], a[108:111], v[204:207]
    ds_read_b64 a[190:191], v35 offset:8192
    v_mfma_f32_16x16x32_bf16 v[208:211], a[16:19], a[108:111], v[208:211]
    v_add_u32_e64 v3, s10, v1
    v_mfma_f32_16x16x32_bf16 v[212:215], a[20:23], a[108:111], v[212:215]
    ds_read_b64 a[192:193], v36 offset:8192
    ds_read_b64 a[194:195], v37 offset:8192
    v_mfma_f32_16x16x32_bf16 v[216:219], a[24:27], a[108:111], v[216:219]
    v_add_u32_e64 v7, s11, v1
    v_mfma_f32_16x16x32_bf16 v[220:223], a[28:31], a[108:111], v[220:223]
    ds_read_b64 a[196:197], v38 offset:8192
    v_mfma_f32_16x16x32_bf16 v[224:227], a[0:3], a[112:115], v[224:227]
    v_lshrrev_b32_e64 v69, 2, v64
    ds_read_b64 a[198:199], v39 offset:8192
    v_mfma_f32_16x16x32_bf16 v[228:231], a[4:7], a[112:115], v[228:231]
    ds_read_b64 a[200:201], v40 offset:8192
    v_mfma_f32_16x16x32_bf16 v[232:235], a[8:11], a[112:115], v[232:235]
    v_mul_u32_u24 v69, 320, v69
    v_mfma_f32_16x16x32_bf16 v[236:239], a[12:15], a[112:115], v[236:239]
    ds_read_b64 a[202:203], v41 offset:8192
    v_mfma_f32_16x16x32_bf16 v[240:243], a[16:19], a[112:115], v[240:243]
    v_mfma_f32_16x16x32_bf16 v[244:247], a[20:23], a[112:115], v[244:247]
    v_mfma_f32_16x16x32_bf16 v[248:251], a[24:27], a[112:115], v[248:251]
    v_mfma_f32_16x16x32_bf16 v[252:255], a[28:31], a[112:115], v[252:255]
    s_waitcnt vmcnt(8) lgkmcnt(0)
    s_barrier
    v_mfma_f32_16x16x32_bf16 v[96:99], a[32:35], a[116:119], v[96:99]
    s_add_u32 m0, s73, 65536
    ds_read_b64_tr_b16 a[64:65], v24 offset:16384
    v_lshl_add_u32 v69, v70, 3, v69
    v_mfma_f32_16x16x32_bf16 v[100:103], a[36:39], a[116:119], v[100:103]
    buffer_load_dwordx4 v44, s[36:39], s70 offen offset:0 lds
    ds_read_b128 a[136:139], v32 offset:0
    v_mfma_f32_16x16x32_bf16 v[104:107], a[40:43], a[116:119], v[104:107]
    s_mul_i32 s10, s82, 160
    v_mfma_f32_16x16x32_bf16 v[108:111], a[44:47], a[116:119], v[108:111]
    buffer_load_dwordx4 v45, s[36:39], s70 offen offset:1024 lds
    ds_read_b64_tr_b16 a[66:67], v24 offset:17408
    v_mfma_f32_16x16x32_bf16 v[112:115], a[48:51], a[116:119], v[112:115]
    s_add_u32 s10, s10, 81920
    v_mfma_f32_16x16x32_bf16 v[116:119], a[52:55], a[116:119], v[116:119]
    buffer_load_dwordx4 v46, s[36:39], s70 offen offset:2048 lds
    ds_read_b64_tr_b16 a[68:69], v25 offset:16384
    v_mfma_f32_16x16x32_bf16 v[120:123], a[56:59], a[116:119], v[120:123]
    v_add_u32_e64 v69, s10, v69
    v_mfma_f32_16x16x32_bf16 v[124:127], a[60:63], a[116:119], v[124:127]
    buffer_load_dwordx4 v47, s[36:39], s70 offen offset:3072 lds
    ds_read_b64_tr_b16 a[70:71], v25 offset:17408
    v_mfma_f32_16x16x32_bf16 v[128:131], a[32:35], a[120:123], v[128:131]
    s_add_u32 s70, s70, 0x40000
    v_and_b32_e64 v71, 1, v65
    v_mfma_f32_16x16x32_bf16 v[132:135], a[36:39], a[120:123], v[132:135]
    ds_read_b128 a[140:143], v32 offset:2048
    v_mfma_f32_16x16x32_bf16 v[136:139], a[40:43], a[120:123], v[136:139]
    s_add_u32 m0, s88, 143488
    v_lshlrev_b32_e64 v71, 5, v71
    v_mfma_f32_16x16x32_bf16 v[140:143], a[44:47], a[120:123], v[140:143]
    ds_read_b64_tr_b16 a[72:73], v26 offset:16384
    v_mfma_f32_16x16x32_bf16 v[144:147], a[48:51], a[120:123], v[144:147]
    buffer_load_dwordx4 v48, s[32:35], s71 offen offset:0 lds
    ds_read_b64_tr_b16 a[74:75], v26 offset:17408
    v_add_u32_e64 v72, v69, v71
    v_mfma_f32_16x16x32_bf16 v[148:151], a[52:55], a[120:123], v[148:151]
    ds_read_b64_tr_b16 a[76:77], v27 offset:16384
    v_mfma_f32_16x16x32_bf16 v[152:155], a[56:59], a[120:123], v[152:155]
    buffer_load_dwordx4 v49, s[32:35], s71 offen offset:1024 lds
    v_sub_u32 v73, v69, v71
    s_nop 0
    v_mfma_f32_16x16x32_bf16 v[156:159], a[60:63], a[120:123], v[156:159]
    ds_read_b128 a[144:147], v32 offset:4096
    v_mfma_f32_16x16x32_bf16 v[160:163], a[32:35], a[124:127], v[160:163]
    buffer_load_dwordx4 v50, s[32:35], s71 offen offset:2048 lds
    v_mov_b32_e64 v74, s82
    v_mfma_f32_16x16x32_bf16 v[164:167], a[36:39], a[124:127], v[164:167]
    buffer_load_dwordx4 v51, s[32:35], s71 offen offset:3072 lds
    ds_read_b64_tr_b16 a[78:79], v27 offset:17408
    v_mfma_f32_16x16x32_bf16 v[168:171], a[40:43], a[124:127], v[168:171]
    v_cmp_eq_u32 vcc, 0, v74
    s_nop 0
    v_mfma_f32_16x16x32_bf16 v[172:175], a[44:47], a[124:127], v[172:175]
    s_add_u32 m0, s88, 147584
    ds_read_b64_tr_b16 a[80:81], v28 offset:16384
    v_mfma_f32_16x16x32_bf16 v[176:179], a[48:51], a[124:127], v[176:179]
    s_mul_i32 s10, s82, 320
    v_mfma_f32_16x16x32_bf16 v[180:183], a[52:55], a[124:127], v[180:183]
L_pad0:
    s_cbranch_execz L_pad4
    s_nop 0
    buffer_load_dwordx4 v52, s[32:35], s71 offen offset:0 lds
    ds_read_b64_tr_b16 a[82:83], v28 offset:17408
    v_mfma_f32_16x16x32_bf16 v[184:187], a[56:59], a[124:127], v[184:187]
    s_add_u32 s11, s67, s66
    s_nop 0
    v_mfma_f32_16x16x32_bf16 v[188:191], a[60:63], a[124:127], v[188:191]
    s_add_u32 s71, s71, 128
    ds_read_b128 a[148:151], v32 offset:6144
    v_mfma_f32_16x16x32_bf16 v[192:195], a[32:35], a[128:131], v[192:195]
    ds_read_b64_tr_b16 a[84:85], v29 offset:16384
    s_and_b32 s11, s11, 3
    s_nop 0
    v_mfma_f32_16x16x32_bf16 v[196:199], a[36:39], a[128:131], v[196:199]
    ds_read_b64_tr_b16 a[86:87], v29 offset:17408
    v_mfma_f32_16x16x32_bf16 v[200:203], a[40:43], a[128:131], v[200:203]
    s_mul_i32 s11, s11, 320
    v_mfma_f32_16x16x32_bf16 v[204:207], a[44:47], a[128:131], v[204:207]
    ds_read_b64_tr_b16 a[88:89], v30 offset:16384
    v_mfma_f32_16x16x32_bf16 v[208:211], a[48:51], a[128:131], v[208:211]
    v_cndmask_b32 v8, v73, v72, vcc
    v_mfma_f32_16x16x32_bf16 v[212:215], a[52:55], a[128:131], v[212:215]
    ds_read_b128 a[152:155], v32 offset:8192
    v_mfma_f32_16x16x32_bf16 v[216:219], a[56:59], a[128:131], v[216:219]
    v_cndmask_b32 v9, v72, v73, vcc
    v_mfma_f32_16x16x32_bf16 v[220:223], a[60:63], a[128:131], v[220:223]
    ds_read_b64_tr_b16 a[90:91], v30 offset:17408
    v_mfma_f32_16x16x32_bf16 v[224:227], a[32:35], a[132:135], v[224:227]
    v_add_u32_e64 v69, s10, v64
    v_mfma_f32_16x16x32_bf16 v[228:231], a[36:39], a[132:135], v[228:231]
    ds_read_b64_tr_b16 a[92:93], v31 offset:16384
    v_mfma_f32_16x16x32_bf16 v[232:235], a[40:43], a[132:135], v[232:235]
    v_add_u32_e64 v69, 0, v69
    v_mfma_f32_16x16x32_bf16 v[236:239], a[44:47], a[132:135], v[236:239]
    ds_read_b64_tr_b16 a[94:95], v31 offset:17408
    v_mfma_f32_16x16x32_bf16 v[240:243], a[48:51], a[132:135], v[240:243]
    v_mfma_f32_16x16x32_bf16 v[244:247], a[52:55], a[132:135], v[244:247]
    v_mfma_f32_16x16x32_bf16 v[248:251], a[56:59], a[132:135], v[248:251]
    v_mfma_f32_16x16x32_bf16 v[252:255], a[60:63], a[132:135], v[252:255]
    s_waitcnt vmcnt(10) lgkmcnt(0)
    s_barrier
    v_mfma_f32_16x16x32_bf16 v[96:99], a[64:67], a[136:139], v[96:99]
    s_add_u32 m0, s73, 81920
    ds_read_b64_tr_b16 a[0:1], v24 offset:57344
    v_mul_u32_u24 v71, 3277, v69
    v_mfma_f32_16x16x32_bf16 v[100:103], a[68:71], a[136:139], v[100:103]
    buffer_load_dwordx4 v44, s[36:39], s70 offen offset:0 lds
    ds_read_b128 a[96:99], v33 offset:0
    v_mfma_f32_16x16x32_bf16 v[104:107], a[72:75], a[136:139], v[104:107]
    v_lshrrev_b32_e64 v71, 16, v71
    v_mfma_f32_16x16x32_bf16 v[108:111], a[76:79], a[136:139], v[108:111]
    buffer_load_dwordx4 v45, s[36:39], s70 offen offset:1024 lds
    ds_read_b64_tr_b16 a[2:3], v24 offset:58368
    ds_read_b64_tr_b16 a[4:5], v25 offset:57344
    v_mfma_f32_16x16x32_bf16 v[112:115], a[80:83], a[136:139], v[112:115]
    v_mul_u32_u24 v72, 20, v71
    s_nop 0
    v_mfma_f32_16x16x32_bf16 v[116:119], a[84:87], a[136:139], v[116:119]
    buffer_load_dwordx4 v46, s[36:39], s70 offen offset:2048 lds
    ds_read_b64_tr_b16 a[6:7], v25 offset:58368
    v_mfma_f32_16x16x32_bf16 v[120:123], a[88:91], a[136:139], v[120:123]
    v_sub_u32 v72, v69, v72
    s_nop 0
    ds_read_b128 a[100:103], v33 offset:2048
    v_mfma_f32_16x16x32_bf16 v[124:127], a[92:95], a[136:139], v[124:127]
    buffer_load_dwordx4 v47, s[36:39], s70 offen offset:3072 lds
    ds_read_b64_tr_b16 a[8:9], v26 offset:57344
    v_mfma_f32_16x16x32_bf16 v[128:131], a[64:67], a[140:143], v[128:131]
    s_add_u32 s70, s70, 0x40000
    v_bfe_u32 v73, v71, 2, 1
    v_mfma_f32_16x16x32_bf16 v[132:135], a[68:71], a[140:143], v[132:135]
    ds_read_b64_tr_b16 a[10:11], v26 offset:58368
    ds_read_b64_tr_b16 a[12:13], v27 offset:57344
    v_mfma_f32_16x16x32_bf16 v[136:139], a[72:75], a[140:143], v[136:139]
    s_add_u32 m0, s75, 128
    v_lshlrev_b32_e64 v73, 1, v73
    v_mfma_f32_16x16x32_bf16 v[140:143], a[76:79], a[140:143], v[140:143]
    ds_read_b128 a[104:107], v33 offset:4096
    v_mfma_f32_16x16x32_bf16 v[144:147], a[80:83], a[140:143], v[144:147]
    s_add_u32 s68, s72, 16512
    v_xor_b32_e64 v72, v72, v73
    v_mfma_f32_16x16x32_bf16 v[148:151], a[84:87], a[140:143], v[148:151]
    ds_read_b64_tr_b16 a[14:15], v27 offset:58368
    ds_read_b64_tr_b16 a[16:17], v28 offset:57344
    v_mfma_f32_16x16x32_bf16 v[152:155], a[88:91], a[140:143], v[152:155]
    buffer_load_dwordx4 v53, s[40:43], s68 offen offset:0 nt lds
    v_mul_u32_u24 v71, 1280, v71
    v_mfma_f32_16x16x32_bf16 v[156:159], a[92:95], a[140:143], v[156:159]
    buffer_load_dwordx4 v54, s[40:43], s68 offen offset:1024 nt lds
    ds_read_b64_tr_b16 a[18:19], v28 offset:58368
    v_mfma_f32_16x16x32_bf16 v[160:163], a[64:67], a[144:147], v[160:163]
    v_lshl_add_u32 v71, v72, 4, v71
    ds_read_b128 a[108:111], v33 offset:6144
    v_mfma_f32_16x16x32_bf16 v[164:167], a[68:71], a[144:147], v[164:167]
    buffer_load_dwordx4 v55, s[40:43], s68 offen offset:2048 nt lds
    ds_read_b64_tr_b16 a[20:21], v29 offset:57344
    v_mfma_f32_16x16x32_bf16 v[168:171], a[72:75], a[144:147], v[168:171]
    v_add_u32_e64 v71, s11, v71
    v_mfma_f32_16x16x32_bf16 v[172:175], a[76:79], a[144:147], v[172:175]
    buffer_load_dwordx4 v56, s[40:43], s68 offen offset:3072 nt lds
    ds_read_b64_tr_b16 a[22:23], v29 offset:58368
    ds_read_b64_tr_b16 a[24:25], v30 offset:57344
    v_mfma_f32_16x16x32_bf16 v[176:179], a[80:83], a[144:147], v[176:179]
    v_subrev_u32 v10, 0, v71
    v_mfma_f32_16x16x32_bf16 v[180:183], a[84:87], a[144:147], v[180:183]
    ds_read_b128 a[112:115], v33 offset:8192
    v_mfma_f32_16x16x32_bf16 v[184:187], a[88:91], a[144:147], v[184:187]
    v_add_u32_e32 v69, s10, v64
    ds_read_b64_tr_b16 a[26:27], v30 offset:58368
    v_mfma_f32_16x16x32_bf16 v[188:191], a[92:95], a[144:147], v[188:191]
    ds_read_b64_tr_b16 a[28:29], v31 offset:57344
    v_mfma_f32_16x16x32_bf16 v[192:195], a[64:67], a[148:151], v[192:195]
    v_add_u32_e64 v69, 64, v69
    v_mfma_f32_16x16x32_bf16 v[196:199], a[68:71], a[148:151], v[196:199]
    ds_read_b64_tr_b16 a[30:31], v31 offset:58368
    v_mfma_f32_16x16x32_bf16 v[200:203], a[72:75], a[148:151], v[200:203]
    v_mul_u32_u24 v71, 3277, v69
    ds_read_b64 a[204:205], v34 offset:12288
    v_mfma_f32_16x16x32_bf16 v[204:207], a[76:79], a[148:151], v[204:207]
    ds_read_b64 a[206:207], v35 offset:12288
    v_mfma_f32_16x16x32_bf16 v[208:211], a[80:83], a[148:151], v[208:211]
    v_lshrrev_b32_e64 v71, 16, v71
    v_mfma_f32_16x16x32_bf16 v[212:215], a[84:87], a[148:151], v[212:215]
    ds_read_b64 a[208:209], v36 offset:12288
    ds_read_b64 a[210:211], v37 offset:12288
    v_mfma_f32_16x16x32_bf16 v[216:219], a[88:91], a[148:151], v[216:219]
    v_mul_u32_u24 v72, 20, v71
    v_mfma_f32_16x16x32_bf16 v[220:223], a[92:95], a[148:151], v[220:223]
    ds_read_b64 a[212:213], v38 offset:12288
    v_mfma_f32_16x16x32_bf16 v[224:227], a[64:67], a[152:155], v[224:227]
    v_sub_u32 v72, v69, v72
    ds_read_b64 a[214:215], v39 offset:12288
    v_mfma_f32_16x16x32_bf16 v[228:231], a[68:71], a[152:155], v[228:231]
    ds_read_b64 a[216:217], v40 offset:12288
    v_mfma_f32_16x16x32_bf16 v[232:235], a[72:75], a[152:155], v[232:235]
    v_bfe_u32 v73, v71, 2, 1
    v_mfma_f32_16x16x32_bf16 v[236:239], a[76:79], a[152:155], v[236:239]
    ds_read_b64 a[218:219], v41 offset:12288
    v_mfma_f32_16x16x32_bf16 v[240:243], a[80:83], a[152:155], v[240:243]
    v_mfma_f32_16x16x32_bf16 v[244:247], a[84:87], a[152:155], v[244:247]
    v_mfma_f32_16x16x32_bf16 v[248:251], a[88:91], a[152:155], v[248:251]
    v_mfma_f32_16x16x32_bf16 v[252:255], a[92:95], a[152:155], v[252:255]
    s_waitcnt vmcnt(8) lgkmcnt(0)
    s_barrier
    v_mfma_f32_16x16x32_bf16 v[96:99], a[0:3], a[96:99], v[96:99]
    s_add_u32 m0, s73, 122880
    ds_read_b64_tr_b16 a[32:33], v24 offset:0
    v_lshlrev_b32_e64 v73, 1, v73
    v_mfma_f32_16x16x32_bf16 v[100:103], a[4:7], a[96:99], v[100:103]
    buffer_load_dwordx4 v44, s[36:39], s70 offen offset:0 lds
    ds_read_b128 a[116:119], v32 offset:40960
    v_mfma_f32_16x16x32_bf16 v[104:107], a[8:11], a[96:99], v[104:107]
    v_xor_b32_e64 v72, v72, v73
    v_mfma_f32_16x16x32_bf16 v[108:111], a[12:15], a[96:99], v[108:111]
    buffer_load_dwordx4 v45, s[36:39], s70 offen offset:1024 lds
    ds_read_b64_tr_b16 a[34:35], v24 offset:1024
    v_mfma_f32_16x16x32_bf16 v[112:115], a[16:19], a[96:99], v[112:115]
    v_mul_u32_u24 v71, 1280, v71
    v_mfma_f32_16x16x32_bf16 v[116:119], a[20:23], a[96:99], v[116:119]
    buffer_load_dwordx4 v46, s[36:39], s70 offen offset:2048 lds
    ds_read_b64_tr_b16 a[36:37], v25 offset:0
    v_mfma_f32_16x16x32_bf16 v[120:123], a[24:27], a[96:99], v[120:123]
    v_lshl_add_u32 v71, v72, 4, v71
    v_mfma_f32_16x16x32_bf16 v[124:127], a[28:31], a[96:99], v[124:127]
    buffer_load_dwordx4 v47, s[36:39], s70 offen offset:3072 lds
    ds_read_b64_tr_b16 a[38:39], v25 offset:1024
    v_mfma_f32_16x16x32_bf16 v[128:131], a[0:3], a[100:103], v[128:131]
    s_add_u32 s70, s70, 0x40000
    v_add_u32_e64 v71, s11, v71
    v_mfma_f32_16x16x32_bf16 v[132:135], a[4:7], a[100:103], v[132:135]
    ds_read_b128 a[120:123], v32 offset:43008
    v_mfma_f32_16x16x32_bf16 v[136:139], a[8:11], a[100:103], v[136:139]
    s_add_u32 m0, s88, 102528
    v_subrev_u32 v11, 1024, v71
    v_mfma_f32_16x16x32_bf16 v[140:143], a[12:15], a[100:103], v[140:143]
    ds_read_b64_tr_b16 a[40:41], v26 offset:0
    v_mfma_f32_16x16x32_bf16 v[144:147], a[16:19], a[100:103], v[144:147]
    buffer_load_dwordx4 v48, s[32:35], s71 offen offset:0 lds
    ds_read_b64_tr_b16 a[42:43], v26 offset:1024
    v_add_u32_e64 v69, s10, v64
    v_mfma_f32_16x16x32_bf16 v[148:151], a[20:23], a[100:103], v[148:151]
    ds_read_b64_tr_b16 a[44:45], v27 offset:0
    v_mfma_f32_16x16x32_bf16 v[152:155], a[24:27], a[100:103], v[152:155]
    buffer_load_dwordx4 v49, s[32:35], s71 offen offset:1024 lds
    v_add_u32 v69, 128, v69
    v_mfma_f32_16x16x32_bf16 v[156:159], a[28:31], a[100:103], v[156:159]
    ds_read_b128 a[124:127], v32 offset:45056
    v_mfma_f32_16x16x32_bf16 v[160:163], a[0:3], a[104:107], v[160:163]
    buffer_load_dwordx4 v50, s[32:35], s71 offen offset:2048 lds
    v_mul_u32_u24 v71, 3277, v69
    v_mfma_f32_16x16x32_bf16 v[164:167], a[4:7], a[104:107], v[164:167]
    buffer_load_dwordx4 v51, s[32:35], s71 offen offset:3072 lds
    ds_read_b64_tr_b16 a[46:47], v27 offset:1024
    v_mfma_f32_16x16x32_bf16 v[168:171], a[8:11], a[104:107], v[168:171]
    v_lshrrev_b32_e64 v71, 16, v71
    v_mfma_f32_16x16x32_bf16 v[172:175], a[12:15], a[104:107], v[172:175]
    s_add_u32 m0, s88, 106624
    ds_read_b64_tr_b16 a[48:49], v28 offset:0
    v_mfma_f32_16x16x32_bf16 v[176:179], a[16:19], a[104:107], v[176:179]
    v_mul_u32_u24 v72, 20, v71
    s_nop 0
    v_mfma_f32_16x16x32_bf16 v[180:183], a[20:23], a[104:107], v[180:183]
    buffer_load_dwordx4 v52, s[32:35], s71 offen offset:0 lds
    ds_read_b64_tr_b16 a[50:51], v28 offset:1024
    v_mfma_f32_16x16x32_bf16 v[184:187], a[24:27], a[104:107], v[184:187]
    v_sub_u32 v72, v69, v72
    s_nop 0
    v_mfma_f32_16x16x32_bf16 v[188:191], a[28:31], a[104:107], v[188:191]
    s_add_u32 s71, s71, 128
    ds_read_b128 a[128:131], v32 offset:47104
    v_mfma_f32_16x16x32_bf16 v[192:195], a[0:3], a[108:111], v[192:195]
    ds_read_b64_tr_b16 a[52:53], v29 offset:0
    v_bfe_u32 v73, v71, 2, 1
    v_mfma_f32_16x16x32_bf16 v[196:199], a[4:7], a[108:111], v[196:199]
    ds_read_b64_tr_b16 a[54:55], v29 offset:1024
    v_mfma_f32_16x16x32_bf16 v[200:203], a[8:11], a[108:111], v[200:203]
    v_lshlrev_b32_e64 v73, 1, v73
    v_mfma_f32_16x16x32_bf16 v[204:207], a[12:15], a[108:111], v[204:207]
    ds_read_b64_tr_b16 a[56:57], v30 offset:0
    v_mfma_f32_16x16x32_bf16 v[208:211], a[16:19], a[108:111], v[208:211]
    v_xor_b32_e64 v72, v72, v73
    v_mfma_f32_16x16x32_bf16 v[212:215], a[20:23], a[108:111], v[212:215]
    ds_read_b128 a[132:135], v32 offset:49152
    v_mfma_f32_16x16x32_bf16 v[216:219], a[24:27], a[108:111], v[216:219]
    v_mul_u32_u24 v71, 1280, v71
    v_mfma_f32_16x16x32_bf16 v[220:223], a[28:31], a[108:111], v[220:223]
    ds_read_b64_tr_b16 a[58:59], v30 offset:1024
    v_mfma_f32_16x16x32_bf16 v[224:227], a[0:3], a[112:115], v[224:227]
    v_lshl_add_u32 v71, v72, 4, v71
    v_mfma_f32_16x16x32_bf16 v[228:231], a[4:7], a[112:115], v[228:231]
    ds_read_b64_tr_b16 a[60:61], v31 offset:0
    v_mfma_f32_16x16x32_bf16 v[232:235], a[8:11], a[112:115], v[232:235]
    v_add_u32_e64 v71, s11, v71
    v_mfma_f32_16x16x32_bf16 v[236:239], a[12:15], a[112:115], v[236:239]
    ds_read_b64_tr_b16 a[62:63], v31 offset:1024
    v_mfma_f32_16x16x32_bf16 v[240:243], a[16:19], a[112:115], v[240:243]
    v_mfma_f32_16x16x32_bf16 v[244:247], a[20:23], a[112:115], v[244:247]
    v_mfma_f32_16x16x32_bf16 v[248:251], a[24:27], a[112:115], v[248:251]
    v_mfma_f32_16x16x32_bf16 v[252:255], a[28:31], a[112:115], v[252:255]
    s_waitcnt vmcnt(9) lgkmcnt(0)
    s_barrier
    v_mfma_f32_16x16x32_bf16 v[96:99], a[32:35], a[116:119], v[96:99]
    s_add_u32 m0, s73, 65536
    ds_read_b64_tr_b16 a[64:65], v24 offset:16384
    v_subrev_u32 v12, 2048, v71
    v_mfma_f32_16x16x32_bf16 v[100:103], a[36:39], a[116:119], v[100:103]
    ds_read_b128 a[136:139], v33 offset:40960
    v_mfma_f32_16x16x32_bf16 v[104:107], a[40:43], a[116:119], v[104:107]
    buffer_load_dwordx4 v44, s[36:39], s70 offen offset:0 lds
    v_add_u32_e64 v69, s10, v64
    v_mfma_f32_16x16x32_bf16 v[108:111], a[44:47], a[116:119], v[108:111]
    ds_read_b64_tr_b16 a[66:67], v24 offset:17408
    ds_read_b64_tr_b16 a[68:69], v25 offset:16384
    v_mfma_f32_16x16x32_bf16 v[112:115], a[48:51], a[116:119], v[112:115]
    v_add_u32 v69, 192, v69
    v_mfma_f32_16x16x32_bf16 v[116:119], a[52:55], a[116:119], v[116:119]
    buffer_load_dwordx4 v45, s[36:39], s70 offen offset:1024 lds
    ds_read_b64_tr_b16 a[70:71], v25 offset:17408
    v_mfma_f32_16x16x32_bf16 v[120:123], a[56:59], a[116:119], v[120:123]
    v_mul_u32_u24 v71, 3277, v69
    ds_read_b128 a[140:143], v33 offset:43008
    v_mfma_f32_16x16x32_bf16 v[124:127], a[60:63], a[116:119], v[124:127]
    buffer_load_dwordx4 v46, s[36:39], s70 offen offset:2048 lds
    ds_read_b64_tr_b16 a[72:73], v26 offset:16384
    v_mfma_f32_16x16x32_bf16 v[128:131], a[32:35], a[120:123], v[128:131]
    v_lshrrev_b32_e64 v71, 16, v71
    v_mfma_f32_16x16x32_bf16 v[132:135], a[36:39], a[120:123], v[132:135]
    ds_read_b64_tr_b16 a[74:75], v26 offset:17408
    ds_read_b64_tr_b16 a[76:77], v27 offset:16384
    v_mfma_f32_16x16x32_bf16 v[136:139], a[40:43], a[120:123], v[136:139]
    buffer_load_dwordx4 v47, s[36:39], s70 offen offset:3072 lds
    v_mul_u32_u24 v72, 20, v71
    s_nop 0
    v_mfma_f32_16x16x32_bf16 v[140:143], a[44:47], a[120:123], v[140:143]
    ds_read_b128 a[144:147], v33 offset:45056
    v_mfma_f32_16x16x32_bf16 v[144:147], a[48:51], a[120:123], v[144:147]
    s_add_u32 s70, s70, 0x40000
    v_sub_u32 v72, v69, v72
    s_nop 0
    v_mfma_f32_16x16x32_bf16 v[148:151], a[52:55], a[120:123], v[148:151]
    ds_read_b64_tr_b16 a[78:79], v27 offset:17408
    ds_read_b64_tr_b16 a[80:81], v28 offset:16384
    v_mfma_f32_16x16x32_bf16 v[152:155], a[56:59], a[120:123], v[152:155]
    v_bfe_u32 v73, v71, 2, 1
    v_mfma_f32_16x16x32_bf16 v[156:159], a[60:63], a[120:123], v[156:159]
    s_add_u32 m0, s75, 4224
    ds_read_b64_tr_b16 a[82:83], v28 offset:17408
    v_mfma_f32_16x16x32_bf16 v[160:163], a[32:35], a[124:127], v[160:163]
    v_lshlrev_b32_e64 v73, 1, v73
    ds_read_b128 a[148:151], v33 offset:47104
    v_mfma_f32_16x16x32_bf16 v[164:167], a[36:39], a[124:127], v[164:167]
    s_add_u32 s68, s72, 16512
    ds_read_b64_tr_b16 a[84:85], v29 offset:16384
    v_mfma_f32_16x16x32_bf16 v[168:171], a[40:43], a[124:127], v[168:171]
    v_xor_b32_e64 v72, v72, v73
    v_mfma_f32_16x16x32_bf16 v[172:175], a[44:47], a[124:127], v[172:175]
    ds_read_b64_tr_b16 a[86:87], v29 offset:17408
    ds_read_b64_tr_b16 a[88:89], v30 offset:16384
    v_mfma_f32_16x16x32_bf16 v[176:179], a[48:51], a[124:127], v[176:179]
    buffer_load_dwordx4 v57, s[44:47], s68 offen offset:0 nt lds
    v_mul_u32_u24 v71, 1280, v71
    v_mfma_f32_16x16x32_bf16 v[180:183], a[52:55], a[124:127], v[180:183]
    ds_read_b128 a[152:155], v33 offset:49152
    v_mfma_f32_16x16x32_bf16 v[184:187], a[56:59], a[124:127], v[184:187]
    buffer_load_dwordx4 v58, s[44:47], s68 offen offset:1024 nt lds
    v_lshl_add_u32 v71, v72, 4, v71
    ds_read_b64_tr_b16 a[90:91], v30 offset:17408
    v_mfma_f32_16x16x32_bf16 v[188:191], a[60:63], a[124:127], v[188:191]
    ds_read_b64_tr_b16 a[92:93], v31 offset:16384
    v_mfma_f32_16x16x32_bf16 v[192:195], a[32:35], a[128:131], v[192:195]
    v_add_u32_e64 v71, s11, v71
    v_mfma_f32_16x16x32_bf16 v[196:199], a[36:39], a[128:131], v[196:199]
    buffer_load_dwordx4 v57, s[44:47], s68 offen offset:2048 nt lds
    ds_read_b64_tr_b16 a[94:95], v31 offset:17408
    v_mfma_f32_16x16x32_bf16 v[200:203], a[40:43], a[128:131], v[200:203]
    v_subrev_u32 v13, 3072, v71
    ds_read_b64 a[220:221], v34 offset:0
    v_mfma_f32_16x16x32_bf16 v[204:207], a[44:47], a[128:131], v[204:207]
    buffer_load_dwordx4 v58, s[44:47], s68 offen offset:3072 nt lds
    ds_read_b64 a[222:223], v35 offset:0
    v_mfma_f32_16x16x32_bf16 v[208:211], a[48:51], a[128:131], v[208:211]
    v_add_u32_e64 v69, s10, v64
    v_mfma_f32_16x16x32_bf16 v[212:215], a[52:55], a[128:131], v[212:215]
    ds_read_b64 a[224:225], v36 offset:0
    ds_read_b64 a[226:227], v37 offset:0
    v_mfma_f32_16x16x32_bf16 v[216:219], a[56:59], a[128:131], v[216:219]
    v_add_u32 v69, 256, v69
    v_mfma_f32_16x16x32_bf16 v[220:223], a[60:63], a[128:131], v[220:223]
    ds_read_b64 a[228:229], v38 offset:0
    v_mfma_f32_16x16x32_bf16 v[224:227], a[32:35], a[132:135], v[224:227]
    v_mul_u32_u24 v71, 3277, v69
    ds_read_b64 a[230:231], v39 offset:0
    v_mfma_f32_16x16x32_bf16 v[228:231], a[36:39], a[132:135], v[228:231]
    ds_read_b64 a[232:233], v40 offset:0
    v_mfma_f32_16x16x32_bf16 v[232:235], a[40:43], a[132:135], v[232:235]
    v_lshrrev_b32_e64 v71, 16, v71
    v_mfma_f32_16x16x32_bf16 v[236:239], a[44:47], a[132:135], v[236:239]
    ds_read_b64 a[234:235], v41 offset:0
    v_mfma_f32_16x16x32_bf16 v[240:243], a[48:51], a[132:135], v[240:243]
    v_mfma_f32_16x16x32_bf16 v[244:247], a[52:55], a[132:135], v[244:247]
    v_mfma_f32_16x16x32_bf16 v[248:251], a[56:59], a[132:135], v[248:251]
    v_mfma_f32_16x16x32_bf16 v[252:255], a[60:63], a[132:135], v[252:255]
    s_waitcnt vmcnt(8) lgkmcnt(0)
    s_barrier
    v_mfma_f32_16x16x32_bf16 v[96:99], a[64:67], a[136:139], v[96:99]
    s_add_u32 m0, s73, 81920
    ds_read_b64_tr_b16 a[0:1], v24 offset:57344
    v_mul_u32_u24 v72, 20, v71
    s_nop 0
    v_mfma_f32_16x16x32_bf16 v[100:103], a[68:71], a[136:139], v[100:103]
    ds_read_b128 a[96:99], v32 offset:0
    v_mfma_f32_16x16x32_bf16 v[104:107], a[72:75], a[136:139], v[104:107]
    buffer_load_dwordx4 v44, s[36:39], s70 offen offset:0 lds
    v_sub_u32 v72, v69, v72
    s_nop 0
    v_mfma_f32_16x16x32_bf16 v[108:111], a[76:79], a[136:139], v[108:111]
    ds_read_b64_tr_b16 a[2:3], v24 offset:58368
    v_mfma_f32_16x16x32_bf16 v[112:115], a[80:83], a[136:139], v[112:115]
    v_bfe_u32 v73, v71, 2, 1
    v_mfma_f32_16x16x32_bf16 v[116:119], a[84:87], a[136:139], v[116:119]
    buffer_load_dwordx4 v45, s[36:39], s70 offen offset:1024 lds
    ds_read_b64_tr_b16 a[4:5], v25 offset:57344
    v_mfma_f32_16x16x32_bf16 v[120:123], a[88:91], a[136:139], v[120:123]
    v_lshlrev_b32_e64 v73, 1, v73
    v_mfma_f32_16x16x32_bf16 v[124:127], a[92:95], a[136:139], v[124:127]
    buffer_load_dwordx4 v46, s[36:39], s70 offen offset:2048 lds
    ds_read_b64_tr_b16 a[6:7], v25 offset:58368
    v_mfma_f32_16x16x32_bf16 v[128:131], a[64:67], a[140:143], v[128:131]
    v_xor_b32_e64 v72, v72, v73
    v_mfma_f32_16x16x32_bf16 v[132:135], a[68:71], a[140:143], v[132:135]
    ds_read_b128 a[100:103], v32 offset:2048
    v_mfma_f32_16x16x32_bf16 v[136:139], a[72:75], a[140:143], v[136:139]
    buffer_load_dwordx4 v47, s[36:39], s70 offen offset:3072 lds
    v_mul_u32_u24 v71, 1280, v71
    v_mfma_f32_16x16x32_bf16 v[140:143], a[76:79], a[140:143], v[140:143]
    ds_read_b64_tr_b16 a[8:9], v26 offset:57344
    v_mfma_f32_16x16x32_bf16 v[144:147], a[80:83], a[140:143], v[144:147]
    s_add_u32 s70, s70, 0x40000
    ds_read_b64_tr_b16 a[10:11], v26 offset:58368
    v_lshl_add_u32 v71, v72, 4, v71
    v_mfma_f32_16x16x32_bf16 v[148:151], a[84:87], a[140:143], v[148:151]
    ds_read_b64_tr_b16 a[12:13], v27 offset:57344
    v_mfma_f32_16x16x32_bf16 v[152:155], a[88:91], a[140:143], v[152:155]
    v_add_u32_e64 v71, s11, v71
    v_mfma_f32_16x16x32_bf16 v[156:159], a[92:95], a[140:143], v[156:159]
    s_add_u32 m0, s88, 143488
    ds_read_b128 a[104:107], v32 offset:4096
    v_mfma_f32_16x16x32_bf16 v[160:163], a[64:67], a[144:147], v[160:163]
    v_subrev_u32 v14, 0, v71
    s_nop 0
    v_mfma_f32_16x16x32_bf16 v[164:167], a[68:71], a[144:147], v[164:167]
    buffer_load_dwordx4 v48, s[32:35], s71 offen offset:0 lds
    ds_read_b64_tr_b16 a[14:15], v27 offset:58368
    v_mfma_f32_16x16x32_bf16 v[168:171], a[72:75], a[144:147], v[168:171]
    s_add_u32 s10, s65, 0
    s_nop 0
    v_mfma_f32_16x16x32_bf16 v[172:175], a[76:79], a[144:147], v[172:175]
    ds_read_b64_tr_b16 a[16:17], v28 offset:57344
    v_mfma_f32_16x16x32_bf16 v[176:179], a[80:83], a[144:147], v[176:179]
    buffer_load_dwordx4 v49, s[32:35], s71 offen offset:1024 lds
    s_and_b32 s10, s10, 3
    s_nop 0
    v_mfma_f32_16x16x32_bf16 v[180:183], a[84:87], a[144:147], v[180:183]
    ds_read_b64_tr_b16 a[18:19], v28 offset:58368
    v_mfma_f32_16x16x32_bf16 v[184:187], a[88:91], a[144:147], v[184:187]
    buffer_load_dwordx4 v50, s[32:35], s71 offen offset:2048 lds
    s_lshl_b32 s10, s10, 10
    s_nop 0
    v_mfma_f32_16x16x32_bf16 v[188:191], a[92:95], a[144:147], v[188:191]
    ds_read_b128 a[108:111], v32 offset:6144
    v_mfma_f32_16x16x32_bf16 v[192:195], a[64:67], a[148:151], v[192:195]
    ds_read_b64_tr_b16 a[20:21], v29 offset:57344
    v_add_u32_e64 v5, s10, v7
    v_mfma_f32_16x16x32_bf16 v[196:199], a[68:71], a[148:151], v[196:199]
    buffer_load_dwordx4 v51, s[32:35], s71 offen offset:3072 lds
    ds_read_b64_tr_b16 a[22:23], v29 offset:58368
    v_mfma_f32_16x16x32_bf16 v[200:203], a[72:75], a[148:151], v[200:203]
    s_add_u32 s10, s65, 1
    s_nop 0
    v_mfma_f32_16x16x32_bf16 v[204:207], a[76:79], a[148:151], v[204:207]
    s_add_u32 m0, s88, 147584
    ds_read_b64_tr_b16 a[24:25], v30 offset:57344
    v_mfma_f32_16x16x32_bf16 v[208:211], a[80:83], a[148:151], v[208:211]
    s_and_b32 s10, s10, 3
    s_nop 0
    v_mfma_f32_16x16x32_bf16 v[212:215], a[84:87], a[148:151], v[212:215]
    ds_read_b128 a[112:115], v32 offset:8192
    v_mfma_f32_16x16x32_bf16 v[216:219], a[88:91], a[148:151], v[216:219]
    buffer_load_dwordx4 v52, s[32:35], s71 offen offset:0 lds
    s_lshl_b32 s10, s10, 10
    s_nop 0
    v_mfma_f32_16x16x32_bf16 v[220:223], a[92:95], a[148:151], v[220:223]
    ds_read_b64_tr_b16 a[26:27], v30 offset:58368
    v_mfma_f32_16x16x32_bf16 v[224:227], a[64:67], a[152:155], v[224:227]
    s_add_u32 s71, s71, 128
    v_add_u32_e64 v15, s10, v7
    v_mfma_f32_16x16x32_bf16 v[228:231], a[68:71], a[152:155], v[228:231]
    ds_read_b64_tr_b16 a[28:29], v31 offset:57344
    v_mfma_f32_16x16x32_bf16 v[232:235], a[72:75], a[152:155], v[232:235]
    s_add_u32 s10, s65, 2
    s_nop 0
    v_mfma_f32_16x16x32_bf16 v[236:239], a[76:79], a[152:155], v[236:239]
    ds_read_b64_tr_b16 a[30:31], v31 offset:58368
    v_mfma_f32_16x16x32_bf16 v[240:243], a[80:83], a[152:155], v[240:243]
    v_mfma_f32_16x16x32_bf16 v[244:247], a[84:87], a[152:155], v[244:247]
    v_mfma_f32_16x16x32_bf16 v[248:251], a[88:91], a[152:155], v[248:251]
    v_mfma_f32_16x16x32_bf16 v[252:255], a[92:95], a[152:155], v[252:255]
    s_waitcnt vmcnt(9) lgkmcnt(0)
    s_barrier
    v_mfma_f32_16x16x32_bf16 v[96:99], a[0:3], a[96:99], v[96:99]
    s_add_u32 m0, s73, 122880
    ds_read_b64_tr_b16 a[32:33], v24 offset:0
    s_and_b32 s10, s10, 3
    s_nop 0
    v_mfma_f32_16x16x32_bf16 v[100:103], a[4:7], a[96:99], v[100:103]
    ds_read_b128 a[116:119], v33 offset:0
    v_mfma_f32_16x16x32_bf16 v[104:107], a[8:11], a[96:99], v[104:107]
    buffer_load_dwordx4 v44, s[36:39], s70 offen offset:0 lds
    s_lshl_b32 s10, s10, 10
    s_nop 0
    v_mfma_f32_16x16x32_bf16 v[108:111], a[12:15], a[96:99], v[108:111]
    ds_read_b64_tr_b16 a[34:35], v24 offset:1024
    ds_read_b64_tr_b16 a[36:37], v25 offset:0
    v_mfma_f32_16x16x32_bf16 v[112:115], a[16:19], a[96:99], v[112:115]
    v_add_u32_e64 v92, s10, v7
    v_mfma_f32_16x16x32_bf16 v[116:119], a[20:23], a[96:99], v[116:119]
    buffer_load_dwordx4 v45, s[36:39], s70 offen offset:1024 lds
    ds_read_b64_tr_b16 a[38:39], v25 offset:1024
    v_mfma_f32_16x16x32_bf16 v[120:123], a[24:27], a[96:99], v[120:123]
    s_add_u32 s10, s65, 3
    s_nop 0
    ds_read_b128 a[120:123], v33 offset:2048
    v_mfma_f32_16x16x32_bf16 v[124:127], a[28:31], a[96:99], v[124:127]
    buffer_load_dwordx4 v46, s[36:39], s70 offen offset:2048 lds
    ds_read_b64_tr_b16 a[40:41], v26 offset:0
    v_mfma_f32_16x16x32_bf16 v[128:131], a[0:3], a[100:103], v[128:131]
    s_and_b32 s10, s10, 3
    s_nop 0
    v_mfma_f32_16x16x32_bf16 v[132:135], a[4:7], a[100:103], v[132:135]
    ds_read_b64_tr_b16 a[42:43], v26 offset:1024
    ds_read_b64_tr_b16 a[44:45], v27 offset:0
    v_mfma_f32_16x16x32_bf16 v[136:139], a[8:11], a[100:103], v[136:139]
    buffer_load_dwordx4 v47, s[36:39], s70 offen offset:3072 lds
    s_lshl_b32 s10, s10, 10
    s_nop 0
    v_mfma_f32_16x16x32_bf16 v[140:143], a[12:15], a[100:103], v[140:143]
    ds_read_b128 a[124:127], v33 offset:4096
    v_mfma_f32_16x16x32_bf16 v[144:147], a[16:19], a[100:103], v[144:147]
    s_add_u32 s70, s70, 0x40000
    v_add_u32_e64 v93, s10, v7
    v_mfma_f32_16x16x32_bf16 v[148:151], a[20:23], a[100:103], v[148:151]
    ds_read_b64_tr_b16 a[46:47], v27 offset:1024
    ds_read_b64_tr_b16 a[48:49], v28 offset:0
    v_mfma_f32_16x16x32_bf16 v[152:155], a[24:27], a[100:103], v[152:155]
    s_lshl_b32 s10, s64, 5
    s_nop 0
    v_mfma_f32_16x16x32_bf16 v[156:159], a[28:31], a[100:103], v[156:159]
    s_add_u32 m0, s75, 8320
    ds_read_b64_tr_b16 a[50:51], v28 offset:1024
    v_mfma_f32_16x16x32_bf16 v[160:163], a[0:3], a[104:107], v[160:163]
    s_lshl_b32 s11, s66, 2
    s_nop 0
    ds_read_b128 a[128:131], v33 offset:6144
    v_mfma_f32_16x16x32_bf16 v[164:167], a[4:7], a[104:107], v[164:167]
    s_add_u32 s68, s72, 128
    ds_read_b64_tr_b16 a[52:53], v29 offset:0
    v_mfma_f32_16x16x32_bf16 v[168:171], a[8:11], a[104:107], v[168:171]
    s_add_u32 s11, s11, s67
    s_nop 0
    v_mfma_f32_16x16x32_bf16 v[172:175], a[12:15], a[104:107], v[172:175]
    ds_read_b64_tr_b16 a[54:55], v29 offset:1024
    ds_read_b64_tr_b16 a[56:57], v30 offset:0
    v_mfma_f32_16x16x32_bf16 v[176:179], a[16:19], a[104:107], v[176:179]
    buffer_load_dwordx4 v57, s[44:47], s68 offen offset:0 nt lds
    s_add_u32 s10, s10, s11
    s_nop 0
    v_mfma_f32_16x16x32_bf16 v[180:183], a[20:23], a[104:107], v[180:183]
    ds_read_b128 a[132:135], v33 offset:8192
    v_mfma_f32_16x16x32_bf16 v[184:187], a[24:27], a[104:107], v[184:187]
    buffer_load_dwordx4 v58, s[44:47], s68 offen offset:1024 nt lds
    s_lshl_b32 s10, s10, 2
    s_nop 0
    ds_read_b64_tr_b16 a[58:59], v30 offset:1024
    v_mfma_f32_16x16x32_bf16 v[188:191], a[28:31], a[104:107], v[188:191]
    ds_read_b64_tr_b16 a[60:61], v31 offset:0
    v_mfma_f32_16x16x32_bf16 v[192:195], a[0:3], a[108:111], v[192:195]
    s_add_u32 s10, s10, s3
    s_nop 0
    v_mfma_f32_16x16x32_bf16 v[196:199], a[4:7], a[108:111], v[196:199]
    buffer_load_dwordx4 v57, s[44:47], s68 offen offset:2048 nt lds
    ds_read_b64_tr_b16 a[62:63], v31 offset:1024
    v_mfma_f32_16x16x32_bf16 v[200:203], a[8:11], a[108:111], v[200:203]
    s_lshl_b32 s10, s10, 16
    s_nop 0
    ds_read_b64_tr_b16 a[236:237], v16 offset:4096
    v_mfma_f32_16x16x32_bf16 v[204:207], a[12:15], a[108:111], v[204:207]
    buffer_load_dwordx4 v58, s[44:47], s68 offen offset:3072 nt lds
    ds_read_b64_tr_b16 a[238:239], v17 offset:4096
    v_mfma_f32_16x16x32_bf16 v[208:211], a[16:19], a[108:111], v[208:211]
    s_lshl_b32 s0, s65, 12
    s_nop 0
    v_mfma_f32_16x16x32_bf16 v[212:215], a[20:23], a[108:111], v[212:215]
    ds_read_b64_tr_b16 a[240:241], v18 offset:4096
    ds_read_b64_tr_b16 a[242:243], v19 offset:4096
    v_mfma_f32_16x16x32_bf16 v[216:219], a[24:27], a[108:111], v[216:219]
    s_add_u32 s10, s10, 33554432
    v_mfma_f32_16x16x32_bf16 v[220:223], a[28:31], a[108:111], v[220:223]
    ds_read_b64_tr_b16 a[244:245], v20 offset:4096
    v_mfma_f32_16x16x32_bf16 v[224:227], a[0:3], a[112:115], v[224:227]
    s_add_u32 s0, s0, s10
    s_nop 0
    ds_read_b64_tr_b16 a[246:247], v21 offset:4096
L_pad1:
    s_cbranch_execz L_pad5
    s_nop 0
    v_mfma_f32_16x16x32_bf16 v[228:231], a[4:7], a[112:115], v[228:231]
    ds_read_b64_tr_b16 a[248:249], v22 offset:4096
    v_mfma_f32_16x16x32_bf16 v[232:235], a[8:11], a[112:115], v[232:235]
    s_lshl_b32 s1, s65, 14
    s_nop 0
    v_mfma_f32_16x16x32_bf16 v[236:239], a[12:15], a[112:115], v[236:239]
    ds_read_b64_tr_b16 a[250:251], v23 offset:4096
    v_mfma_f32_16x16x32_bf16 v[240:243], a[16:19], a[112:115], v[240:243]
    v_mfma_f32_16x16x32_bf16 v[244:247], a[20:23], a[112:115], v[244:247]
    v_mfma_f32_16x16x32_bf16 v[248:251], a[24:27], a[112:115], v[248:251]
    v_mfma_f32_16x16x32_bf16 v[252:255], a[28:31], a[112:115], v[252:255]
    s_waitcnt vmcnt(8) lgkmcnt(0)
    s_barrier
    v_mfma_f32_16x16x32_bf16 v[96:99], a[32:35], a[116:119], v[96:99]
    s_add_u32 m0, s73, 65536
    ds_read_b64_tr_b16 a[64:65], v24 offset:16384
    s_add_u32 s1, s1, s10
    s_nop 0
    v_mfma_f32_16x16x32_bf16 v[100:103], a[36:39], a[116:119], v[100:103]
    ds_read_b128 a[136:139], v32 offset:40960
    v_mfma_f32_16x16x32_bf16 v[104:107], a[40:43], a[116:119], v[104:107]
    buffer_load_dwordx4 v44, s[36:39], s70 offen offset:0 lds
    s_lshl_b32 s5, s64, 7
    v_mfma_f32_16x16x32_bf16 v[108:111], a[44:47], a[116:119], v[108:111]
    ds_read_b64_tr_b16 a[66:67], v24 offset:17408
    v_mfma_f32_16x16x32_bf16 v[112:115], a[48:51], a[116:119], v[112:115]
    s_add_u32 s5, s5, s11
    v_mfma_f32_16x16x32_bf16 v[116:119], a[52:55], a[116:119], v[116:119]
    buffer_load_dwordx4 v45, s[36:39], s70 offen offset:1024 lds
    ds_read_b64_tr_b16 a[68:69], v25 offset:16384
    v_mfma_f32_16x16x32_bf16 v[120:123], a[56:59], a[116:119], v[120:123]
    s_lshl_b32 s5, s5, 2
    s_nop 0
    v_mfma_f32_16x16x32_bf16 v[124:127], a[60:63], a[116:119], v[124:127]
    buffer_load_dwordx4 v46, s[36:39], s70 offen offset:2048 lds
    ds_read_b64_tr_b16 a[70:71], v25 offset:17408
    v_mfma_f32_16x16x32_bf16 v[128:131], a[32:35], a[120:123], v[128:131]
    s_add_u32 s5, s5, s3
    s_nop 0
    v_mfma_f32_16x16x32_bf16 v[132:135], a[36:39], a[120:123], v[132:135]
    ds_read_b128 a[140:143], v32 offset:43008
    v_mfma_f32_16x16x32_bf16 v[136:139], a[40:43], a[120:123], v[136:139]
    buffer_load_dwordx4 v47, s[36:39], s70 offen offset:3072 lds
    s_lshl_b32 s5, s5, 6
    s_nop 0
    v_mfma_f32_16x16x32_bf16 v[140:143], a[44:47], a[120:123], v[140:143]
    ds_read_b64_tr_b16 a[72:73], v26 offset:16384
    v_mfma_f32_16x16x32_bf16 v[144:147], a[48:51], a[120:123], v[144:147]
    s_add_u32 s70, s70, 0x40000
    ds_read_b64_tr_b16 a[74:75], v26 offset:17408
    s_add_u32 s5, s5, 25165824
    v_mfma_f32_16x16x32_bf16 v[148:151], a[52:55], a[120:123], v[148:151]
    ds_read_b64_tr_b16 a[76:77], v27 offset:16384
    v_mfma_f32_16x16x32_bf16 v[152:155], a[56:59], a[120:123], v[152:155]
    s_lshl_b32 s7, s66, 1
    s_nop 0
    v_mfma_f32_16x16x32_bf16 v[156:159], a[60:63], a[120:123], v[156:159]
    s_add_u32 m0, s88, 102528
    ds_read_b128 a[144:147], v32 offset:45056
    v_mfma_f32_16x16x32_bf16 v[160:163], a[32:35], a[124:127], v[160:163]
    s_add_u32 s7, s7, s69
    s_nop 0
    v_mfma_f32_16x16x32_bf16 v[164:167], a[36:39], a[124:127], v[164:167]
    buffer_load_dwordx4 v48, s[32:35], s71 offen offset:0 lds
    ds_read_b64_tr_b16 a[78:79], v27 offset:17408
    v_mfma_f32_16x16x32_bf16 v[168:171], a[40:43], a[124:127], v[168:171]
    s_mul_i32 s7, s7, 204800
    v_mfma_f32_16x16x32_bf16 v[172:175], a[44:47], a[124:127], v[172:175]
    ds_read_b64_tr_b16 a[80:81], v28 offset:16384
    v_mfma_f32_16x16x32_bf16 v[176:179], a[48:51], a[124:127], v[176:179]
    buffer_load_dwordx4 v49, s[32:35], s71 offen offset:1024 lds
    s_mul_i32 s8, s64, 1280
    v_mfma_f32_16x16x32_bf16 v[180:183], a[52:55], a[124:127], v[180:183]
    ds_read_b64_tr_b16 a[82:83], v28 offset:17408
    v_mfma_f32_16x16x32_bf16 v[184:187], a[56:59], a[124:127], v[184:187]
    buffer_load_dwordx4 v50, s[32:35], s71 offen offset:2048 lds
    s_add_u32 s11, s67, s66
    s_nop 0
    v_mfma_f32_16x16x32_bf16 v[188:191], a[60:63], a[124:127], v[188:191]
    ds_read_b128 a[148:151], v32 offset:47104
    v_mfma_f32_16x16x32_bf16 v[192:195], a[32:35], a[128:131], v[192:195]
    ds_read_b64_tr_b16 a[84:85], v29 offset:16384
    s_and_b32 s11, s11, 3
    s_nop 0
    v_mfma_f32_16x16x32_bf16 v[196:199], a[36:39], a[128:131], v[196:199]
    buffer_load_dwordx4 v51, s[32:35], s71 offen offset:3072 lds
    ds_read_b64_tr_b16 a[86:87], v29 offset:17408
    v_mfma_f32_16x16x32_bf16 v[200:203], a[40:43], a[128:131], v[200:203]
    s_mul_i32 s11, s11, 320
    v_mfma_f32_16x16x32_bf16 v[204:207], a[44:47], a[128:131], v[204:207]
    s_add_u32 m0, s88, 106624
    ds_read_b64_tr_b16 a[88:89], v30 offset:16384
    v_mfma_f32_16x16x32_bf16 v[208:211], a[48:51], a[128:131], v[208:211]
    s_add_u32 s7, s7, s8
    s_nop 0
    v_mfma_f32_16x16x32_bf16 v[212:215], a[52:55], a[128:131], v[212:215]
    ds_read_b128 a[152:155], v32 offset:49152
    v_mfma_f32_16x16x32_bf16 v[216:219], a[56:59], a[128:131], v[216:219]
    buffer_load_dwordx4 v52, s[32:35], s71 offen offset:0 lds
    s_add_u32 s7, s7, s11
    s_nop 0
    v_mfma_f32_16x16x32_bf16 v[220:223], a[60:63], a[128:131], v[220:223]
    ds_read_b64_tr_b16 a[90:91], v30 offset:17408
    v_mfma_f32_16x16x32_bf16 v[224:227], a[32:35], a[132:135], v[224:227]
    s_add_u32 s71, s71, 128
    s_mul_i32 s8, s82, 160
    v_mfma_f32_16x16x32_bf16 v[228:231], a[36:39], a[132:135], v[228:231]
    ds_read_b64_tr_b16 a[92:93], v31 offset:16384
    v_mfma_f32_16x16x32_bf16 v[232:235], a[40:43], a[132:135], v[232:235]
    s_mul_i32 s6, s65, 40960
    v_mfma_f32_16x16x32_bf16 v[236:239], a[44:47], a[132:135], v[236:239]
    ds_read_b64_tr_b16 a[94:95], v31 offset:17408
    v_mfma_f32_16x16x32_bf16 v[240:243], a[48:51], a[132:135], v[240:243]
    v_mfma_f32_16x16x32_bf16 v[244:247], a[52:55], a[132:135], v[244:247]
    v_mfma_f32_16x16x32_bf16 v[248:251], a[56:59], a[132:135], v[248:251]
    v_mfma_f32_16x16x32_bf16 v[252:255], a[60:63], a[132:135], v[252:255]
    s_waitcnt vmcnt(13) lgkmcnt(0)
    s_barrier
    v_mfma_f32_16x16x32_bf16 v[96:99], a[64:67], a[136:139], v[96:99]
    s_add_u32 m0, s73, 81920
    ds_read_b64_tr_b16 a[0:1], v24 offset:57344
    v_mfma_f32_16x16x32_bf16 v[100:103], a[68:71], a[136:139], v[100:103]
    s_add_u32 s7, s7, s8
    s_nop 0
    v_mfma_f32_16x16x32_bf16 v[104:107], a[72:75], a[136:139], v[104:107]
    buffer_load_dwordx4 v44, s[36:39], s70 offen offset:0 lds
    ds_read_b128 a[96:99], v33 offset:40960
    v_mfma_f32_16x16x32_bf16 v[108:111], a[76:79], a[136:139], v[108:111]
    v_mfma_f32_16x16x32_bf16 v[112:115], a[80:83], a[136:139], v[112:115]
    ds_read_b64_tr_b16 a[2:3], v24 offset:58368
    v_mfma_f32_16x16x32_bf16 v[116:119], a[84:87], a[136:139], v[116:119]
    buffer_load_dwordx4 v45, s[36:39], s70 offen offset:1024 lds
    ds_read_b64_tr_b16 a[4:5], v25 offset:57344
    v_mfma_f32_16x16x32_bf16 v[120:123], a[88:91], a[136:139], v[120:123]
    ds_read_b64_tr_b16 a[6:7], v25 offset:58368
    v_mfma_f32_16x16x32_bf16 v[124:127], a[92:95], a[136:139], v[124:127]
    buffer_load_dwordx4 v46, s[36:39], s70 offen offset:2048 lds
    v_mfma_f32_16x16x32_bf16 v[128:131], a[64:67], a[140:143], v[128:131]
    s_add_u32 s6, s6, s7
    s_nop 0
    v_mfma_f32_16x16x32_bf16 v[132:135], a[68:71], a[140:143], v[132:135]
    ds_read_b128 a[100:103], v33 offset:43008
    v_mfma_f32_16x16x32_bf16 v[136:139], a[72:75], a[140:143], v[136:139]
    buffer_load_dwordx4 v47, s[36:39], s70 offen offset:3072 lds
    v_mfma_f32_16x16x32_bf16 v[140:143], a[76:79], a[140:143], v[140:143]
    ds_read_b64_tr_b16 a[8:9], v26 offset:57344
    v_mfma_f32_16x16x32_bf16 v[144:147], a[80:83], a[140:143], v[144:147]
    s_add_u32 s70, s70, 0x40000
    ds_read_b64_tr_b16 a[10:11], v26 offset:58368
    v_mfma_f32_16x16x32_bf16 v[148:151], a[84:87], a[140:143], v[148:151]
    ds_read_b64_tr_b16 a[12:13], v27 offset:57344
    v_mfma_f32_16x16x32_bf16 v[152:155], a[88:91], a[140:143], v[152:155]
    v_mfma_f32_16x16x32_bf16 v[156:159], a[92:95], a[140:143], v[156:159]
    s_add_u32 m0, s75, 12416
    s_mul_i32 s8, s65, 10240
    v_mfma_f32_16x16x32_bf16 v[160:163], a[64:67], a[144:147], v[160:163]
    ds_read_b128 a[104:107], v33 offset:45056
    v_mfma_f32_16x16x32_bf16 v[164:167], a[68:71], a[144:147], v[164:167]
    s_add_u32 s68, s72, 4224
    v_mfma_f32_16x16x32_bf16 v[168:171], a[72:75], a[144:147], v[168:171]
    ds_read_b64_tr_b16 a[14:15], v27 offset:58368
    v_mfma_f32_16x16x32_bf16 v[172:175], a[76:79], a[144:147], v[172:175]
    ds_read_b64_tr_b16 a[16:17], v28 offset:57344
    v_mfma_f32_16x16x32_bf16 v[176:179], a[80:83], a[144:147], v[176:179]
    buffer_load_dwordx4 v57, s[44:47], s68 offen offset:0 nt lds
    ds_read_b64_tr_b16 a[18:19], v28 offset:58368
    v_mfma_f32_16x16x32_bf16 v[180:183], a[84:87], a[144:147], v[180:183]
    v_mfma_f32_16x16x32_bf16 v[184:187], a[88:91], a[144:147], v[184:187]
    buffer_load_dwordx4 v58, s[44:47], s68 offen offset:1024 nt lds
    s_add_u32 s7, s7, 163840
    v_mfma_f32_16x16x32_bf16 v[188:191], a[92:95], a[144:147], v[188:191]
    ds_read_b128 a[108:111], v33 offset:47104
    v_mfma_f32_16x16x32_bf16 v[192:195], a[64:67], a[148:151], v[192:195]
    ds_read_b64_tr_b16 a[20:21], v29 offset:57344
    v_mfma_f32_16x16x32_bf16 v[196:199], a[68:71], a[148:151], v[196:199]
    buffer_load_dwordx4 v57, s[44:47], s68 offen offset:2048 nt lds
    v_mfma_f32_16x16x32_bf16 v[200:203], a[72:75], a[148:151], v[200:203]
    ds_read_b64_tr_b16 a[22:23], v29 offset:58368
    v_mfma_f32_16x16x32_bf16 v[204:207], a[76:79], a[148:151], v[204:207]
    buffer_load_dwordx4 v58, s[44:47], s68 offen offset:3072 nt lds
    ds_read_b64_tr_b16 a[24:25], v30 offset:57344
    v_mfma_f32_16x16x32_bf16 v[208:211], a[80:83], a[148:151], v[208:211]
    v_mfma_f32_16x16x32_bf16 v[212:215], a[84:87], a[148:151], v[212:215]
    s_add_u32 s7, s7, s8
    s_nop 0
    v_mfma_f32_16x16x32_bf16 v[216:219], a[88:91], a[148:151], v[216:219]
    ds_read_b128 a[112:115], v33 offset:49152
    v_mfma_f32_16x16x32_bf16 v[220:223], a[92:95], a[148:151], v[220:223]
    ds_read_b64_tr_b16 a[26:27], v30 offset:58368
    v_mfma_f32_16x16x32_bf16 v[224:227], a[64:67], a[152:155], v[224:227]
    v_mfma_f32_16x16x32_bf16 v[228:231], a[68:71], a[152:155], v[228:231]
    ds_read_b64_tr_b16 a[28:29], v31 offset:57344
    v_mfma_f32_16x16x32_bf16 v[232:235], a[72:75], a[152:155], v[232:235]
    ds_read_b64_tr_b16 a[30:31], v31 offset:58368
    v_mfma_f32_16x16x32_bf16 v[236:239], a[76:79], a[152:155], v[236:239]
    v_mfma_f32_16x16x32_bf16 v[240:243], a[80:83], a[152:155], v[240:243]
    v_mfma_f32_16x16x32_bf16 v[244:247], a[84:87], a[152:155], v[244:247]
    v_mfma_f32_16x16x32_bf16 v[248:251], a[88:91], a[152:155], v[248:251]
    v_mfma_f32_16x16x32_bf16 v[252:255], a[92:95], a[152:155], v[252:255]
    s_waitcnt vmcnt(8) lgkmcnt(0)
    s_barrier
    v_mfma_f32_16x16x32_bf16 v[96:99], a[0:3], a[96:99], v[96:99]
    s_add_u32 m0, s73, 122880
    ds_read_b64_tr_b16 a[32:33], v24 offset:0
    v_mfma_f32_16x16x32_bf16 v[100:103], a[4:7], a[96:99], v[100:103]
    ds_read_b128 a[116:119], v32 offset:0
    v_mfma_f32_16x16x32_bf16 v[104:107], a[8:11], a[96:99], v[104:107]
    buffer_load_dwordx4 v44, s[36:39], s70 offen offset:0 lds
    v_mfma_f32_16x16x32_bf16 v[108:111], a[12:15], a[96:99], v[108:111]
    ds_read_b64_tr_b16 a[34:35], v24 offset:1024
    v_mfma_f32_16x16x32_bf16 v[112:115], a[16:19], a[96:99], v[112:115]
    v_mfma_f32_16x16x32_bf16 v[116:119], a[20:23], a[96:99], v[116:119]
    buffer_load_dwordx4 v45, s[36:39], s70 offen offset:1024 lds
    ds_read_b64_tr_b16 a[36:37], v25 offset:0
    v_mfma_f32_16x16x32_bf16 v[120:123], a[24:27], a[96:99], v[120:123]
    ds_read_b64_tr_b16 a[38:39], v25 offset:1024
    v_mfma_f32_16x16x32_bf16 v[124:127], a[28:31], a[96:99], v[124:127]
    buffer_load_dwordx4 v46, s[36:39], s70 offen offset:2048 lds
    v_mfma_f32_16x16x32_bf16 v[128:131], a[0:3], a[100:103], v[128:131]
    ds_read_b128 a[120:123], v32 offset:2048
    v_mfma_f32_16x16x32_bf16 v[132:135], a[4:7], a[100:103], v[132:135]
    v_mfma_f32_16x16x32_bf16 v[136:139], a[8:11], a[100:103], v[136:139]
    buffer_load_dwordx4 v47, s[36:39], s70 offen offset:3072 lds
    ds_read_b64_tr_b16 a[40:41], v26 offset:0
    v_mfma_f32_16x16x32_bf16 v[140:143], a[12:15], a[100:103], v[140:143]
    v_mfma_f32_16x16x32_bf16 v[144:147], a[16:19], a[100:103], v[144:147]
    s_add_u32 s70, s70, 0x40000
    ds_read_b64_tr_b16 a[42:43], v26 offset:1024
    v_mfma_f32_16x16x32_bf16 v[148:151], a[20:23], a[100:103], v[148:151]
    ds_read_b64_tr_b16 a[44:45], v27 offset:0
    v_mfma_f32_16x16x32_bf16 v[152:155], a[24:27], a[100:103], v[152:155]
    v_mfma_f32_16x16x32_bf16 v[156:159], a[28:31], a[100:103], v[156:159]
    s_add_u32 m0, s88, 143488
    ds_read_b128 a[124:127], v32 offset:4096
    v_mfma_f32_16x16x32_bf16 v[160:163], a[0:3], a[104:107], v[160:163]
    v_mfma_f32_16x16x32_bf16 v[164:167], a[4:7], a[104:107], v[164:167]
    buffer_load_dwordx4 v48, s[32:35], s71 offen offset:0 lds
    ds_read_b64_tr_b16 a[46:47], v27 offset:1024
    v_mfma_f32_16x16x32_bf16 v[168:171], a[8:11], a[104:107], v[168:171]
    ds_read_b64_tr_b16 a[48:49], v28 offset:0
    v_mfma_f32_16x16x32_bf16 v[172:175], a[12:15], a[104:107], v[172:175]
    v_mfma_f32_16x16x32_bf16 v[176:179], a[16:19], a[104:107], v[176:179]
    buffer_load_dwordx4 v49, s[32:35], s71 offen offset:1024 lds
    ds_read_b64_tr_b16 a[50:51], v28 offset:1024
    v_mfma_f32_16x16x32_bf16 v[180:183], a[20:23], a[104:107], v[180:183]
    v_mfma_f32_16x16x32_bf16 v[184:187], a[24:27], a[104:107], v[184:187]
    buffer_load_dwordx4 v50, s[32:35], s71 offen offset:2048 lds
    ds_read_b128 a[128:131], v32 offset:6144
    v_mfma_f32_16x16x32_bf16 v[188:191], a[28:31], a[104:107], v[188:191]
    v_mfma_f32_16x16x32_bf16 v[192:195], a[0:3], a[108:111], v[192:195]
    ds_read_b64_tr_b16 a[52:53], v29 offset:0
    v_mfma_f32_16x16x32_bf16 v[196:199], a[4:7], a[108:111], v[196:199]
    buffer_load_dwordx4 v51, s[32:35], s71 offen offset:3072 lds
    ds_read_b64_tr_b16 a[54:55], v29 offset:1024
    v_mfma_f32_16x16x32_bf16 v[200:203], a[8:11], a[108:111], v[200:203]
    v_mfma_f32_16x16x32_bf16 v[204:207], a[12:15], a[108:111], v[204:207]
    s_add_u32 m0, s88, 147584
    ds_read_b64_tr_b16 a[56:57], v30 offset:0
    v_mfma_f32_16x16x32_bf16 v[208:211], a[16:19], a[108:111], v[208:211]
    v_mfma_f32_16x16x32_bf16 v[212:215], a[20:23], a[108:111], v[212:215]
    ds_read_b128 a[132:135], v32 offset:8192
    v_mfma_f32_16x16x32_bf16 v[216:219], a[24:27], a[108:111], v[216:219]
    buffer_load_dwordx4 v52, s[32:35], s71 offen offset:0 lds
    ds_read_b64_tr_b16 a[58:59], v30 offset:1024
    v_mfma_f32_16x16x32_bf16 v[220:223], a[28:31], a[108:111], v[220:223]
    v_mfma_f32_16x16x32_bf16 v[224:227], a[0:3], a[112:115], v[224:227]
    s_add_u32 s71, s71, 128
    ds_read_b64_tr_b16 a[60:61], v31 offset:0
    v_mfma_f32_16x16x32_bf16 v[228:231], a[4:7], a[112:115], v[228:231]
    v_mfma_f32_16x16x32_bf16 v[232:235], a[8:11], a[112:115], v[232:235]
    ds_read_b64_tr_b16 a[62:63], v31 offset:1024
    v_mfma_f32_16x16x32_bf16 v[236:239], a[12:15], a[112:115], v[236:239]
    v_mfma_f32_16x16x32_bf16 v[240:243], a[16:19], a[112:115], v[240:243]
    v_mfma_f32_16x16x32_bf16 v[244:247], a[20:23], a[112:115], v[244:247]
    v_mfma_f32_16x16x32_bf16 v[248:251], a[24:27], a[112:115], v[248:251]
    v_mfma_f32_16x16x32_bf16 v[252:255], a[28:31], a[112:115], v[252:255]
    s_waitcnt vmcnt(13) lgkmcnt(0)
    s_barrier
    v_mfma_f32_16x16x32_bf16 v[96:99], a[32:35], a[116:119], v[96:99]
    s_add_u32 m0, s73, 65536
    ds_read_b64_tr_b16 a[64:65], v24 offset:16384
    v_mfma_f32_16x16x32_bf16 v[100:103], a[36:39], a[116:119], v[100:103]
    ds_read_b128 a[136:139], v33 offset:0
    v_mfma_f32_16x16x32_bf16 v[104:107], a[40:43], a[116:119], v[104:107]
    buffer_load_dwordx4 v44, s[36:39], s70 offen offset:0 lds
    v_mfma_f32_16x16x32_bf16 v[108:111], a[44:47], a[116:119], v[108:111]
    ds_read_b64_tr_b16 a[66:67], v24 offset:17408
    v_mfma_f32_16x16x32_bf16 v[112:115], a[48:51], a[116:119], v[112:115]
    v_mfma_f32_16x16x32_bf16 v[116:119], a[52:55], a[116:119], v[116:119]
    buffer_load_dwordx4 v45, s[36:39], s70 offen offset:1024 lds
    ds_read_b64_tr_b16 a[68:69], v25 offset:16384
    v_mfma_f32_16x16x32_bf16 v[120:123], a[56:59], a[116:119], v[120:123]
    ds_read_b64_tr_b16 a[70:71], v25 offset:17408
    v_mfma_f32_16x16x32_bf16 v[124:127], a[60:63], a[116:119], v[124:127]
    buffer_load_dwordx4 v46, s[36:39], s70 offen offset:2048 lds
    v_mfma_f32_16x16x32_bf16 v[128:131], a[32:35], a[120:123], v[128:131]
    ds_read_b128 a[140:143], v33 offset:2048
    v_mfma_f32_16x16x32_bf16 v[132:135], a[36:39], a[120:123], v[132:135]
    v_mfma_f32_16x16x32_bf16 v[136:139], a[40:43], a[120:123], v[136:139]
    buffer_load_dwordx4 v47, s[36:39], s70 offen offset:3072 lds
    ds_read_b64_tr_b16 a[72:73], v26 offset:16384
    v_mfma_f32_16x16x32_bf16 v[140:143], a[44:47], a[120:123], v[140:143]
    v_mfma_f32_16x16x32_bf16 v[144:147], a[48:51], a[120:123], v[144:147]
    s_add_u32 s70, s70, 0x40000
    ds_read_b64_tr_b16 a[74:75], v26 offset:17408
    v_mfma_f32_16x16x32_bf16 v[148:151], a[52:55], a[120:123], v[148:151]
    ds_read_b64_tr_b16 a[76:77], v27 offset:16384
    v_mfma_f32_16x16x32_bf16 v[152:155], a[56:59], a[120:123], v[152:155]
    v_mfma_f32_16x16x32_bf16 v[156:159], a[60:63], a[120:123], v[156:159]
    s_add_u32 m0, s75, 128
    ds_read_b128 a[144:147], v33 offset:4096
    v_mfma_f32_16x16x32_bf16 v[160:163], a[32:35], a[124:127], v[160:163]
    v_mfma_f32_16x16x32_bf16 v[164:167], a[36:39], a[124:127], v[164:167]
    s_add_u32 s68, s72, 8320
    ds_read_b64_tr_b16 a[78:79], v27 offset:17408
    v_mfma_f32_16x16x32_bf16 v[168:171], a[40:43], a[124:127], v[168:171]
    ds_read_b64_tr_b16 a[80:81], v28 offset:16384
    v_mfma_f32_16x16x32_bf16 v[172:175], a[44:47], a[124:127], v[172:175]
    v_mfma_f32_16x16x32_bf16 v[176:179], a[48:51], a[124:127], v[176:179]
    buffer_load_dwordx4 v57, s[44:47], s68 offen offset:0 nt lds
    ds_read_b64_tr_b16 a[82:83], v28 offset:17408
    v_mfma_f32_16x16x32_bf16 v[180:183], a[52:55], a[124:127], v[180:183]
    v_mfma_f32_16x16x32_bf16 v[184:187], a[56:59], a[124:127], v[184:187]
    buffer_load_dwordx4 v58, s[44:47], s68 offen offset:1024 nt lds
    ds_read_b128 a[148:151], v33 offset:6144
    v_mfma_f32_16x16x32_bf16 v[188:191], a[60:63], a[124:127], v[188:191]
    v_mfma_f32_16x16x32_bf16 v[192:195], a[32:35], a[128:131], v[192:195]
    ds_read_b64_tr_b16 a[84:85], v29 offset:16384
    v_mfma_f32_16x16x32_bf16 v[196:199], a[36:39], a[128:131], v[196:199]
    buffer_load_dwordx4 v57, s[44:47], s68 offen offset:2048 nt lds
    ds_read_b64_tr_b16 a[86:87], v29 offset:17408
    v_mfma_f32_16x16x32_bf16 v[200:203], a[40:43], a[128:131], v[200:203]
    v_mfma_f32_16x16x32_bf16 v[204:207], a[44:47], a[128:131], v[204:207]
    buffer_load_dwordx4 v58, s[44:47], s68 offen offset:3072 nt lds
    ds_read_b64_tr_b16 a[88:89], v30 offset:16384
    v_mfma_f32_16x16x32_bf16 v[208:211], a[48:51], a[128:131], v[208:211]
    v_mfma_f32_16x16x32_bf16 v[212:215], a[52:55], a[128:131], v[212:215]
    ds_read_b128 a[152:155], v33 offset:8192
    v_mfma_f32_16x16x32_bf16 v[216:219], a[56:59], a[128:131], v[216:219]
    ds_read_b64_tr_b16 a[90:91], v30 offset:17408
    v_mfma_f32_16x16x32_bf16 v[220:223], a[60:63], a[128:131], v[220:223]
    v_mfma_f32_16x16x32_bf16 v[224:227], a[32:35], a[132:135], v[224:227]
    ds_read_b64_tr_b16 a[92:93], v31 offset:16384
    v_mfma_f32_16x16x32_bf16 v[228:231], a[36:39], a[132:135], v[228:231]
    v_mfma_f32_16x16x32_bf16 v[232:235], a[40:43], a[132:135], v[232:235]
    ds_read_b64_tr_b16 a[94:95], v31 offset:17408
    v_mfma_f32_16x16x32_bf16 v[236:239], a[44:47], a[132:135], v[236:239]
    v_mfma_f32_16x16x32_bf16 v[240:243], a[48:51], a[132:135], v[240:243]
    v_mfma_f32_16x16x32_bf16 v[244:247], a[52:55], a[132:135], v[244:247]
    v_mfma_f32_16x16x32_bf16 v[248:251], a[56:59], a[132:135], v[248:251]
    v_mfma_f32_16x16x32_bf16 v[252:255], a[60:63], a[132:135], v[252:255]
    s_waitcnt vmcnt(8) lgkmcnt(0)
    s_barrier
    v_mfma_f32_16x16x32_bf16 v[96:99], a[64:67], a[136:139], v[96:99]
    s_add_u32 m0, s75, 4224
    ds_read_b64_tr_b16 a[0:1], v24 offset:57344
    v_mfma_f32_16x16x32_bf16 v[100:103], a[68:71], a[136:139], v[100:103]
    ds_read_b128 a[96:99], v32 offset:40960
    v_mfma_f32_16x16x32_bf16 v[104:107], a[72:75], a[136:139], v[104:107]
    s_add_u32 s68, s72, 12416
    v_mfma_f32_16x16x32_bf16 v[108:111], a[76:79], a[136:139], v[108:111]
    ds_read_b64_tr_b16 a[2:3], v24 offset:58368
    v_mfma_f32_16x16x32_bf16 v[112:115], a[80:83], a[136:139], v[112:115]
    v_mfma_f32_16x16x32_bf16 v[116:119], a[84:87], a[136:139], v[116:119]
    buffer_load_dwordx4 v57, s[44:47], s68 offen offset:0 nt lds
    ds_read_b64_tr_b16 a[4:5], v25 offset:57344
    v_mfma_f32_16x16x32_bf16 v[120:123], a[88:91], a[136:139], v[120:123]
    ds_read_b64_tr_b16 a[6:7], v25 offset:58368
    v_mfma_f32_16x16x32_bf16 v[124:127], a[92:95], a[136:139], v[124:127]
    buffer_load_dwordx4 v58, s[44:47], s68 offen offset:1024 nt lds
    v_mfma_f32_16x16x32_bf16 v[128:131], a[64:67], a[140:143], v[128:131]
    ds_read_b128 a[100:103], v32 offset:43008
    v_mfma_f32_16x16x32_bf16 v[132:135], a[68:71], a[140:143], v[132:135]
    v_mfma_f32_16x16x32_bf16 v[136:139], a[72:75], a[140:143], v[136:139]
    buffer_load_dwordx4 v57, s[44:47], s68 offen offset:2048 nt lds
    ds_read_b64_tr_b16 a[8:9], v26 offset:57344
    v_mfma_f32_16x16x32_bf16 v[140:143], a[76:79], a[140:143], v[140:143]
    v_mfma_f32_16x16x32_bf16 v[144:147], a[80:83], a[140:143], v[144:147]
    buffer_load_dwordx4 v58, s[44:47], s68 offen offset:3072 nt lds
    ds_read_b64_tr_b16 a[10:11], v26 offset:58368
    v_mfma_f32_16x16x32_bf16 v[148:151], a[84:87], a[140:143], v[148:151]
    ds_read_b64_tr_b16 a[12:13], v27 offset:57344
    v_mfma_f32_16x16x32_bf16 v[152:155], a[88:91], a[140:143], v[152:155]
    v_mfma_f32_16x16x32_bf16 v[156:159], a[92:95], a[140:143], v[156:159]
    ds_read_b128 a[104:107], v32 offset:45056
    v_mfma_f32_16x16x32_bf16 v[160:163], a[64:67], a[144:147], v[160:163]
    v_mfma_f32_16x16x32_bf16 v[164:167], a[68:71], a[144:147], v[164:167]
    ds_read_b64_tr_b16 a[14:15], v27 offset:58368
    v_mfma_f32_16x16x32_bf16 v[168:171], a[72:75], a[144:147], v[168:171]
    ds_read_b64_tr_b16 a[16:17], v28 offset:57344
    v_mfma_f32_16x16x32_bf16 v[172:175], a[76:79], a[144:147], v[172:175]
    v_mfma_f32_16x16x32_bf16 v[176:179], a[80:83], a[144:147], v[176:179]
    ds_read_b64_tr_b16 a[18:19], v28 offset:58368
    v_mfma_f32_16x16x32_bf16 v[180:183], a[84:87], a[144:147], v[180:183]
    v_mfma_f32_16x16x32_bf16 v[184:187], a[88:91], a[144:147], v[184:187]
    ds_read_b128 a[108:111], v32 offset:47104
    v_mfma_f32_16x16x32_bf16 v[188:191], a[92:95], a[144:147], v[188:191]
    v_mfma_f32_16x16x32_bf16 v[192:195], a[64:67], a[148:151], v[192:195]
    ds_read_b64_tr_b16 a[20:21], v29 offset:57344
    v_mfma_f32_16x16x32_bf16 v[196:199], a[68:71], a[148:151], v[196:199]
    ds_read_b64_tr_b16 a[22:23], v29 offset:58368
    v_mfma_f32_16x16x32_bf16 v[200:203], a[72:75], a[148:151], v[200:203]
    v_mfma_f32_16x16x32_bf16 v[204:207], a[76:79], a[148:151], v[204:207]
    ds_read_b64_tr_b16 a[24:25], v30 offset:57344
    v_mfma_f32_16x16x32_bf16 v[208:211], a[80:83], a[148:151], v[208:211]
    v_mfma_f32_16x16x32_bf16 v[212:215], a[84:87], a[148:151], v[212:215]
    ds_read_b128 a[112:115], v32 offset:49152
    v_mfma_f32_16x16x32_bf16 v[216:219], a[88:91], a[148:151], v[216:219]
    ds_read_b64_tr_b16 a[26:27], v30 offset:58368
    v_mfma_f32_16x16x32_bf16 v[220:223], a[92:95], a[148:151], v[220:223]
    v_mfma_f32_16x16x32_bf16 v[224:227], a[64:67], a[152:155], v[224:227]
    ds_read_b64_tr_b16 a[28:29], v31 offset:57344
    v_mfma_f32_16x16x32_bf16 v[228:231], a[68:71], a[152:155], v[228:231]
    v_mfma_f32_16x16x32_bf16 v[232:235], a[72:75], a[152:155], v[232:235]
    ds_read_b64_tr_b16 a[30:31], v31 offset:58368
    v_mfma_f32_16x16x32_bf16 v[236:239], a[76:79], a[152:155], v[236:239]
    v_mfma_f32_16x16x32_bf16 v[240:243], a[80:83], a[152:155], v[240:243]
    v_mfma_f32_16x16x32_bf16 v[244:247], a[84:87], a[152:155], v[244:247]
    v_mfma_f32_16x16x32_bf16 v[248:251], a[88:91], a[152:155], v[248:251]
    v_mfma_f32_16x16x32_bf16 v[252:255], a[92:95], a[152:155], v[252:255]
    s_waitcnt vmcnt(8) lgkmcnt(0)
    s_barrier
    v_mfma_f32_16x16x32_bf16 v[96:99], a[0:3], a[96:99], v[96:99]
    ds_read_b64_tr_b16 a[32:33], v24 offset:0
    v_mfma_f32_16x16x32_bf16 v[100:103], a[4:7], a[96:99], v[100:103]
    ds_read_b128 a[116:119], v33 offset:40960
    v_mfma_f32_16x16x32_bf16 v[104:107], a[8:11], a[96:99], v[104:107]
    v_mfma_f32_16x16x32_bf16 v[108:111], a[12:15], a[96:99], v[108:111]
    ds_read_b64_tr_b16 a[34:35], v24 offset:1024
    v_mfma_f32_16x16x32_bf16 v[112:115], a[16:19], a[96:99], v[112:115]
    v_mfma_f32_16x16x32_bf16 v[116:119], a[20:23], a[96:99], v[116:119]
    ds_read_b64_tr_b16 a[36:37], v25 offset:0
    v_mfma_f32_16x16x32_bf16 v[120:123], a[24:27], a[96:99], v[120:123]
    ds_read_b64_tr_b16 a[38:39], v25 offset:1024
    v_mfma_f32_16x16x32_bf16 v[124:127], a[28:31], a[96:99], v[124:127]
    v_mfma_f32_16x16x32_bf16 v[128:131], a[0:3], a[100:103], v[128:131]
    ds_read_b128 a[120:123], v33 offset:43008
    v_mfma_f32_16x16x32_bf16 v[132:135], a[4:7], a[100:103], v[132:135]
    v_mfma_f32_16x16x32_bf16 v[136:139], a[8:11], a[100:103], v[136:139]
    ds_read_b64_tr_b16 a[40:41], v26 offset:0
    v_mfma_f32_16x16x32_bf16 v[140:143], a[12:15], a[100:103], v[140:143]
    v_mfma_f32_16x16x32_bf16 v[144:147], a[16:19], a[100:103], v[144:147]
    ds_read_b64_tr_b16 a[42:43], v26 offset:1024
    v_mfma_f32_16x16x32_bf16 v[148:151], a[20:23], a[100:103], v[148:151]
    ds_read_b64_tr_b16 a[44:45], v27 offset:0
    v_mfma_f32_16x16x32_bf16 v[152:155], a[24:27], a[100:103], v[152:155]
    v_mfma_f32_16x16x32_bf16 v[156:159], a[28:31], a[100:103], v[156:159]
    ds_read_b128 a[124:127], v33 offset:45056
    v_mfma_f32_16x16x32_bf16 v[160:163], a[0:3], a[104:107], v[160:163]
    v_mfma_f32_16x16x32_bf16 v[164:167], a[4:7], a[104:107], v[164:167]
    ds_read_b64_tr_b16 a[46:47], v27 offset:1024
    v_mfma_f32_16x16x32_bf16 v[168:171], a[8:11], a[104:107], v[168:171]
    ds_read_b64_tr_b16 a[48:49], v28 offset:0
    v_mfma_f32_16x16x32_bf16 v[172:175], a[12:15], a[104:107], v[172:175]
    v_mfma_f32_16x16x32_bf16 v[176:179], a[16:19], a[104:107], v[176:179]
    ds_read_b64_tr_b16 a[50:51], v28 offset:1024
    v_mfma_f32_16x16x32_bf16 v[180:183], a[20:23], a[104:107], v[180:183]
    v_mfma_f32_16x16x32_bf16 v[184:187], a[24:27], a[104:107], v[184:187]
    ds_read_b128 a[128:131], v33 offset:47104
    v_mfma_f32_16x16x32_bf16 v[188:191], a[28:31], a[104:107], v[188:191]
    v_mfma_f32_16x16x32_bf16 v[192:195], a[0:3], a[108:111], v[192:195]
    ds_read_b64_tr_b16 a[52:53], v29 offset:0
    v_mfma_f32_16x16x32_bf16 v[196:199], a[4:7], a[108:111], v[196:199]
    ds_read_b64_tr_b16 a[54:55], v29 offset:1024
    v_mfma_f32_16x16x32_bf16 v[200:203], a[8:11], a[108:111], v[200:203]
    v_mfma_f32_16x16x32_bf16 v[204:207], a[12:15], a[108:111], v[204:207]
    ds_read_b64_tr_b16 a[56:57], v30 offset:0
    v_mfma_f32_16x16x32_bf16 v[208:211], a[16:19], a[108:111], v[208:211]
    v_mfma_f32_16x16x32_bf16 v[212:215], a[20:23], a[108:111], v[212:215]
    ds_read_b128 a[132:135], v33 offset:49152
    v_mfma_f32_16x16x32_bf16 v[216:219], a[24:27], a[108:111], v[216:219]
    ds_read_b64_tr_b16 a[58:59], v30 offset:1024
    v_mfma_f32_16x16x32_bf16 v[220:223], a[28:31], a[108:111], v[220:223]
    v_mfma_f32_16x16x32_bf16 v[224:227], a[0:3], a[112:115], v[224:227]
    ds_read_b64_tr_b16 a[60:61], v31 offset:0
    v_mfma_f32_16x16x32_bf16 v[228:231], a[4:7], a[112:115], v[228:231]
    v_mfma_f32_16x16x32_bf16 v[232:235], a[8:11], a[112:115], v[232:235]
    ds_read_b64_tr_b16 a[62:63], v31 offset:1024
    v_mfma_f32_16x16x32_bf16 v[236:239], a[12:15], a[112:115], v[236:239]
    v_mfma_f32_16x16x32_bf16 v[240:243], a[16:19], a[112:115], v[240:243]
    v_mfma_f32_16x16x32_bf16 v[244:247], a[20:23], a[112:115], v[244:247]
    v_mfma_f32_16x16x32_bf16 v[248:251], a[24:27], a[112:115], v[248:251]
    v_mfma_f32_16x16x32_bf16 v[252:255], a[28:31], a[112:115], v[252:255]
    s_waitcnt lgkmcnt(0)
    s_barrier
    v_mfma_f32_16x16x32_bf16 v[96:99], a[32:35], a[116:119], v[96:99]
    s_add_u32 s68, s97, s28
    s_nop 0
    v_mfma_f32_16x16x32_bf16 v[100:103], a[36:39], a[116:119], v[100:103]
    s_add_u32 m0, s88, 82048
    s_nop 0
    v_mfma_f32_16x16x32_bf16 v[104:107], a[40:43], a[116:119], v[104:107]
    buffer_load_dwordx4 v10, s[52:55], s68 offen offset:0 lds
    s_nop 0
    v_mfma_f32_16x16x32_bf16 v[108:111], a[44:47], a[116:119], v[108:111]
    s_nop 0
    s_nop 0
    v_cvt_pk_bf16_f32 v96, v96, v97
    v_mfma_f32_16x16x32_bf16 v[112:115], a[48:51], a[116:119], v[112:115]
    v_cvt_pk_bf16_f32 v97, v98, v99
    v_cvt_pk_bf16_f32 v98, v100, v101
    v_mfma_f32_16x16x32_bf16 v[116:119], a[52:55], a[116:119], v[116:119]
    v_cvt_pk_bf16_f32 v99, v102, v103
    v_cvt_pk_bf16_f32 v100, v104, v105
    v_mfma_f32_16x16x32_bf16 v[120:123], a[56:59], a[116:119], v[120:123]
    v_cvt_pk_bf16_f32 v101, v106, v107
    v_cvt_pk_bf16_f32 v102, v108, v109
    v_mfma_f32_16x16x32_bf16 v[124:127], a[60:63], a[116:119], v[124:127]
    buffer_load_dwordx4 v11, s[52:55], s68 offen offset:1024 lds
    v_cvt_pk_bf16_f32 v103, v110, v111
    v_mfma_f32_16x16x32_bf16 v[128:131], a[32:35], a[120:123], v[128:131]
    v_cvt_pk_bf16_f32 v104, v112, v113
    v_cvt_pk_bf16_f32 v105, v114, v115
    v_mfma_f32_16x16x32_bf16 v[132:135], a[36:39], a[120:123], v[132:135]
    v_cvt_pk_bf16_f32 v106, v116, v117
    v_cvt_pk_bf16_f32 v107, v118, v119
    v_mfma_f32_16x16x32_bf16 v[136:139], a[40:43], a[120:123], v[136:139]
    v_cvt_pk_bf16_f32 v108, v120, v121
    v_cvt_pk_bf16_f32 v109, v122, v123
    v_mfma_f32_16x16x32_bf16 v[140:143], a[44:47], a[120:123], v[140:143]
    v_cvt_pk_bf16_f32 v110, v124, v125
    v_cvt_pk_bf16_f32 v111, v126, v127
    v_mfma_f32_16x16x32_bf16 v[144:147], a[48:51], a[120:123], v[144:147]
    buffer_load_dwordx4 v12, s[52:55], s68 offen offset:2048 lds
    v_cvt_pk_bf16_f32 v128, v128, v129
    v_mfma_f32_16x16x32_bf16 v[148:151], a[52:55], a[120:123], v[148:151]
    v_cvt_pk_bf16_f32 v129, v130, v131
    v_cvt_pk_bf16_f32 v130, v132, v133
    v_mfma_f32_16x16x32_bf16 v[152:155], a[56:59], a[120:123], v[152:155]
    v_cvt_pk_bf16_f32 v131, v134, v135
    v_cvt_pk_bf16_f32 v132, v136, v137
    v_mfma_f32_16x16x32_bf16 v[156:159], a[60:63], a[120:123], v[156:159]
    v_cvt_pk_bf16_f32 v133, v138, v139
    v_cvt_pk_bf16_f32 v134, v140, v141
    v_mfma_f32_16x16x32_bf16 v[160:163], a[32:35], a[124:127], v[160:163]
    v_cvt_pk_bf16_f32 v135, v142, v143
L_pad2:
    s_cbranch_execz L_pad6
    s_nop 0
    v_cvt_pk_bf16_f32 v136, v144, v145
    v_mfma_f32_16x16x32_bf16 v[164:167], a[36:39], a[124:127], v[164:167]
    buffer_load_dwordx4 v13, s[52:55], s68 offen offset:3072 lds
    s_add_u32 m0, s88, 86144
    v_mfma_f32_16x16x32_bf16 v[168:171], a[40:43], a[124:127], v[168:171]
    v_cvt_pk_bf16_f32 v137, v146, v147
    v_cvt_pk_bf16_f32 v138, v148, v149
    v_mfma_f32_16x16x32_bf16 v[172:175], a[44:47], a[124:127], v[172:175]
    v_cvt_pk_bf16_f32 v139, v150, v151
    v_cvt_pk_bf16_f32 v140, v152, v153
    v_mfma_f32_16x16x32_bf16 v[176:179], a[48:51], a[124:127], v[176:179]
    v_cvt_pk_bf16_f32 v141, v154, v155
    v_cvt_pk_bf16_f32 v142, v156, v157
    v_mfma_f32_16x16x32_bf16 v[180:183], a[52:55], a[124:127], v[180:183]
    v_cvt_pk_bf16_f32 v143, v158, v159
    v_cvt_pk_bf16_f32 v160, v160, v161
    v_mfma_f32_16x16x32_bf16 v[184:187], a[56:59], a[124:127], v[184:187]
    buffer_load_dwordx4 v14, s[52:55], s68 offen offset:0 lds
    s_add_u32 s68, s97, s29
    s_nop 0
    v_mfma_f32_16x16x32_bf16 v[188:191], a[60:63], a[124:127], v[188:191]
    s_add_u32 m0, s88, 102528
    v_cvt_pk_bf16_f32 v161, v162, v163
    v_mfma_f32_16x16x32_bf16 v[192:195], a[32:35], a[128:131], v[192:195]
    v_cvt_pk_bf16_f32 v162, v164, v165
    v_cvt_pk_bf16_f32 v163, v166, v167
    v_mfma_f32_16x16x32_bf16 v[196:199], a[36:39], a[128:131], v[196:199]
    v_cvt_pk_bf16_f32 v164, v168, v169
    v_cvt_pk_bf16_f32 v165, v170, v171
    v_mfma_f32_16x16x32_bf16 v[200:203], a[40:43], a[128:131], v[200:203]
    v_cvt_pk_bf16_f32 v166, v172, v173
    v_cvt_pk_bf16_f32 v167, v174, v175
    v_mfma_f32_16x16x32_bf16 v[204:207], a[44:47], a[128:131], v[204:207]
    buffer_load_dwordx4 v10, s[52:55], s68 offen offset:0 lds
    v_cvt_pk_bf16_f32 v168, v176, v177
    v_mfma_f32_16x16x32_bf16 v[208:211], a[48:51], a[128:131], v[208:211]
    v_cvt_pk_bf16_f32 v169, v178, v179
    v_cvt_pk_bf16_f32 v170, v180, v181
    v_mfma_f32_16x16x32_bf16 v[212:215], a[52:55], a[128:131], v[212:215]
    v_cvt_pk_bf16_f32 v171, v182, v183
    v_cvt_pk_bf16_f32 v172, v184, v185
    v_mfma_f32_16x16x32_bf16 v[216:219], a[56:59], a[128:131], v[216:219]
    v_cvt_pk_bf16_f32 v173, v186, v187
    v_cvt_pk_bf16_f32 v174, v188, v189
    v_mfma_f32_16x16x32_bf16 v[220:223], a[60:63], a[128:131], v[220:223]
    v_cvt_pk_bf16_f32 v175, v190, v191
    v_cvt_pk_bf16_f32 v192, v192, v193
    v_mfma_f32_16x16x32_bf16 v[224:227], a[32:35], a[132:135], v[224:227]
    buffer_load_dwordx4 v11, s[52:55], s68 offen offset:1024 lds
    v_cvt_pk_bf16_f32 v193, v194, v195
    v_mfma_f32_16x16x32_bf16 v[228:231], a[36:39], a[132:135], v[228:231]
    v_cvt_pk_bf16_f32 v194, v196, v197
    v_cvt_pk_bf16_f32 v195, v198, v199
    v_mfma_f32_16x16x32_bf16 v[232:235], a[40:43], a[132:135], v[232:235]
    v_cvt_pk_bf16_f32 v196, v200, v201
    v_cvt_pk_bf16_f32 v197, v202, v203
    v_mfma_f32_16x16x32_bf16 v[236:239], a[44:47], a[132:135], v[236:239]
    v_cvt_pk_bf16_f32 v198, v204, v205
    v_cvt_pk_bf16_f32 v199, v206, v207
    v_mfma_f32_16x16x32_bf16 v[240:243], a[48:51], a[132:135], v[240:243]
    v_cvt_pk_bf16_f32 v200, v208, v209
    v_cvt_pk_bf16_f32 v201, v210, v211
    v_mfma_f32_16x16x32_bf16 v[244:247], a[52:55], a[132:135], v[244:247]
    buffer_load_dwordx4 v12, s[52:55], s68 offen offset:2048 lds
    v_cvt_pk_bf16_f32 v202, v212, v213
    v_mfma_f32_16x16x32_bf16 v[248:251], a[56:59], a[132:135], v[248:251]
    v_cvt_pk_bf16_f32 v203, v214, v215
    v_cvt_pk_bf16_f32 v204, v216, v217
    v_mfma_f32_16x16x32_bf16 v[252:255], a[60:63], a[132:135], v[252:255]
    v_cvt_pk_bf16_f32 v205, v218, v219
    v_cvt_pk_bf16_f32 v206, v220, v221
    v_mfma_f32_16x16x32_bf16 v[24:27], a[156:159], v[96:99], 0
    v_cvt_pk_bf16_f32 v207, v222, v223
    v_cvt_pk_bf16_f32 v224, v224, v225
    v_mfma_f32_16x16x32_bf16 v[28:31], a[172:175], v[96:99], 0
    v_cvt_pk_bf16_f32 v225, v226, v227
    v_cvt_pk_bf16_f32 v226, v228, v229
    v_mfma_f32_16x16x32_bf16 v[32:35], a[188:191], v[96:99], 0
    buffer_load_dwordx4 v13, s[52:55], s68 offen offset:3072 lds
    s_add_u32 m0, s88, 106624
    v_mfma_f32_16x16x32_bf16 v[36:39], a[204:207], v[96:99], 0
    v_cvt_pk_bf16_f32 v227, v230, v231
    v_cvt_pk_bf16_f32 v228, v232, v233
    v_mfma_f32_16x16x32_bf16 v[40:43], a[220:223], v[96:99], 0
    v_cvt_pk_bf16_f32 v229, v234, v235
    v_cvt_pk_bf16_f32 v230, v236, v237
    v_mfma_f32_16x16x32_bf16 v[24:27], a[160:163], v[100:103], v[24:27]
    v_cvt_pk_bf16_f32 v231, v238, v239
    v_cvt_pk_bf16_f32 v232, v240, v241
    v_mfma_f32_16x16x32_bf16 v[28:31], a[176:179], v[100:103], v[28:31]
    v_cvt_pk_bf16_f32 v233, v242, v243
    v_cvt_pk_bf16_f32 v234, v244, v245
    v_mfma_f32_16x16x32_bf16 v[32:35], a[192:195], v[100:103], v[32:35]
    buffer_load_dwordx4 v14, s[52:55], s68 offen offset:0 lds
    s_add_u32 s68, s97, s78
    s_nop 0
    v_mfma_f32_16x16x32_bf16 v[36:39], a[208:211], v[100:103], v[36:39]
    s_add_u32 m0, s88, 123008
    v_cvt_pk_bf16_f32 v235, v246, v247
    v_mfma_f32_16x16x32_bf16 v[40:43], a[224:227], v[100:103], v[40:43]
    v_cvt_pk_bf16_f32 v236, v248, v249
    v_cvt_pk_bf16_f32 v237, v250, v251
    v_mfma_f32_16x16x32_bf16 v[24:27], a[164:167], v[104:107], v[24:27]
    v_cvt_pk_bf16_f32 v238, v252, v253
    v_cvt_pk_bf16_f32 v239, v254, v255
    v_mfma_f32_16x16x32_bf16 v[28:31], a[180:183], v[104:107], v[28:31]
    v_mfma_f32_16x16x32_bf16 v[32:35], a[196:199], v[104:107], v[32:35]
    v_mfma_f32_16x16x32_bf16 v[36:39], a[212:215], v[104:107], v[36:39]
    v_mfma_f32_16x16x32_bf16 v[40:43], a[228:231], v[104:107], v[40:43]
    v_mfma_f32_16x16x32_bf16 v[24:27], a[168:171], v[108:111], v[24:27]
    v_mfma_f32_16x16x32_bf16 v[28:31], a[184:187], v[108:111], v[28:31]
    buffer_load_dwordx4 v10, s[52:55], s68 offen offset:0 lds
    v_mfma_f32_16x16x32_bf16 v[32:35], a[200:203], v[108:111], v[32:35]
    v_mfma_f32_16x16x32_bf16 v[36:39], a[216:219], v[108:111], v[36:39]
    v_mfma_f32_16x16x32_bf16 v[40:43], a[232:235], v[108:111], v[40:43]
    v_mfma_f32_16x16x32_bf16 v[44:47], a[156:159], v[128:131], 0
    v_mfma_f32_16x16x32_bf16 v[48:51], a[172:175], v[128:131], 0
    s_nop 0
    s_nop 0
    v_max3_f32 v84, v24, v25, v26
    v_mfma_f32_16x16x32_bf16 v[52:55], a[188:191], v[128:131], 0
    v_max3_f32 v85, v27, v28, v29
    v_max3_f32 v84, v84, v30, v31
    v_mfma_f32_16x16x32_bf16 v[56:59], a[204:207], v[128:131], 0
    v_max3_f32 v85, v85, v32, v33
    v_max3_f32 v84, v84, v34, v35
    v_mfma_f32_16x16x32_bf16 v[60:63], a[220:223], v[128:131], 0
    v_max3_f32 v85, v85, v36, v37
    v_max3_f32 v84, v84, v38, v39
    v_mfma_f32_16x16x32_bf16 v[44:47], a[160:163], v[132:135], v[44:47]
    buffer_load_dwordx4 v11, s[52:55], s68 offen offset:1024 lds
    v_max3_f32 v85, v85, v40, v41
    v_mfma_f32_16x16x32_bf16 v[48:51], a[176:179], v[132:135], v[48:51]
    v_max3_f32 v84, v84, v42, v43
    v_max_f32_e64 v84, v84, v85
    v_mfma_f32_16x16x32_bf16 v[52:55], a[192:195], v[132:135], v[52:55]
    v_mov_b32_e64 v85, v84
    v_mfma_f32_16x16x32_bf16 v[56:59], a[208:211], v[132:135], v[56:59]
    s_nop 0
    v_permlane32_swap_b32_e32 v84, v85
    v_mfma_f32_16x16x32_bf16 v[60:63], a[224:227], v[132:135], v[60:63]
    v_max_f32_e32 v84, v84, v85
    v_mov_b32_e32 v85, v84
    v_mfma_f32_16x16x32_bf16 v[44:47], a[164:167], v[136:139], v[44:47]
    s_nop 0
    v_permlane16_swap_b32_e32 v84, v85
    v_mfma_f32_16x16x32_bf16 v[48:51], a[180:183], v[136:139], v[48:51]
    v_max_f32_e32 v84, v84, v85
    v_mul_f32_e32 v84, s83, v84
    v_pk_fma_f32 v[24:25], v[24:25], s[82:83], v[84:85] op_sel:[0,1,0] op_sel_hi:[1,1,0] neg_lo:[0,0,1] neg_hi:[0,0,1]
    v_pk_fma_f32 v[26:27], v[26:27], s[82:83], v[84:85] op_sel:[0,1,0] op_sel_hi:[1,1,0] neg_lo:[0,0,1] neg_hi:[0,0,1]
    v_pk_fma_f32 v[28:29], v[28:29], s[82:83], v[84:85] op_sel:[0,1,0] op_sel_hi:[1,1,0] neg_lo:[0,0,1] neg_hi:[0,0,1]
    v_pk_fma_f32 v[30:31], v[30:31], s[82:83], v[84:85] op_sel:[0,1,0] op_sel_hi:[1,1,0] neg_lo:[0,0,1] neg_hi:[0,0,1]
    v_pk_fma_f32 v[32:33], v[32:33], s[82:83], v[84:85] op_sel:[0,1,0] op_sel_hi:[1,1,0] neg_lo:[0,0,1] neg_hi:[0,0,1]
    v_pk_fma_f32 v[34:35], v[34:35], s[82:83], v[84:85] op_sel:[0,1,0] op_sel_hi:[1,1,0] neg_lo:[0,0,1] neg_hi:[0,0,1]
    v_pk_fma_f32 v[36:37], v[36:37], s[82:83], v[84:85] op_sel:[0,1,0] op_sel_hi:[1,1,0] neg_lo:[0,0,1] neg_hi:[0,0,1]
    v_pk_fma_f32 v[38:39], v[38:39], s[82:83], v[84:85] op_sel:[0,1,0] op_sel_hi:[1,1,0] neg_lo:[0,0,1] neg_hi:[0,0,1]
    v_pk_fma_f32 v[40:41], v[40:41], s[82:83], v[84:85] op_sel:[0,1,0] op_sel_hi:[1,1,0] neg_lo:[0,0,1] neg_hi:[0,0,1]
    v_pk_fma_f32 v[42:43], v[42:43], s[82:83], v[84:85] op_sel:[0,1,0] op_sel_hi:[1,1,0] neg_lo:[0,0,1] neg_hi:[0,0,1]
    v_mfma_f32_16x16x32_bf16 v[52:55], a[196:199], v[136:139], v[52:55]
    buffer_load_dwordx4 v12, s[52:55], s68 offen offset:2048 lds
    v_exp_f32_e64 v24, v24
    v_mfma_f32_16x16x32_bf16 v[56:59], a[212:215], v[136:139], v[56:59]
    v_exp_f32_e64 v25, v25
    v_mfma_f32_16x16x32_bf16 v[60:63], a[228:231], v[136:139], v[60:63]
    v_exp_f32_e64 v26, v26
    v_mfma_f32_16x16x32_bf16 v[44:47], a[168:171], v[140:143], v[44:47]
    v_exp_f32_e64 v27, v27
    v_mfma_f32_16x16x32_bf16 v[48:51], a[184:187], v[140:143], v[48:51]
    v_exp_f32_e64 v28, v28
    v_mfma_f32_16x16x32_bf16 v[52:55], a[200:203], v[140:143], v[52:55]
    v_exp_f32_e64 v29, v29
    v_mfma_f32_16x16x32_bf16 v[56:59], a[216:219], v[140:143], v[56:59]
    v_exp_f32_e64 v30, v30
    v_mfma_f32_16x16x32_bf16 v[60:63], a[232:235], v[140:143], v[60:63]
    v_exp_f32_e32 v31, v31
    v_exp_f32_e32 v32, v32
    v_exp_f32_e64 v33, v33
    buffer_load_dwordx4 v13, s[52:55], s68 offen offset:3072 lds
    s_add_u32 m0, s88, 127104
    v_exp_f32_e32 v34, v34
    v_exp_f32_e32 v35, v35
    v_exp_f32_e32 v36, v36
    v_exp_f32_e32 v37, v37
    v_exp_f32_e32 v38, v38
    v_exp_f32_e32 v39, v39
    v_exp_f32_e32 v40, v40
    v_exp_f32_e32 v41, v41
    v_exp_f32_e32 v42, v42
    v_exp_f32_e32 v43, v43
    v_pk_add_f32 v[86:87], v[24:25], v[26:27]
    v_pk_add_f32 v[86:87], v[86:87], v[28:29]
    v_pk_add_f32 v[86:87], v[86:87], v[30:31]
    v_pk_add_f32 v[86:87], v[86:87], v[32:33]
    v_pk_add_f32 v[86:87], v[86:87], v[34:35]
    v_pk_add_f32 v[86:87], v[86:87], v[36:37]
    v_pk_add_f32 v[86:87], v[86:87], v[38:39]
    v_pk_add_f32 v[86:87], v[86:87], v[40:41]
    v_pk_add_f32 v[86:87], v[86:87], v[42:43]
    v_add_f32_e32 v86, v86, v87
    v_mov_b32_e32 v87, v86
    v_max3_f32 v88, v44, v45, v46
    v_max3_f32 v89, v47, v48, v49
    buffer_load_dwordx4 v14, s[52:55], s68 offen offset:0 lds
    s_add_u32 s68, s97, s79
    s_add_u32 m0, s88, 143488
    v_permlane32_swap_b32_e32 v86, v87
    v_add_f32_e32 v86, v86, v87
    v_mov_b32_e32 v87, v86
    v_max3_f32 v88, v88, v50, v51
    v_max3_f32 v89, v89, v52, v53
    v_permlane16_swap_b32_e32 v86, v87
    v_add_f32_e32 v86, v86, v87
    v_rcp_f32_e32 v86, v86
    s_waitcnt vmcnt(15)
    v_pk_mul_f32 v[24:25], v[24:25], v[86:87] op_sel_hi:[1,0]
    v_pk_mul_f32 v[26:27], v[26:27], v[86:87] op_sel_hi:[1,0]
    v_pk_mul_f32 v[28:29], v[28:29], v[86:87] op_sel_hi:[1,0]
    v_pk_mul_f32 v[30:31], v[30:31], v[86:87] op_sel_hi:[1,0]
    v_pk_mul_f32 v[32:33], v[32:33], v[86:87] op_sel_hi:[1,0]
    v_pk_mul_f32 v[34:35], v[34:35], v[86:87] op_sel_hi:[1,0]
    v_pk_mul_f32 v[36:37], v[36:37], v[86:87] op_sel_hi:[1,0]
    v_pk_mul_f32 v[38:39], v[38:39], v[86:87] op_sel_hi:[1,0]
    v_pk_mul_f32 v[40:41], v[40:41], v[86:87] op_sel_hi:[1,0]
    v_pk_mul_f32 v[42:43], v[42:43], v[86:87] op_sel_hi:[1,0]
    v_cvt_pk_bf16_f32 v64, v24, v25
    v_cvt_pk_bf16_f32 v65, v26, v27
    v_mfma_f32_16x16x32_bf16 v[24:27], a[156:159], v[160:163], 0
    v_cvt_pk_bf16_f32 v66, v28, v29
    v_cvt_pk_bf16_f32 v67, v30, v31
    v_mfma_f32_16x16x32_bf16 v[28:31], a[172:175], v[160:163], 0
    v_cvt_pk_bf16_f32 v68, v32, v33
    v_cvt_pk_bf16_f32 v69, v34, v35
    v_mfma_f32_16x16x32_bf16 v[32:35], a[188:191], v[160:163], 0
    buffer_load_dwordx4 v10, s[52:55], s68 offen offset:0 lds
    v_cvt_pk_bf16_f32 v70, v36, v37
    v_mfma_f32_16x16x32_bf16 v[24:27], a[160:163], v[164:167], v[24:27]
    v_cvt_pk_bf16_f32 v71, v38, v39
    v_cvt_pk_bf16_f32 v72, v40, v41
    v_mfma_f32_16x16x32_bf16 v[36:39], a[204:207], v[160:163], 0
    v_cvt_pk_bf16_f32 v73, v42, v43
    ds_read_b64_tr_b16 a[0:1], v16 offset:8192
    v_mfma_f32_16x16x32_bf16 v[40:43], a[220:223], v[160:163], 0
    ds_read_b64_tr_b16 a[2:3], v16 offset:12288
    ds_read_b64_tr_b16 a[4:5], v17 offset:8192
    v_mfma_f32_16x16x32_bf16 v[28:31], a[176:179], v[164:167], v[28:31]
    ds_read_b64_tr_b16 a[6:7], v17 offset:12288
    ds_read_b64_tr_b16 a[8:9], v18 offset:8192
    v_mfma_f32_16x16x32_bf16 v[32:35], a[192:195], v[164:167], v[32:35]
    ds_read_b64_tr_b16 a[10:11], v18 offset:12288
    ds_read_b64_tr_b16 a[12:13], v19 offset:8192
    v_mfma_f32_16x16x32_bf16 v[36:39], a[208:211], v[164:167], v[36:39]
    ds_read_b64_tr_b16 a[14:15], v19 offset:12288
    ds_read_b64_tr_b16 a[16:17], v20 offset:8192
    v_mfma_f32_16x16x32_bf16 v[40:43], a[224:227], v[164:167], v[40:43]
    ds_read_b64_tr_b16 a[18:19], v20 offset:12288
    ds_read_b64_tr_b16 a[20:21], v21 offset:8192
    v_mfma_f32_16x16x32_bf16 v[24:27], a[164:167], v[168:171], v[24:27]
    ds_read_b64_tr_b16 a[22:23], v21 offset:12288
    ds_read_b64_tr_b16 a[24:25], v22 offset:8192
    v_mfma_f32_16x16x32_bf16 v[28:31], a[180:183], v[168:171], v[28:31]
    buffer_load_dwordx4 v11, s[52:55], s68 offen offset:1024 lds
    ds_read_b64_tr_b16 a[26:27], v22 offset:12288
    v_mfma_f32_16x16x32_bf16 v[32:35], a[196:199], v[168:171], v[32:35]
    ds_read_b64_tr_b16 a[28:29], v23 offset:8192
    ds_read_b64_tr_b16 a[30:31], v23 offset:12288
    v_mfma_f32_16x16x32_bf16 v[36:39], a[212:215], v[168:171], v[36:39]
    ds_read_b64_tr_b16 a[32:33], v16 offset:0
    ds_read_b64_tr_b16 a[34:35], v16 offset:4096
    v_mfma_f32_16x16x32_bf16 v[40:43], a[228:231], v[168:171], v[40:43]
    ds_read_b64_tr_b16 a[36:37], v17 offset:0
    ds_read_b64_tr_b16 a[38:39], v17 offset:4096
    v_mfma_f32_16x16x32_bf16 v[24:27], a[168:171], v[172:175], v[24:27]
    ds_read_b64_tr_b16 a[40:41], v18 offset:0
    ds_read_b64_tr_b16 a[42:43], v18 offset:4096
    v_mfma_f32_16x16x32_bf16 v[28:31], a[184:187], v[172:175], v[28:31]
    ds_read_b64_tr_b16 a[44:45], v19 offset:0
    ds_read_b64_tr_b16 a[46:47], v19 offset:4096
    v_mfma_f32_16x16x32_bf16 v[32:35], a[200:203], v[172:175], v[32:35]
    ds_read_b64_tr_b16 a[48:49], v20 offset:0
    ds_read_b64_tr_b16 a[50:51], v20 offset:4096
    v_mfma_f32_16x16x32_bf16 v[36:39], a[216:219], v[172:175], v[36:39]
    ds_read_b64_tr_b16 a[52:53], v21 offset:0
    ds_read_b64_tr_b16 a[54:55], v21 offset:4096
    v_mfma_f32_16x16x32_bf16 v[40:43], a[232:235], v[172:175], v[40:43]
    ds_read_b64_tr_b16 a[56:57], v22 offset:0
    ds_read_b64_tr_b16 a[58:59], v22 offset:4096
    ds_read_b64_tr_b16 a[60:61], v23 offset:0
    buffer_load_dwordx4 v12, s[52:55], s68 offen offset:2048 lds
    ds_read_b64_tr_b16 a[62:63], v23 offset:4096
    v_max3_f32 v88, v88, v54, v55
    v_max3_f32 v89, v89, v56, v57
    v_max3_f32 v88, v88, v58, v59
    v_max3_f32 v89, v89, v60, v61
    v_max3_f32 v88, v88, v62, v63
    v_max_f32_e32 v88, v88, v89
    v_mov_b32_e32 v89, v88
    v_max3_f32 v84, v24, v25, v26
    v_max3_f32 v85, v27, v28, v29
    v_permlane32_swap_b32_e32 v88, v89
    v_max_f32_e32 v88, v88, v89
    v_mov_b32_e64 v89, v88
    v_max3_f32 v84, v84, v30, v31
    v_max3_f32 v85, v85, v32, v33
    v_permlane16_swap_b32_e32 v88, v89
    v_max_f32_e32 v88, v88, v89
    v_mul_f32_e64 v88, s83, v88
    v_pk_fma_f32 v[44:45], v[44:45], s[82:83], v[88:89] op_sel:[0,1,0] op_sel_hi:[1,1,0] neg_lo:[0,0,1] neg_hi:[0,0,1]
    v_pk_fma_f32 v[46:47], v[46:47], s[82:83], v[88:89] op_sel:[0,1,0] op_sel_hi:[1,1,0] neg_lo:[0,0,1] neg_hi:[0,0,1]
    v_pk_fma_f32 v[48:49], v[48:49], s[82:83], v[88:89] op_sel:[0,1,0] op_sel_hi:[1,1,0] neg_lo:[0,0,1] neg_hi:[0,0,1]
    v_pk_fma_f32 v[50:51], v[50:51], s[82:83], v[88:89] op_sel:[0,1,0] op_sel_hi:[1,1,0] neg_lo:[0,0,1] neg_hi:[0,0,1]
    v_pk_fma_f32 v[52:53], v[52:53], s[82:83], v[88:89] op_sel:[0,1,0] op_sel_hi:[1,1,0] neg_lo:[0,0,1] neg_hi:[0,0,1]
    v_pk_fma_f32 v[54:55], v[54:55], s[82:83], v[88:89] op_sel:[0,1,0] op_sel_hi:[1,1,0] neg_lo:[0,0,1] neg_hi:[0,0,1]
    v_pk_fma_f32 v[56:57], v[56:57], s[82:83], v[88:89] op_sel:[0,1,0] op_sel_hi:[1,1,0] neg_lo:[0,0,1] neg_hi:[0,0,1]
    v_pk_fma_f32 v[58:59], v[58:59], s[82:83], v[88:89] op_sel:[0,1,0] op_sel_hi:[1,1,0] neg_lo:[0,0,1] neg_hi:[0,0,1]
    v_pk_fma_f32 v[60:61], v[60:61], s[82:83], v[88:89] op_sel:[0,1,0] op_sel_hi:[1,1,0] neg_lo:[0,0,1] neg_hi:[0,0,1]
    v_pk_fma_f32 v[62:63], v[62:63], s[82:83], v[88:89] op_sel:[0,1,0] op_sel_hi:[1,1,0] neg_lo:[0,0,1] neg_hi:[0,0,1]
    v_exp_f32_e32 v44, v44
    s_waitcnt lgkmcnt(0)
    v_mfma_f32_16x16x32_bf16 v[96:99], a[0:3], v[64:67], 0
    buffer_load_dwordx4 v13, s[52:55], s68 offen offset:3072 lds
    s_add_u32 m0, s88, 147584
    v_mfma_f32_16x16x32_bf16 v[100:103], a[4:7], v[64:67], 0
    s_buffer_load_dwordx8 s[20:27], s[60:63], 0
    v_add_u32 v16, 40960, v8
    v_mfma_f32_16x16x32_bf16 v[104:107], a[8:11], v[64:67], 0
    v_add_u32 v17, 40960, v9
    v_add_u32 v18, 40960, v7
    v_mfma_f32_16x16x32_bf16 v[108:111], a[12:15], v[64:67], 0
    v_add_u32 v19, 40960, v3
    v_add_u32 v20, 40960, v5
    v_mfma_f32_16x16x32_bf16 v[112:115], a[16:19], v[64:67], 0
    v_add_u32 v21, 40960, v15
    v_add_u32 v22, 40960, v92
    v_mfma_f32_16x16x32_bf16 v[116:119], a[20:23], v[64:67], 0
    v_add_u32 v23, 40960, v93
    s_barrier
    v_mfma_f32_16x16x32_bf16 v[120:123], a[24:27], v[64:67], 0
    v_exp_f32_e32 v45, v45
    v_mfma_f32_16x16x32_bf16 v[124:127], a[28:31], v[64:67], 0
    v_exp_f32_e64 v46, v46
    v_mfma_f32_16x16x32_bf16 v[96:99], a[32:35], v[68:71], v[96:99]
    v_exp_f32_e64 v47, v47
    v_mfma_f32_16x16x32_bf16 v[100:103], a[36:39], v[68:71], v[100:103]
    buffer_load_dwordx4 v14, s[52:55], s68 offen offset:0 lds
    v_exp_f32_e64 v48, v48
    v_mfma_f32_16x16x32_bf16 v[104:107], a[40:43], v[68:71], v[104:107]
    v_exp_f32_e64 v49, v49
    v_mfma_f32_16x16x32_bf16 v[108:111], a[44:47], v[68:71], v[108:111]
    v_exp_f32_e64 v50, v50
    v_mfma_f32_16x16x32_bf16 v[112:115], a[48:51], v[68:71], v[112:115]
    v_exp_f32_e64 v51, v51
    v_mfma_f32_16x16x32_bf16 v[116:119], a[52:55], v[68:71], v[116:119]
    v_exp_f32_e64 v52, v52
    v_mfma_f32_16x16x32_bf16 v[120:123], a[56:59], v[68:71], v[120:123]
    v_exp_f32_e64 v53, v53
    v_mfma_f32_16x16x32_bf16 v[124:127], a[60:63], v[68:71], v[124:127]
    v_exp_f32_e64 v54, v54
    v_mfma_f32_16x16x16_bf16 v[96:99], a[236:237], v[72:73], v[96:99]
    v_exp_f32_e64 v55, v55
    v_mfma_f32_16x16x16_bf16 v[100:103], a[238:239], v[72:73], v[100:103]
    v_exp_f32_e64 v56, v56
    v_mfma_f32_16x16x16_bf16 v[104:107], a[240:241], v[72:73], v[104:107]
    v_exp_f32_e64 v57, v57
    v_mfma_f32_16x16x16_bf16 v[108:111], a[242:243], v[72:73], v[108:111]
    v_exp_f32_e64 v58, v58
    v_mfma_f32_16x16x16_bf16 v[112:115], a[244:245], v[72:73], v[112:115]
    v_exp_f32_e64 v59, v59
    v_mfma_f32_16x16x16_bf16 v[116:119], a[246:247], v[72:73], v[116:119]
    v_exp_f32_e64 v60, v60
    v_mfma_f32_16x16x16_bf16 v[120:123], a[248:249], v[72:73], v[120:123]
    v_exp_f32_e64 v61, v61
    v_mfma_f32_16x16x16_bf16 v[124:127], a[250:251], v[72:73], v[124:127]
    v_exp_f32_e32 v62, v62
    v_exp_f32_e32 v63, v63
    v_cvt_pk_bf16_f32 v96, v96, v97
    v_pk_add_f32 v[90:91], v[44:45], v[46:47]
    v_pk_add_f32 v[90:91], v[90:91], v[48:49]
    v_pk_add_f32 v[90:91], v[90:91], v[50:51]
    v_pk_add_f32 v[90:91], v[90:91], v[52:53]
    v_pk_add_f32 v[90:91], v[90:91], v[54:55]
    v_pk_add_f32 v[90:91], v[90:91], v[56:57]
    v_pk_add_f32 v[90:91], v[90:91], v[58:59]
    v_pk_add_f32 v[90:91], v[90:91], v[60:61]
    v_pk_add_f32 v[90:91], v[90:91], v[62:63]
    v_add_f32_e32 v90, v90, v91
    v_mov_b32_e32 v91, v90
    v_cvt_pk_bf16_f32 v97, v98, v99
    v_cvt_pk_bf16_f32 v98, v100, v101
    v_permlane32_swap_b32_e32 v90, v91
    v_add_f32_e32 v90, v90, v91
    v_mov_b32_e64 v91, v90
    v_cvt_pk_bf16_f32 v99, v102, v103
    ds_write_b128 v3, v[96:99] offset:0
    v_permlane16_swap_b32_e32 v90, v91
    v_add_f32_e32 v90, v90, v91
    v_rcp_f32_e64 v90, v90
    v_cvt_pk_bf16_f32 v100, v104, v105
    v_pk_mul_f32 v[44:45], v[44:45], v[90:91] op_sel_hi:[1,0]
    v_pk_mul_f32 v[46:47], v[46:47], v[90:91] op_sel_hi:[1,0]
    v_pk_mul_f32 v[48:49], v[48:49], v[90:91] op_sel_hi:[1,0]
    v_pk_mul_f32 v[50:51], v[50:51], v[90:91] op_sel_hi:[1,0]
    v_pk_mul_f32 v[52:53], v[52:53], v[90:91] op_sel_hi:[1,0]
    v_pk_mul_f32 v[54:55], v[54:55], v[90:91] op_sel_hi:[1,0]
    v_pk_mul_f32 v[56:57], v[56:57], v[90:91] op_sel_hi:[1,0]
    v_pk_mul_f32 v[58:59], v[58:59], v[90:91] op_sel_hi:[1,0]
    v_pk_mul_f32 v[60:61], v[60:61], v[90:91] op_sel_hi:[1,0]
    v_pk_mul_f32 v[62:63], v[62:63], v[90:91] op_sel_hi:[1,0]
    v_cvt_pk_bf16_f32 v74, v44, v45
    v_cvt_pk_bf16_f32 v75, v46, v47
    v_mfma_f32_16x16x32_bf16 v[44:47], a[156:159], v[192:195], 0
    v_cvt_pk_bf16_f32 v76, v48, v49
    v_cvt_pk_bf16_f32 v77, v50, v51
    v_mfma_f32_16x16x32_bf16 v[48:51], a[172:175], v[192:195], 0
    v_cvt_pk_bf16_f32 v78, v52, v53
    v_cvt_pk_bf16_f32 v79, v54, v55
    v_mfma_f32_16x16x32_bf16 v[128:131], a[0:3], v[74:77], 0
    v_cvt_pk_bf16_f32 v80, v56, v57
    v_cvt_pk_bf16_f32 v81, v58, v59
    v_mfma_f32_16x16x32_bf16 v[132:135], a[4:7], v[74:77], 0
    v_cvt_pk_bf16_f32 v82, v60, v61
    v_cvt_pk_bf16_f32 v83, v62, v63
    v_mfma_f32_16x16x32_bf16 v[136:139], a[8:11], v[74:77], 0
    v_cvt_pk_bf16_f32 v101, v106, v107
    v_cvt_pk_bf16_f32 v102, v108, v109
    v_mfma_f32_16x16x32_bf16 v[140:143], a[12:15], v[74:77], 0
    v_cvt_pk_bf16_f32 v103, v110, v111
    ds_write_b128 v3, v[100:103] offset:20480
    v_mfma_f32_16x16x32_bf16 v[144:147], a[16:19], v[74:77], 0
    v_cvt_pk_bf16_f32 v104, v112, v113
    v_cvt_pk_bf16_f32 v105, v114, v115
    v_mfma_f32_16x16x32_bf16 v[148:151], a[20:23], v[74:77], 0
    v_cvt_pk_bf16_f32 v106, v116, v117
    v_cvt_pk_bf16_f32 v107, v118, v119
    v_mfma_f32_16x16x32_bf16 v[152:155], a[24:27], v[74:77], 0
    ds_write_b128 v19, v[104:107] offset:0
    v_mfma_f32_16x16x32_bf16 v[156:159], a[28:31], v[74:77], 0
    v_cvt_pk_bf16_f32 v108, v120, v121
    v_cvt_pk_bf16_f32 v109, v122, v123
    v_mfma_f32_16x16x32_bf16 v[128:131], a[32:35], v[78:81], v[128:131]
    v_cvt_pk_bf16_f32 v110, v124, v125
    v_cvt_pk_bf16_f32 v111, v126, v127
    v_mfma_f32_16x16x32_bf16 v[132:135], a[36:39], v[78:81], v[132:135]
    ds_write_b128 v19, v[108:111] offset:20480
    v_mfma_f32_16x16x32_bf16 v[136:139], a[40:43], v[78:81], v[136:139]
    v_max3_f32 v84, v84, v34, v35
    v_max3_f32 v85, v85, v36, v37
    v_mfma_f32_16x16x32_bf16 v[140:143], a[44:47], v[78:81], v[140:143]
    v_max3_f32 v84, v84, v38, v39
    v_max3_f32 v85, v85, v40, v41
    v_mfma_f32_16x16x32_bf16 v[144:147], a[48:51], v[78:81], v[144:147]
    v_max3_f32 v84, v84, v42, v43
    v_max_f32_e64 v84, v84, v85
    v_mfma_f32_16x16x32_bf16 v[148:151], a[52:55], v[78:81], v[148:151]
    v_mov_b32_e64 v85, v84
    v_mfma_f32_16x16x32_bf16 v[152:155], a[56:59], v[78:81], v[152:155]
    s_nop 0
    v_permlane32_swap_b32_e32 v84, v85
    v_mfma_f32_16x16x32_bf16 v[156:159], a[60:63], v[78:81], v[156:159]
    v_max_f32_e32 v84, v84, v85
    v_mov_b32_e32 v85, v84
    v_mfma_f32_16x16x16_bf16 v[128:131], a[236:237], v[82:83], v[128:131]
    s_nop 0
    v_permlane16_swap_b32_e32 v84, v85
    v_mfma_f32_16x16x16_bf16 v[132:135], a[238:239], v[82:83], v[132:135]
    v_max_f32_e32 v84, v84, v85
    v_mul_f32_e32 v84, s83, v84
    v_pk_fma_f32 v[24:25], v[24:25], s[82:83], v[84:85] op_sel:[0,1,0] op_sel_hi:[1,1,0] neg_lo:[0,0,1] neg_hi:[0,0,1]
    v_pk_fma_f32 v[26:27], v[26:27], s[82:83], v[84:85] op_sel:[0,1,0] op_sel_hi:[1,1,0] neg_lo:[0,0,1] neg_hi:[0,0,1]
    v_pk_fma_f32 v[28:29], v[28:29], s[82:83], v[84:85] op_sel:[0,1,0] op_sel_hi:[1,1,0] neg_lo:[0,0,1] neg_hi:[0,0,1]
    v_pk_fma_f32 v[30:31], v[30:31], s[82:83], v[84:85] op_sel:[0,1,0] op_sel_hi:[1,1,0] neg_lo:[0,0,1] neg_hi:[0,0,1]
    v_pk_fma_f32 v[32:33], v[32:33], s[82:83], v[84:85] op_sel:[0,1,0] op_sel_hi:[1,1,0] neg_lo:[0,0,1] neg_hi:[0,0,1]
    v_pk_fma_f32 v[34:35], v[34:35], s[82:83], v[84:85] op_sel:[0,1,0] op_sel_hi:[1,1,0] neg_lo:[0,0,1] neg_hi:[0,0,1]
    v_pk_fma_f32 v[36:37], v[36:37], s[82:83], v[84:85] op_sel:[0,1,0] op_sel_hi:[1,1,0] neg_lo:[0,0,1] neg_hi:[0,0,1]
    v_pk_fma_f32 v[38:39], v[38:39], s[82:83], v[84:85] op_sel:[0,1,0] op_sel_hi:[1,1,0] neg_lo:[0,0,1] neg_hi:[0,0,1]
    v_pk_fma_f32 v[40:41], v[40:41], s[82:83], v[84:85] op_sel:[0,1,0] op_sel_hi:[1,1,0] neg_lo:[0,0,1] neg_hi:[0,0,1]
    v_pk_fma_f32 v[42:43], v[42:43], s[82:83], v[84:85] op_sel:[0,1,0] op_sel_hi:[1,1,0] neg_lo:[0,0,1] neg_hi:[0,0,1]
    v_mfma_f32_16x16x16_bf16 v[136:139], a[240:241], v[82:83], v[136:139]
    v_exp_f32_e64 v24, v24
    v_mfma_f32_16x16x16_bf16 v[140:143], a[242:243], v[82:83], v[140:143]
    v_exp_f32_e64 v25, v25
    v_mfma_f32_16x16x16_bf16 v[144:147], a[244:245], v[82:83], v[144:147]
    v_exp_f32_e64 v26, v26
    v_mfma_f32_16x16x16_bf16 v[148:151], a[246:247], v[82:83], v[148:151]
    v_exp_f32_e64 v27, v27
    v_mfma_f32_16x16x16_bf16 v[152:155], a[248:249], v[82:83], v[152:155]
    v_exp_f32_e64 v28, v28
    v_mfma_f32_16x16x16_bf16 v[156:159], a[250:251], v[82:83], v[156:159]
    v_exp_f32_e64 v29, v29
    v_mfma_f32_16x16x32_bf16 v[52:55], a[188:191], v[192:195], 0
    v_exp_f32_e64 v30, v30
    v_mfma_f32_16x16x32_bf16 v[56:59], a[204:207], v[192:195], 0
    buffer_store_dwordx4 v[96:99], v1, s[48:51], s92 offen offset:0 sc1
    v_exp_f32_e64 v31, v31
    v_mfma_f32_16x16x32_bf16 v[60:63], a[220:223], v[192:195], 0
    v_exp_f32_e64 v32, v32
    v_mfma_f32_16x16x32_bf16 v[44:47], a[160:163], v[196:199], v[44:47]
    v_exp_f32_e64 v33, v33
    v_mfma_f32_16x16x32_bf16 v[48:51], a[176:179], v[196:199], v[48:51]
    v_exp_f32_e64 v34, v34
    v_mfma_f32_16x16x32_bf16 v[52:55], a[192:195], v[196:199], v[52:55]
    v_exp_f32_e64 v35, v35
    v_mfma_f32_16x16x32_bf16 v[56:59], a[208:211], v[196:199], v[56:59]
    v_exp_f32_e64 v36, v36
    v_mfma_f32_16x16x32_bf16 v[60:63], a[224:227], v[196:199], v[60:63]
    v_exp_f32_e64 v37, v37
    v_mfma_f32_16x16x32_bf16 v[44:47], a[164:167], v[200:203], v[44:47]
    v_exp_f32_e64 v38, v38
    v_mfma_f32_16x16x32_bf16 v[48:51], a[180:183], v[200:203], v[48:51]
    v_exp_f32_e64 v39, v39
    v_mfma_f32_16x16x32_bf16 v[52:55], a[196:199], v[200:203], v[52:55]
    buffer_store_dwordx4 v[100:103], v1, s[48:51], s93 offen offset:0 sc1
    v_exp_f32_e64 v40, v40
    v_mfma_f32_16x16x32_bf16 v[56:59], a[212:215], v[200:203], v[56:59]
    v_exp_f32_e64 v41, v41
    v_mfma_f32_16x16x32_bf16 v[60:63], a[228:231], v[200:203], v[60:63]
    v_exp_f32_e64 v42, v42
    v_mfma_f32_16x16x32_bf16 v[44:47], a[168:171], v[204:207], v[44:47]
    v_exp_f32_e64 v43, v43
    v_cvt_pk_bf16_f32 v128, v128, v129
    v_cvt_pk_bf16_f32 v129, v130, v131
    v_cvt_pk_bf16_f32 v130, v132, v133
    v_pk_add_f32 v[86:87], v[24:25], v[26:27]
    v_pk_add_f32 v[86:87], v[86:87], v[28:29]
    v_pk_add_f32 v[86:87], v[86:87], v[30:31]
    v_pk_add_f32 v[86:87], v[86:87], v[32:33]
    v_pk_add_f32 v[86:87], v[86:87], v[34:35]
    v_pk_add_f32 v[86:87], v[86:87], v[36:37]
    v_pk_add_f32 v[86:87], v[86:87], v[38:39]
    v_pk_add_f32 v[86:87], v[86:87], v[40:41]
    v_pk_add_f32 v[86:87], v[86:87], v[42:43]
    v_mfma_f32_16x16x32_bf16 v[48:51], a[184:187], v[204:207], v[48:51]
    v_add_f32_e32 v86, v86, v87
    v_mov_b32_e32 v87, v86
    v_mfma_f32_16x16x32_bf16 v[52:55], a[200:203], v[204:207], v[52:55]
    v_cvt_pk_bf16_f32 v131, v134, v135
    v_permlane32_swap_b32_e64 v86, v87
    v_mfma_f32_16x16x32_bf16 v[56:59], a[216:219], v[204:207], v[56:59]
    buffer_store_dwordx4 v[104:107], v1, s[48:51], s94 offen offset:0 sc1
    v_add_f32_e64 v86, v86, v87
    v_mfma_f32_16x16x32_bf16 v[60:63], a[232:235], v[204:207], v[60:63]
    v_mov_b32_e64 v87, v86
    ds_write_b128 v3, v[128:131] offset:1024
L_pad3:
    s_cbranch_execz L_pad7
    s_nop 0
    v_cvt_pk_bf16_f32 v132, v136, v137
    v_permlane16_swap_b32_e32 v86, v87
    v_add_f32_e32 v86, v86, v87
    v_rcp_f32_e64 v86, v86
    v_cvt_pk_bf16_f32 v133, v138, v139
    v_pk_mul_f32 v[24:25], v[24:25], v[86:87] op_sel_hi:[1,0]
    v_pk_mul_f32 v[26:27], v[26:27], v[86:87] op_sel_hi:[1,0]
    v_pk_mul_f32 v[28:29], v[28:29], v[86:87] op_sel_hi:[1,0]
    v_pk_mul_f32 v[30:31], v[30:31], v[86:87] op_sel_hi:[1,0]
    v_pk_mul_f32 v[32:33], v[32:33], v[86:87] op_sel_hi:[1,0]
    v_pk_mul_f32 v[34:35], v[34:35], v[86:87] op_sel_hi:[1,0]
    v_pk_mul_f32 v[36:37], v[36:37], v[86:87] op_sel_hi:[1,0]
    v_pk_mul_f32 v[38:39], v[38:39], v[86:87] op_sel_hi:[1,0]
    v_pk_mul_f32 v[40:41], v[40:41], v[86:87] op_sel_hi:[1,0]
    v_pk_mul_f32 v[42:43], v[42:43], v[86:87] op_sel_hi:[1,0]
    v_cvt_pk_bf16_f32 v64, v24, v25
    v_cvt_pk_bf16_f32 v65, v26, v27
    v_mfma_f32_16x16x32_bf16 v[24:27], a[156:159], v[224:227], 0
    v_cvt_pk_bf16_f32 v66, v28, v29
    v_cvt_pk_bf16_f32 v67, v30, v31
    v_mfma_f32_16x16x32_bf16 v[28:31], a[172:175], v[224:227], 0
    v_cvt_pk_bf16_f32 v68, v32, v33
    buffer_store_dwordx4 v[108:111], v1, s[48:51], s95 offen offset:0 sc1
    v_mfma_f32_16x16x32_bf16 v[160:163], a[0:3], v[64:67], 0
    v_cvt_pk_bf16_f32 v69, v34, v35
    v_cvt_pk_bf16_f32 v70, v36, v37
    v_mfma_f32_16x16x32_bf16 v[164:167], a[4:7], v[64:67], 0
    v_cvt_pk_bf16_f32 v71, v38, v39
    v_cvt_pk_bf16_f32 v72, v40, v41
    v_mfma_f32_16x16x32_bf16 v[168:171], a[8:11], v[64:67], 0
    v_cvt_pk_bf16_f32 v73, v42, v43
    v_cvt_pk_bf16_f32 v134, v140, v141
    v_mfma_f32_16x16x32_bf16 v[172:175], a[12:15], v[64:67], 0
    v_cvt_pk_bf16_f32 v135, v142, v143
    ds_write_b128 v3, v[132:135] offset:21504
    v_mfma_f32_16x16x32_bf16 v[176:179], a[16:19], v[64:67], 0
    v_cvt_pk_bf16_f32 v136, v144, v145
    v_cvt_pk_bf16_f32 v137, v146, v147
    v_mfma_f32_16x16x32_bf16 v[180:183], a[20:23], v[64:67], 0
    v_cvt_pk_bf16_f32 v138, v148, v149
    v_cvt_pk_bf16_f32 v139, v150, v151
    v_mfma_f32_16x16x32_bf16 v[184:187], a[24:27], v[64:67], 0
    ds_write_b128 v19, v[136:139] offset:1024
    v_mfma_f32_16x16x32_bf16 v[188:191], a[28:31], v[64:67], 0
    buffer_store_dwordx4 v[128:131], v1, s[48:51], s92 offen offset:1024 sc1
    v_cvt_pk_bf16_f32 v140, v152, v153
    v_mfma_f32_16x16x32_bf16 v[160:163], a[32:35], v[68:71], v[160:163]
    v_cvt_pk_bf16_f32 v141, v154, v155
    v_cvt_pk_bf16_f32 v142, v156, v157
    v_mfma_f32_16x16x32_bf16 v[164:167], a[36:39], v[68:71], v[164:167]
    v_cvt_pk_bf16_f32 v143, v158, v159
    ds_write_b128 v19, v[140:143] offset:21504
    v_mfma_f32_16x16x32_bf16 v[168:171], a[40:43], v[68:71], v[168:171]
    v_max3_f32 v88, v44, v45, v46
    v_max3_f32 v89, v47, v48, v49
    v_mfma_f32_16x16x32_bf16 v[172:175], a[44:47], v[68:71], v[172:175]
    v_max3_f32 v88, v88, v50, v51
    v_max3_f32 v89, v89, v52, v53
    v_mfma_f32_16x16x32_bf16 v[176:179], a[48:51], v[68:71], v[176:179]
    v_max3_f32 v88, v88, v54, v55
    v_max3_f32 v89, v89, v56, v57
    v_mfma_f32_16x16x32_bf16 v[180:183], a[52:55], v[68:71], v[180:183]
    v_max3_f32 v88, v88, v58, v59
    v_max3_f32 v89, v89, v60, v61
    v_mfma_f32_16x16x32_bf16 v[184:187], a[56:59], v[68:71], v[184:187]
    v_max3_f32 v88, v88, v62, v63
    v_max_f32_e64 v88, v88, v89
    v_mfma_f32_16x16x32_bf16 v[188:191], a[60:63], v[68:71], v[188:191]
    buffer_store_dwordx4 v[132:135], v1, s[48:51], s93 offen offset:1024 sc1
    v_mov_b32_e64 v89, v88
    v_mfma_f32_16x16x16_bf16 v[160:163], a[236:237], v[72:73], v[160:163]
    s_nop 0
    v_permlane32_swap_b32_e32 v88, v89
    v_mfma_f32_16x16x16_bf16 v[164:167], a[238:239], v[72:73], v[164:167]
    v_max_f32_e32 v88, v88, v89
    v_mov_b32_e32 v89, v88
    v_mfma_f32_16x16x16_bf16 v[168:171], a[240:241], v[72:73], v[168:171]
    s_nop 0
    v_permlane16_swap_b32_e32 v88, v89
    v_mfma_f32_16x16x16_bf16 v[172:175], a[242:243], v[72:73], v[172:175]
    v_max_f32_e32 v88, v88, v89
    v_mul_f32_e32 v88, s83, v88
    v_cvt_pk_bf16_f32 v160, v160, v161
    v_cvt_pk_bf16_f32 v161, v162, v163
    v_cvt_pk_bf16_f32 v162, v164, v165
    v_pk_fma_f32 v[44:45], v[44:45], s[82:83], v[88:89] op_sel:[0,1,0] op_sel_hi:[1,1,0] neg_lo:[0,0,1] neg_hi:[0,0,1]
    v_pk_fma_f32 v[46:47], v[46:47], s[82:83], v[88:89] op_sel:[0,1,0] op_sel_hi:[1,1,0] neg_lo:[0,0,1] neg_hi:[0,0,1]
    v_pk_fma_f32 v[48:49], v[48:49], s[82:83], v[88:89] op_sel:[0,1,0] op_sel_hi:[1,1,0] neg_lo:[0,0,1] neg_hi:[0,0,1]
    v_pk_fma_f32 v[50:51], v[50:51], s[82:83], v[88:89] op_sel:[0,1,0] op_sel_hi:[1,1,0] neg_lo:[0,0,1] neg_hi:[0,0,1]
    v_pk_fma_f32 v[52:53], v[52:53], s[82:83], v[88:89] op_sel:[0,1,0] op_sel_hi:[1,1,0] neg_lo:[0,0,1] neg_hi:[0,0,1]
    v_pk_fma_f32 v[54:55], v[54:55], s[82:83], v[88:89] op_sel:[0,1,0] op_sel_hi:[1,1,0] neg_lo:[0,0,1] neg_hi:[0,0,1]
    v_pk_fma_f32 v[56:57], v[56:57], s[82:83], v[88:89] op_sel:[0,1,0] op_sel_hi:[1,1,0] neg_lo:[0,0,1] neg_hi:[0,0,1]
    v_pk_fma_f32 v[58:59], v[58:59], s[82:83], v[88:89] op_sel:[0,1,0] op_sel_hi:[1,1,0] neg_lo:[0,0,1] neg_hi:[0,0,1]
    v_pk_fma_f32 v[60:61], v[60:61], s[82:83], v[88:89] op_sel:[0,1,0] op_sel_hi:[1,1,0] neg_lo:[0,0,1] neg_hi:[0,0,1]
    v_pk_fma_f32 v[62:63], v[62:63], s[82:83], v[88:89] op_sel:[0,1,0] op_sel_hi:[1,1,0] neg_lo:[0,0,1] neg_hi:[0,0,1]
    v_mfma_f32_16x16x16_bf16 v[176:179], a[244:245], v[72:73], v[176:179]
    buffer_store_dwordx4 v[136:139], v1, s[48:51], s94 offen offset:1024 sc1
    v_exp_f32_e64 v44, v44
    v_mfma_f32_16x16x16_bf16 v[180:183], a[246:247], v[72:73], v[180:183]
    v_exp_f32_e64 v45, v45
    v_mfma_f32_16x16x16_bf16 v[184:187], a[248:249], v[72:73], v[184:187]
    v_exp_f32_e64 v46, v46
    v_mfma_f32_16x16x16_bf16 v[188:191], a[250:251], v[72:73], v[188:191]
    v_exp_f32_e64 v47, v47
    v_mfma_f32_16x16x32_bf16 v[32:35], a[188:191], v[224:227], 0
    v_exp_f32_e64 v48, v48
    v_mfma_f32_16x16x32_bf16 v[36:39], a[204:207], v[224:227], 0
    v_exp_f32_e64 v49, v49
    v_mfma_f32_16x16x32_bf16 v[40:43], a[220:223], v[224:227], 0
    v_exp_f32_e64 v50, v50
    v_mfma_f32_16x16x32_bf16 v[24:27], a[160:163], v[228:231], v[24:27]
    v_exp_f32_e64 v51, v51
    v_mfma_f32_16x16x32_bf16 v[28:31], a[176:179], v[228:231], v[28:31]
    v_exp_f32_e64 v52, v52
    v_mfma_f32_16x16x32_bf16 v[32:35], a[192:195], v[228:231], v[32:35]
    buffer_store_dwordx4 v[140:143], v1, s[48:51], s95 offen offset:1024 sc1
    v_exp_f32_e64 v53, v53
    v_mfma_f32_16x16x32_bf16 v[36:39], a[208:211], v[228:231], v[36:39]
    v_exp_f32_e64 v54, v54
    v_mfma_f32_16x16x32_bf16 v[40:43], a[224:227], v[228:231], v[40:43]
    v_exp_f32_e64 v55, v55
    v_mfma_f32_16x16x32_bf16 v[24:27], a[164:167], v[232:235], v[24:27]
    v_exp_f32_e64 v56, v56
    v_mfma_f32_16x16x32_bf16 v[28:31], a[180:183], v[232:235], v[28:31]
    v_exp_f32_e64 v57, v57
    v_mfma_f32_16x16x32_bf16 v[32:35], a[196:199], v[232:235], v[32:35]
    v_exp_f32_e64 v58, v58
    v_mfma_f32_16x16x32_bf16 v[36:39], a[212:215], v[232:235], v[36:39]
    v_exp_f32_e64 v59, v59
    v_mfma_f32_16x16x32_bf16 v[40:43], a[228:231], v[232:235], v[40:43]
    v_exp_f32_e64 v60, v60
    v_mfma_f32_16x16x32_bf16 v[24:27], a[168:171], v[236:239], v[24:27]
    v_exp_f32_e64 v61, v61
    v_mfma_f32_16x16x32_bf16 v[28:31], a[184:187], v[236:239], v[28:31]
    v_exp_f32_e64 v62, v62
    v_mfma_f32_16x16x32_bf16 v[32:35], a[200:203], v[236:239], v[32:35]
    v_exp_f32_e64 v63, v63
    v_cvt_pk_bf16_f32 v163, v166, v167
    buffer_store_dwordx4 v[160:163], v1, s[48:51], s92 offen offset:2048 sc1
    ds_write_b128 v3, v[160:163] offset:2048
    v_pk_add_f32 v[90:91], v[44:45], v[46:47]
    v_pk_add_f32 v[90:91], v[90:91], v[48:49]
    v_pk_add_f32 v[90:91], v[90:91], v[50:51]
    v_pk_add_f32 v[90:91], v[90:91], v[52:53]
    v_pk_add_f32 v[90:91], v[90:91], v[54:55]
    v_pk_add_f32 v[90:91], v[90:91], v[56:57]
    v_pk_add_f32 v[90:91], v[90:91], v[58:59]
    v_pk_add_f32 v[90:91], v[90:91], v[60:61]
    v_pk_add_f32 v[90:91], v[90:91], v[62:63]
    v_mfma_f32_16x16x32_bf16 v[36:39], a[216:219], v[236:239], v[36:39]
    v_add_f32_e32 v90, v90, v91
    v_mov_b32_e32 v91, v90
    v_mfma_f32_16x16x32_bf16 v[40:43], a[232:235], v[236:239], v[40:43]
    v_cvt_pk_bf16_f32 v164, v168, v169
    v_permlane32_swap_b32_e32 v90, v91
    v_add_f32_e32 v90, v90, v91
    v_mov_b32_e64 v91, v90
    v_cvt_pk_bf16_f32 v165, v170, v171
    v_cvt_pk_bf16_f32 v166, v172, v173
    v_permlane16_swap_b32_e32 v90, v91
    v_add_f32_e32 v90, v90, v91
    v_rcp_f32_e64 v90, v90
    v_cvt_pk_bf16_f32 v167, v174, v175
    v_pk_mul_f32 v[44:45], v[44:45], v[90:91] op_sel_hi:[1,0]
    v_pk_mul_f32 v[46:47], v[46:47], v[90:91] op_sel_hi:[1,0]
    v_pk_mul_f32 v[48:49], v[48:49], v[90:91] op_sel_hi:[1,0]
    v_pk_mul_f32 v[50:51], v[50:51], v[90:91] op_sel_hi:[1,0]
    v_pk_mul_f32 v[52:53], v[52:53], v[90:91] op_sel_hi:[1,0]
    v_pk_mul_f32 v[54:55], v[54:55], v[90:91] op_sel_hi:[1,0]
    v_pk_mul_f32 v[56:57], v[56:57], v[90:91] op_sel_hi:[1,0]
    v_pk_mul_f32 v[58:59], v[58:59], v[90:91] op_sel_hi:[1,0]
    v_pk_mul_f32 v[60:61], v[60:61], v[90:91] op_sel_hi:[1,0]
    v_pk_mul_f32 v[62:63], v[62:63], v[90:91] op_sel_hi:[1,0]
    v_cvt_pk_bf16_f32 v74, v44, v45
    v_cvt_pk_bf16_f32 v75, v46, v47
    v_cvt_pk_bf16_f32 v76, v48, v49
    v_cvt_pk_bf16_f32 v77, v50, v51
    v_cvt_pk_bf16_f32 v78, v52, v53
    v_cvt_pk_bf16_f32 v79, v54, v55
    v_mfma_f32_16x16x32_bf16 v[192:195], a[0:3], v[74:77], 0
    v_cvt_pk_bf16_f32 v80, v56, v57
    v_cvt_pk_bf16_f32 v81, v58, v59
    v_mfma_f32_16x16x32_bf16 v[196:199], a[4:7], v[74:77], 0
    v_cvt_pk_bf16_f32 v82, v60, v61
    v_cvt_pk_bf16_f32 v83, v62, v63
    v_mfma_f32_16x16x32_bf16 v[200:203], a[8:11], v[74:77], 0
    buffer_store_dwordx4 v[164:167], v1, s[48:51], s93 offen offset:2048 sc1
    ds_write_b128 v3, v[164:167] offset:22528
    v_mfma_f32_16x16x32_bf16 v[204:207], a[12:15], v[74:77], 0
    v_cvt_pk_bf16_f32 v168, v176, v177
    v_cvt_pk_bf16_f32 v169, v178, v179
    v_mfma_f32_16x16x32_bf16 v[208:211], a[16:19], v[74:77], 0
    v_cvt_pk_bf16_f32 v170, v180, v181
    v_cvt_pk_bf16_f32 v171, v182, v183
    v_mfma_f32_16x16x32_bf16 v[212:215], a[20:23], v[74:77], 0
    ds_write_b128 v19, v[168:171] offset:2048
    v_mfma_f32_16x16x32_bf16 v[216:219], a[24:27], v[74:77], 0
    v_cvt_pk_bf16_f32 v172, v184, v185
    v_cvt_pk_bf16_f32 v173, v186, v187
    v_mfma_f32_16x16x32_bf16 v[220:223], a[28:31], v[74:77], 0
    v_cvt_pk_bf16_f32 v174, v188, v189
    v_cvt_pk_bf16_f32 v175, v190, v191
    v_mfma_f32_16x16x32_bf16 v[192:195], a[32:35], v[78:81], v[192:195]
    ds_write_b128 v19, v[172:175] offset:22528
    v_mfma_f32_16x16x32_bf16 v[196:199], a[36:39], v[78:81], v[196:199]
    buffer_store_dwordx4 v[168:171], v1, s[48:51], s94 offen offset:2048 sc1
    v_max3_f32 v84, v24, v25, v26
    v_mfma_f32_16x16x32_bf16 v[200:203], a[40:43], v[78:81], v[200:203]
    v_max3_f32 v85, v27, v28, v29
    v_max3_f32 v84, v84, v30, v31
    v_mfma_f32_16x16x32_bf16 v[204:207], a[44:47], v[78:81], v[204:207]
    v_max3_f32 v85, v85, v32, v33
    v_max3_f32 v84, v84, v34, v35
    v_mfma_f32_16x16x32_bf16 v[208:211], a[48:51], v[78:81], v[208:211]
    v_max3_f32 v85, v85, v36, v37
    v_max3_f32 v84, v84, v38, v39
    v_mfma_f32_16x16x32_bf16 v[212:215], a[52:55], v[78:81], v[212:215]
    v_max3_f32 v85, v85, v40, v41
    v_max3_f32 v84, v84, v42, v43
    v_mfma_f32_16x16x32_bf16 v[216:219], a[56:59], v[78:81], v[216:219]
    v_max_f32_e32 v84, v84, v85
    v_mov_b32_e32 v85, v84
    v_mfma_f32_16x16x32_bf16 v[220:223], a[60:63], v[78:81], v[220:223]
    s_nop 0
    v_permlane32_swap_b32_e32 v84, v85
    v_mfma_f32_16x16x16_bf16 v[192:195], a[236:237], v[82:83], v[192:195]
    v_max_f32_e32 v84, v84, v85
    v_mov_b32_e32 v85, v84
    v_mfma_f32_16x16x16_bf16 v[196:199], a[238:239], v[82:83], v[196:199]
    s_nop 0
    v_permlane16_swap_b32_e32 v84, v85
    v_mfma_f32_16x16x16_bf16 v[200:203], a[240:241], v[82:83], v[200:203]
    buffer_store_dwordx4 v[172:175], v1, s[48:51], s95 offen offset:2048 sc1
    v_max_f32_e64 v84, v84, v85
    v_mfma_f32_16x16x16_bf16 v[204:207], a[242:243], v[82:83], v[204:207]
    v_mul_f32_e64 v84, s83, v84
    v_cvt_pk_bf16_f32 v192, v192, v193
    v_cvt_pk_bf16_f32 v193, v194, v195
    v_cvt_pk_bf16_f32 v194, v196, v197
    v_cvt_pk_bf16_f32 v195, v198, v199
    v_pk_fma_f32 v[24:25], v[24:25], s[82:83], v[84:85] op_sel:[0,1,0] op_sel_hi:[1,1,0] neg_lo:[0,0,1] neg_hi:[0,0,1]
    v_pk_fma_f32 v[26:27], v[26:27], s[82:83], v[84:85] op_sel:[0,1,0] op_sel_hi:[1,1,0] neg_lo:[0,0,1] neg_hi:[0,0,1]
    v_pk_fma_f32 v[28:29], v[28:29], s[82:83], v[84:85] op_sel:[0,1,0] op_sel_hi:[1,1,0] neg_lo:[0,0,1] neg_hi:[0,0,1]
    v_pk_fma_f32 v[30:31], v[30:31], s[82:83], v[84:85] op_sel:[0,1,0] op_sel_hi:[1,1,0] neg_lo:[0,0,1] neg_hi:[0,0,1]
    v_pk_fma_f32 v[32:33], v[32:33], s[82:83], v[84:85] op_sel:[0,1,0] op_sel_hi:[1,1,0] neg_lo:[0,0,1] neg_hi:[0,0,1]
    v_pk_fma_f32 v[34:35], v[34:35], s[82:83], v[84:85] op_sel:[0,1,0] op_sel_hi:[1,1,0] neg_lo:[0,0,1] neg_hi:[0,0,1]
    v_pk_fma_f32 v[36:37], v[36:37], s[82:83], v[84:85] op_sel:[0,1,0] op_sel_hi:[1,1,0] neg_lo:[0,0,1] neg_hi:[0,0,1]
    v_pk_fma_f32 v[38:39], v[38:39], s[82:83], v[84:85] op_sel:[0,1,0] op_sel_hi:[1,1,0] neg_lo:[0,0,1] neg_hi:[0,0,1]
    v_pk_fma_f32 v[40:41], v[40:41], s[82:83], v[84:85] op_sel:[0,1,0] op_sel_hi:[1,1,0] neg_lo:[0,0,1] neg_hi:[0,0,1]
    v_pk_fma_f32 v[42:43], v[42:43], s[82:83], v[84:85] op_sel:[0,1,0] op_sel_hi:[1,1,0] neg_lo:[0,0,1] neg_hi:[0,0,1]
    v_mfma_f32_16x16x16_bf16 v[208:211], a[244:245], v[82:83], v[208:211]
    v_exp_f32_e64 v24, v24
    v_mfma_f32_16x16x16_bf16 v[212:215], a[246:247], v[82:83], v[212:215]
    v_exp_f32_e64 v25, v25
    v_mfma_f32_16x16x16_bf16 v[216:219], a[248:249], v[82:83], v[216:219]
    v_exp_f32_e64 v26, v26
    v_mfma_f32_16x16x16_bf16 v[220:223], a[250:251], v[82:83], v[220:223]
    v_exp_f32_e32 v27, v27
    v_exp_f32_e32 v28, v28
    v_exp_f32_e32 v29, v29
    v_exp_f32_e32 v30, v30
    v_exp_f32_e32 v31, v31
    v_exp_f32_e32 v32, v32
    v_exp_f32_e32 v33, v33
    v_exp_f32_e32 v34, v34
    v_exp_f32_e32 v35, v35
    v_exp_f32_e32 v36, v36
    v_exp_f32_e32 v37, v37
    v_exp_f32_e32 v38, v38
    v_exp_f32_e32 v39, v39
    v_exp_f32_e32 v40, v40
    v_exp_f32_e32 v41, v41
    v_exp_f32_e32 v42, v42
    v_exp_f32_e64 v43, v43
    v_pk_add_f32 v[86:87], v[24:25], v[26:27]
    v_pk_add_f32 v[86:87], v[86:87], v[28:29]
    v_pk_add_f32 v[86:87], v[86:87], v[30:31]
    v_pk_add_f32 v[86:87], v[86:87], v[32:33]
    v_pk_add_f32 v[86:87], v[86:87], v[34:35]
    v_pk_add_f32 v[86:87], v[86:87], v[36:37]
    v_pk_add_f32 v[86:87], v[86:87], v[38:39]
    v_pk_add_f32 v[86:87], v[86:87], v[40:41]
    v_pk_add_f32 v[86:87], v[86:87], v[42:43]
    v_add_f32_e32 v86, v86, v87
    v_mov_b32_e32 v87, v86
    buffer_store_dwordx4 v[192:195], v1, s[48:51], s92 offen offset:3072 sc1
    ds_write_b128 v3, v[192:195] offset:3072
    v_permlane32_swap_b32_e32 v86, v87
    v_add_f32_e32 v86, v86, v87
    v_mov_b32_e64 v87, v86
    v_cvt_pk_bf16_f32 v196, v200, v201
    v_cvt_pk_bf16_f32 v197, v202, v203
    v_permlane16_swap_b32_e32 v86, v87
    v_add_f32_e32 v86, v86, v87
    v_rcp_f32_e64 v86, v86
    v_cvt_pk_bf16_f32 v198, v204, v205
    v_pk_mul_f32 v[24:25], v[24:25], v[86:87] op_sel_hi:[1,0]
    v_pk_mul_f32 v[26:27], v[26:27], v[86:87] op_sel_hi:[1,0]
    v_pk_mul_f32 v[28:29], v[28:29], v[86:87] op_sel_hi:[1,0]
    v_pk_mul_f32 v[30:31], v[30:31], v[86:87] op_sel_hi:[1,0]
    v_pk_mul_f32 v[32:33], v[32:33], v[86:87] op_sel_hi:[1,0]
    v_pk_mul_f32 v[34:35], v[34:35], v[86:87] op_sel_hi:[1,0]
    v_pk_mul_f32 v[36:37], v[36:37], v[86:87] op_sel_hi:[1,0]
    v_pk_mul_f32 v[38:39], v[38:39], v[86:87] op_sel_hi:[1,0]
    v_pk_mul_f32 v[40:41], v[40:41], v[86:87] op_sel_hi:[1,0]
    v_pk_mul_f32 v[42:43], v[42:43], v[86:87] op_sel_hi:[1,0]
    v_cvt_pk_bf16_f32 v64, v24, v25
    v_cvt_pk_bf16_f32 v65, v26, v27
    v_cvt_pk_bf16_f32 v66, v28, v29
    v_cvt_pk_bf16_f32 v67, v30, v31
    v_cvt_pk_bf16_f32 v68, v32, v33
    v_cvt_pk_bf16_f32 v69, v34, v35
    v_mfma_f32_16x16x32_bf16 v[224:227], a[0:3], v[64:67], 0
    v_cvt_pk_bf16_f32 v70, v36, v37
    v_cvt_pk_bf16_f32 v71, v38, v39
    v_mfma_f32_16x16x32_bf16 v[228:231], a[4:7], v[64:67], 0
    v_cvt_pk_bf16_f32 v72, v40, v41
    v_cvt_pk_bf16_f32 v73, v42, v43
    v_mfma_f32_16x16x32_bf16 v[232:235], a[8:11], v[64:67], 0
    v_cvt_pk_bf16_f32 v199, v206, v207
    buffer_store_dwordx4 v[196:199], v1, s[48:51], s93 offen offset:3072 sc1
    v_mfma_f32_16x16x32_bf16 v[236:239], a[12:15], v[64:67], 0
    ds_write_b128 v3, v[196:199] offset:23552
    v_mfma_f32_16x16x32_bf16 v[240:243], a[16:19], v[64:67], 0
    v_cvt_pk_bf16_f32 v200, v208, v209
    v_cvt_pk_bf16_f32 v201, v210, v211
    v_mfma_f32_16x16x32_bf16 v[244:247], a[20:23], v[64:67], 0
    v_cvt_pk_bf16_f32 v202, v212, v213
    v_cvt_pk_bf16_f32 v203, v214, v215
    v_mfma_f32_16x16x32_bf16 v[248:251], a[24:27], v[64:67], 0
    ds_write_b128 v19, v[200:203] offset:3072
    v_mfma_f32_16x16x32_bf16 v[252:255], a[28:31], v[64:67], 0
    v_cvt_pk_bf16_f32 v204, v216, v217
    v_cvt_pk_bf16_f32 v205, v218, v219
    v_mfma_f32_16x16x32_bf16 v[224:227], a[32:35], v[68:71], v[224:227]
    v_cvt_pk_bf16_f32 v206, v220, v221
    v_cvt_pk_bf16_f32 v207, v222, v223
    v_mfma_f32_16x16x32_bf16 v[228:231], a[36:39], v[68:71], v[228:231]
    ds_write_b128 v19, v[204:207] offset:23552
    v_mfma_f32_16x16x32_bf16 v[232:235], a[40:43], v[68:71], v[232:235]
    buffer_store_dwordx4 v[200:203], v1, s[48:51], s94 offen offset:3072 sc1
    v_mfma_f32_16x16x32_bf16 v[236:239], a[44:47], v[68:71], v[236:239]
    v_mfma_f32_16x16x32_bf16 v[240:243], a[48:51], v[68:71], v[240:243]
    v_mfma_f32_16x16x32_bf16 v[244:247], a[52:55], v[68:71], v[244:247]
    v_mfma_f32_16x16x32_bf16 v[248:251], a[56:59], v[68:71], v[248:251]
    v_mfma_f32_16x16x32_bf16 v[252:255], a[60:63], v[68:71], v[252:255]
    v_mfma_f32_16x16x16_bf16 v[224:227], a[236:237], v[72:73], v[224:227]
    v_mfma_f32_16x16x16_bf16 v[228:231], a[238:239], v[72:73], v[228:231]
    v_mfma_f32_16x16x16_bf16 v[232:235], a[240:241], v[72:73], v[232:235]
    v_mfma_f32_16x16x16_bf16 v[236:239], a[242:243], v[72:73], v[236:239]
    buffer_store_dwordx4 v[204:207], v1, s[48:51], s95 offen offset:3072 sc1
    v_mfma_f32_16x16x16_bf16 v[240:243], a[244:245], v[72:73], v[240:243]
    v_mfma_f32_16x16x16_bf16 v[244:247], a[246:247], v[72:73], v[244:247]
    v_mfma_f32_16x16x16_bf16 v[248:251], a[248:249], v[72:73], v[248:251]
    s_nop 0
    s_nop 0
    v_cvt_pk_bf16_f32 v224, v224, v225
    v_mfma_f32_16x16x16_bf16 v[252:255], a[250:251], v[72:73], v[252:255]
    v_cvt_pk_bf16_f32 v225, v226, v227
    v_cvt_pk_bf16_f32 v226, v228, v229
    v_cvt_pk_bf16_f32 v227, v230, v231
    ds_write_b128 v3, v[224:227] offset:4096
    v_cvt_pk_bf16_f32 v228, v232, v233
    v_cvt_pk_bf16_f32 v229, v234, v235
    v_cvt_pk_bf16_f32 v230, v236, v237
    v_cvt_pk_bf16_f32 v231, v238, v239
    ds_write_b128 v3, v[228:231] offset:24576
    v_cvt_pk_bf16_f32 v232, v240, v241
    v_cvt_pk_bf16_f32 v233, v242, v243
    v_cvt_pk_bf16_f32 v234, v244, v245
    v_cvt_pk_bf16_f32 v235, v246, v247
    buffer_store_dwordx4 v[224:227], v2, s[48:51], s92 offen offset:0 sc1
    ds_write_b128 v19, v[232:235] offset:4096
    v_cvt_pk_bf16_f32 v236, v248, v249
    v_cvt_pk_bf16_f32 v237, v250, v251
    v_cvt_pk_bf16_f32 v238, v252, v253
    v_cvt_pk_bf16_f32 v239, v254, v255
    ds_write_b128 v19, v[236:239] offset:24576
    buffer_store_dwordx4 v[228:231], v2, s[48:51], s93 offen offset:0 sc1
    buffer_store_dwordx4 v[232:235], v2, s[48:51], s94 offen offset:0 sc1
    buffer_store_dwordx4 v[236:239], v2, s[48:51], s95 offen offset:0 sc1
    s_waitcnt vmcnt(30) lgkmcnt(0)
    s_barrier
    ds_read_b128 a[160:163], v5 offset:0
    ds_read_b128 a[180:183], v5 offset:10240
    ds_read_b64_tr_b16 a[0:1], v8 offset:0
    ds_read_b64_tr_b16 a[2:3], v8 offset:5120
    ds_read_b64_tr_b16 a[20:21], v8 offset:10240
    ds_read_b64_tr_b16 a[22:23], v8 offset:15360
    ds_read_b64_tr_b16 a[4:5], v9 offset:32
    ds_read_b64_tr_b16 a[6:7], v9 offset:5152
    ds_read_b64_tr_b16 a[24:25], v9 offset:10272
    ds_read_b64_tr_b16 a[26:27], v9 offset:15392
    ds_read_b64_tr_b16 a[8:9], v8 offset:64
    ds_read_b64_tr_b16 a[10:11], v8 offset:5184
    s_waitcnt lgkmcnt(8)
    v_mfma_f32_16x16x32_bf16 v[156:159], a[0:3], a[160:163], 0
    ds_read_b64_tr_b16 a[28:29], v8 offset:10304
    ds_read_b64_tr_b16 a[30:31], v8 offset:15424
    s_waitcnt lgkmcnt(8)
    v_mfma_f32_16x16x32_bf16 v[156:159], a[20:23], a[180:183], v[156:159]
    ds_read_b128 a[164:167], v15 offset:0
    ds_read_b128 a[184:187], v15 offset:10240
    s_waitcnt lgkmcnt(8)
    v_mfma_f32_16x16x32_bf16 v[160:163], a[4:7], a[160:163], 0
    ds_read_b64_tr_b16 a[12:13], v9 offset:96
    ds_read_b64_tr_b16 a[14:15], v9 offset:5216
    s_waitcnt lgkmcnt(8)
    v_mfma_f32_16x16x32_bf16 v[160:163], a[24:27], a[180:183], v[160:163]
    ds_read_b64_tr_b16 a[32:33], v9 offset:10336
    ds_read_b64_tr_b16 a[34:35], v9 offset:15456
    s_waitcnt lgkmcnt(8)
    v_mfma_f32_16x16x32_bf16 v[164:167], a[8:11], a[160:163], 0
    ds_read_b64_tr_b16 a[16:17], v8 offset:128
    ds_read_b64_tr_b16 a[18:19], v8 offset:5248
    s_waitcnt lgkmcnt(8)
    v_mfma_f32_16x16x32_bf16 v[164:167], a[28:31], a[180:183], v[164:167]
    ds_read_b64_tr_b16 a[36:37], v8 offset:10368
    ds_read_b64_tr_b16 a[38:39], v8 offset:15488
    s_waitcnt lgkmcnt(6)
    v_mfma_f32_16x16x32_bf16 v[168:171], a[12:15], a[160:163], 0
    ds_read_b128 a[168:171], v92 offset:0
    ds_read_b128 a[188:191], v92 offset:10240
    s_waitcnt lgkmcnt(6)
    v_mfma_f32_16x16x32_bf16 v[168:171], a[32:35], a[180:183], v[168:171]
    ds_read_b128 a[172:175], v93 offset:0
    ds_read_b128 a[192:195], v93 offset:10240
    s_waitcnt lgkmcnt(6)
    v_mfma_f32_16x16x32_bf16 v[172:175], a[16:19], a[160:163], 0
    ds_read_b128 a[176:179], v7 offset:4096
    ds_read_b128 a[196:199], v7 offset:14336
    s_waitcnt lgkmcnt(6)
    v_mfma_f32_16x16x32_bf16 v[172:175], a[36:39], a[180:183], v[172:175]
    ds_read_b64_tr_b16 a[40:41], v8 offset:20480
    ds_read_b64_tr_b16 a[42:43], v8 offset:25600
    v_mfma_f32_16x16x32_bf16 v[176:179], a[0:3], a[164:167], 0
    ds_read_b64_tr_b16 a[44:45], v9 offset:20512
    v_mfma_f32_16x16x32_bf16 v[176:179], a[20:23], a[184:187], v[176:179]
    ds_read_b64_tr_b16 a[46:47], v9 offset:25632
    ds_read_b64_tr_b16 a[48:49], v8 offset:20544
    v_mfma_f32_16x16x32_bf16 v[180:183], a[4:7], a[164:167], 0
    ds_read_b64_tr_b16 a[50:51], v8 offset:25664
    v_mfma_f32_16x16x32_bf16 v[180:183], a[24:27], a[184:187], v[180:183]
    ds_read_b64_tr_b16 a[52:53], v9 offset:20576
    ds_read_b64_tr_b16 a[54:55], v9 offset:25696
    v_mfma_f32_16x16x32_bf16 v[184:187], a[8:11], a[164:167], 0
    ds_read_b64_tr_b16 a[56:57], v8 offset:20608
    v_mfma_f32_16x16x32_bf16 v[184:187], a[28:31], a[184:187], v[184:187]
    ds_read_b64_tr_b16 a[58:59], v8 offset:25728
    v_mfma_f32_16x16x32_bf16 v[188:191], a[12:15], a[164:167], 0
    ds_read_b64_tr_b16 a[60:61], v8 offset:30720
    ds_read_b64_tr_b16 a[62:63], v8 offset:35840
    v_mfma_f32_16x16x32_bf16 v[188:191], a[32:35], a[184:187], v[188:191]
    ds_read_b64_tr_b16 a[64:65], v9 offset:30752
    v_mfma_f32_16x16x32_bf16 v[192:195], a[16:19], a[164:167], 0
    ds_read_b64_tr_b16 a[66:67], v9 offset:35872
    ds_read_b64_tr_b16 a[68:69], v8 offset:30784
    v_mfma_f32_16x16x32_bf16 v[192:195], a[36:39], a[184:187], v[192:195]
    ds_read_b64_tr_b16 a[70:71], v8 offset:35904
    s_waitcnt lgkmcnt(14)
    s_nop 0
    v_mfma_f32_16x16x32_bf16 v[196:199], a[0:3], a[168:171], 0
    ds_read_b64_tr_b16 a[72:73], v9 offset:30816
    ds_read_b64_tr_b16 a[74:75], v9 offset:35936
    v_mfma_f32_16x16x32_bf16 v[196:199], a[20:23], a[188:191], v[196:199]
    ds_read_b64_tr_b16 a[76:77], v8 offset:30848
    v_mfma_f32_16x16x32_bf16 v[200:203], a[4:7], a[168:171], 0
    ds_read_b64_tr_b16 a[78:79], v8 offset:35968
    v_mfma_f32_16x16x32_bf16 v[200:203], a[24:27], a[188:191], v[200:203]
    v_mfma_f32_16x16x32_bf16 v[204:207], a[8:11], a[168:171], 0
    v_mfma_f32_16x16x32_bf16 v[204:207], a[28:31], a[188:191], v[204:207]
    s_waitcnt vmcnt(20) lgkmcnt(0)
    s_barrier
    v_mfma_f32_16x16x32_bf16 v[208:211], a[12:15], a[168:171], 0
    ds_read_b64_tr_b16 a[80:81], v16 offset:0
    s_add_u32 s68, s98, s28
    s_nop 0
    v_mfma_f32_16x16x32_bf16 v[208:211], a[32:35], a[188:191], v[208:211]
    ds_read_b128 a[200:203], v5 offset:20480
    ds_read_b64_tr_b16 a[82:83], v16 offset:5120
    v_mfma_f32_16x16x32_bf16 v[212:215], a[16:19], a[168:171], 0
    ds_read_b64_tr_b16 a[84:85], v17 offset:32
    s_add_u32 m0, s88, 82048
    v_mfma_f32_16x16x32_bf16 v[212:215], a[36:39], a[188:191], v[212:215]
    ds_read_b128 a[204:207], v15 offset:20480
    ds_read_b64_tr_b16 a[86:87], v17 offset:5152
    v_mfma_f32_16x16x32_bf16 v[216:219], a[0:3], a[172:175], 0
    ds_read_b64_tr_b16 a[88:89], v16 offset:64
    ds_read_b128 a[208:211], v92 offset:20480
    v_mfma_f32_16x16x32_bf16 v[216:219], a[20:23], a[192:195], v[216:219]
    buffer_load_dwordx4 v10, s[52:55], s68 offen offset:0 lds
    v_mfma_f32_16x16x32_bf16 v[220:223], a[4:7], a[172:175], 0
    ds_read_b64_tr_b16 a[90:91], v16 offset:5184
    ds_read_b64_tr_b16 a[92:93], v17 offset:96
    v_mfma_f32_16x16x32_bf16 v[220:223], a[24:27], a[192:195], v[220:223]
    ds_read_b128 a[212:215], v93 offset:20480
    ds_read_b64_tr_b16 a[94:95], v17 offset:5216
    v_mfma_f32_16x16x32_bf16 v[224:227], a[8:11], a[172:175], 0
    buffer_load_dwordx4 v11, s[52:55], s68 offen offset:1024 lds
    ds_read_b64_tr_b16 a[96:97], v16 offset:128
    v_mfma_f32_16x16x32_bf16 v[224:227], a[28:31], a[192:195], v[224:227]
    ds_read_b128 a[216:219], v7 offset:24576
    ds_read_b64_tr_b16 a[98:99], v16 offset:5248
    v_mfma_f32_16x16x32_bf16 v[228:231], a[12:15], a[172:175], 0
    ds_read_b64_tr_b16 a[100:101], v16 offset:10240
    v_mfma_f32_16x16x32_bf16 v[228:231], a[32:35], a[192:195], v[228:231]
    buffer_load_dwordx4 v12, s[52:55], s68 offen offset:2048 lds
    ds_read_b128 a[220:223], v5 offset:30720
    v_mfma_f32_16x16x32_bf16 v[232:235], a[16:19], a[172:175], 0
    ds_read_b64_tr_b16 a[102:103], v16 offset:15360
    ds_read_b64_tr_b16 a[104:105], v17 offset:10272
    v_mfma_f32_16x16x32_bf16 v[232:235], a[36:39], a[192:195], v[232:235]
    buffer_load_dwordx4 v13, s[52:55], s68 offen offset:3072 lds
    ds_read_b128 a[224:227], v15 offset:30720
    v_mfma_f32_16x16x32_bf16 v[236:239], a[0:3], a[176:179], 0
    ds_read_b64_tr_b16 a[106:107], v17 offset:15392
    ds_read_b64_tr_b16 a[108:109], v16 offset:10304
    v_mfma_f32_16x16x32_bf16 v[236:239], a[20:23], a[196:199], v[236:239]
    ds_read_b128 a[228:231], v92 offset:30720
    v_mfma_f32_16x16x32_bf16 v[240:243], a[4:7], a[176:179], 0
    s_add_u32 m0, s88, 86144
    ds_read_b64_tr_b16 a[110:111], v16 offset:15424
    v_mfma_f32_16x16x32_bf16 v[240:243], a[24:27], a[196:199], v[240:243]
    ds_read_b64_tr_b16 a[112:113], v17 offset:10336
    ds_read_b128 a[232:235], v93 offset:30720
    v_mfma_f32_16x16x32_bf16 v[244:247], a[8:11], a[176:179], 0
    ds_read_b64_tr_b16 a[114:115], v17 offset:15456
    buffer_load_dwordx4 v14, s[52:55], s68 offen offset:0 lds
    v_mfma_f32_16x16x32_bf16 v[244:247], a[28:31], a[196:199], v[244:247]
    ds_read_b64_tr_b16 a[116:117], v16 offset:10368
    ds_read_b128 a[236:239], v7 offset:34816
    v_mfma_f32_16x16x32_bf16 v[248:251], a[12:15], a[176:179], 0
    ds_read_b64_tr_b16 a[118:119], v16 offset:15488
    v_mfma_f32_16x16x32_bf16 v[248:251], a[32:35], a[196:199], v[248:251]
    v_mfma_f32_16x16x32_bf16 v[252:255], a[16:19], a[176:179], 0
    v_mfma_f32_16x16x32_bf16 v[252:255], a[36:39], a[196:199], v[252:255]
    s_waitcnt vmcnt(5) lgkmcnt(0)
    s_nop 0
    s_and_b64 s[20:21], s[20:21], s[22:23]
    s_and_b64 s[24:25], s[24:25], s[26:27]
    s_and_b64 s[20:21], s[20:21], s[24:25]
    s_and_b32 s20, s20, s21
    s_cmp_eq_u32 s20, 1
    s_cbranch_scc1 L_ok0
    s_mov_b32 s91, 0
L_spin0:
    s_buffer_load_dwordx8 s[20:27], s[60:63], 0 glc
    s_waitcnt lgkmcnt(0)
    s_and_b64 s[20:21], s[20:21], s[22:23]
    s_and_b64 s[24:25], s[24:25], s[26:27]
    s_and_b64 s[20:21], s[20:21], s[24:25]
    s_and_b32 s20, s20, s21
L_pad4:
    s_cbranch_execz L_back
    s_nop 0
    s_cmp_eq_u32 s20, 1
    s_cbranch_scc1 L_ok0
    s_add_u32 s91, s91, 1
    s_cmp_lt_u32 s91, 250000
    s_cbranch_scc1 L_spin0
.p2align 3
L_ok0:
    buffer_store_dword v6, v4, s[48:51], s90 offen sc1
    v_mfma_f32_16x16x32_bf16 v[156:159], a[40:43], a[200:203], v[156:159]
    ds_read_b64_tr_b16 a[120:121], v16 offset:20480
    s_add_u32 s68, s99, s28
    s_nop 0
    v_mfma_f32_16x16x32_bf16 v[156:159], a[60:63], a[220:223], v[156:159]
    ds_read_b64_tr_b16 a[122:123], v16 offset:25600
    v_mfma_f32_16x16x32_bf16 v[160:163], a[44:47], a[200:203], v[160:163]
    ds_read_b64_tr_b16 a[124:125], v17 offset:20512
    v_mfma_f32_16x16x32_bf16 v[160:163], a[64:67], a[220:223], v[160:163]
    s_add_u32 m0, s88, 102528
    ds_read_b64_tr_b16 a[126:127], v17 offset:25632
    v_mfma_f32_16x16x32_bf16 v[164:167], a[48:51], a[200:203], v[164:167]
    ds_read_b64_tr_b16 a[128:129], v16 offset:20544
    v_mfma_f32_16x16x32_bf16 v[164:167], a[68:71], a[220:223], v[164:167]
    ds_read_b64_tr_b16 a[130:131], v16 offset:25664
    v_mfma_f32_16x16x32_bf16 v[168:171], a[52:55], a[200:203], v[168:171]
    buffer_load_dwordx4 v10, s[52:55], s68 offen offset:0 lds
    ds_read_b64_tr_b16 a[132:133], v17 offset:20576
    v_mfma_f32_16x16x32_bf16 v[168:171], a[72:75], a[220:223], v[168:171]
    ds_read_b64_tr_b16 a[134:135], v17 offset:25696
    v_mfma_f32_16x16x32_bf16 v[172:175], a[56:59], a[200:203], v[172:175]
    buffer_load_dwordx4 v11, s[52:55], s68 offen offset:1024 lds
    v_mfma_f32_16x16x32_bf16 v[172:175], a[76:79], a[220:223], v[172:175]
    ds_read_b64_tr_b16 a[136:137], v16 offset:20608
    ds_read_b64_tr_b16 a[138:139], v16 offset:25728
    v_mfma_f32_16x16x32_bf16 v[176:179], a[40:43], a[204:207], v[176:179]
    ds_read_b64_tr_b16 a[140:141], v16 offset:30720
    v_mfma_f32_16x16x32_bf16 v[176:179], a[60:63], a[224:227], v[176:179]
    buffer_load_dwordx4 v12, s[52:55], s68 offen offset:2048 lds
    v_mfma_f32_16x16x32_bf16 v[180:183], a[44:47], a[204:207], v[180:183]
    ds_read_b64_tr_b16 a[142:143], v16 offset:35840
    ds_read_b64_tr_b16 a[144:145], v17 offset:30752
    v_mfma_f32_16x16x32_bf16 v[180:183], a[64:67], a[224:227], v[180:183]
    buffer_load_dwordx4 v13, s[52:55], s68 offen offset:3072 lds
    v_mfma_f32_16x16x32_bf16 v[184:187], a[48:51], a[204:207], v[184:187]
    ds_read_b64_tr_b16 a[146:147], v17 offset:35872
    v_mfma_f32_16x16x32_bf16 v[184:187], a[68:71], a[224:227], v[184:187]
    ds_read_b64_tr_b16 a[148:149], v16 offset:30784
    ds_read_b64_tr_b16 a[150:151], v16 offset:35904
    v_mfma_f32_16x16x32_bf16 v[188:191], a[52:55], a[204:207], v[188:191]
    s_add_u32 m0, s88, 106624
    v_mfma_f32_16x16x32_bf16 v[188:191], a[72:75], a[224:227], v[188:191]
    ds_read_b64_tr_b16 a[152:153], v17 offset:30816
    v_mfma_f32_16x16x32_bf16 v[192:195], a[56:59], a[204:207], v[192:195]
    ds_read_b64_tr_b16 a[154:155], v17 offset:35936
    buffer_load_dwordx4 v14, s[52:55], s68 offen offset:0 lds
    v_mfma_f32_16x16x32_bf16 v[192:195], a[76:79], a[224:227], v[192:195]
    ds_read_b64_tr_b16 a[156:157], v16 offset:30848
    v_mfma_f32_16x16x32_bf16 v[196:199], a[40:43], a[208:211], v[196:199]
    ds_read_b64_tr_b16 a[158:159], v16 offset:35968
    v_mfma_f32_16x16x32_bf16 v[196:199], a[60:63], a[228:231], v[196:199]
    v_mfma_f32_16x16x32_bf16 v[200:203], a[44:47], a[208:211], v[200:203]
    v_mfma_f32_16x16x32_bf16 v[200:203], a[64:67], a[228:231], v[200:203]
    v_mfma_f32_16x16x32_bf16 v[204:207], a[48:51], a[208:211], v[204:207]
    v_mfma_f32_16x16x32_bf16 v[204:207], a[68:71], a[228:231], v[204:207]
    s_waitcnt vmcnt(6) lgkmcnt(0)
    s_barrier
    v_mfma_f32_16x16x32_bf16 v[208:211], a[52:55], a[208:211], v[208:211]
    ds_read_b128 a[160:163], v20 offset:0
    v_mfma_f32_16x16x32_bf16 v[208:211], a[72:75], a[228:231], v[208:211]
    s_add_u32 s68, s100, s28
    s_nop 0
    v_mfma_f32_16x16x32_bf16 v[212:215], a[56:59], a[208:211], v[212:215]
    ds_read_b128 a[164:167], v21 offset:0
    v_mfma_f32_16x16x32_bf16 v[212:215], a[76:79], a[228:231], v[212:215]
    s_add_u32 m0, s88, 123008
    v_mfma_f32_16x16x32_bf16 v[216:219], a[40:43], a[212:215], v[216:219]
    ds_read_b128 a[168:171], v22 offset:0
    v_mfma_f32_16x16x32_bf16 v[216:219], a[60:63], a[232:235], v[216:219]
    buffer_load_dwordx4 v10, s[52:55], s68 offen offset:0 lds
    v_mfma_f32_16x16x32_bf16 v[220:223], a[44:47], a[212:215], v[220:223]
    v_mfma_f32_16x16x32_bf16 v[220:223], a[64:67], a[232:235], v[220:223]
    ds_read_b128 a[172:175], v23 offset:0
    v_mfma_f32_16x16x32_bf16 v[224:227], a[48:51], a[212:215], v[224:227]
    buffer_load_dwordx4 v11, s[52:55], s68 offen offset:1024 lds
    v_mfma_f32_16x16x32_bf16 v[224:227], a[68:71], a[232:235], v[224:227]
    ds_read_b128 a[176:179], v18 offset:4096
    v_mfma_f32_16x16x32_bf16 v[228:231], a[52:55], a[212:215], v[228:231]
    ds_read_b128 a[180:183], v20 offset:10240
    v_mfma_f32_16x16x32_bf16 v[228:231], a[72:75], a[232:235], v[228:231]
    buffer_load_dwordx4 v12, s[52:55], s68 offen offset:2048 lds
    v_mfma_f32_16x16x32_bf16 v[232:235], a[56:59], a[212:215], v[232:235]
    ds_read_b128 a[184:187], v21 offset:10240
    v_mfma_f32_16x16x32_bf16 v[232:235], a[76:79], a[232:235], v[232:235]
    v_mfma_f32_16x16x32_bf16 v[236:239], a[40:43], a[216:219], v[236:239]
    buffer_load_dwordx4 v13, s[52:55], s68 offen offset:3072 lds
    v_mfma_f32_16x16x32_bf16 v[236:239], a[60:63], a[236:239], v[236:239]
    ds_read_b128 a[188:191], v22 offset:10240
    v_mfma_f32_16x16x32_bf16 v[240:243], a[44:47], a[216:219], v[240:243]
    s_add_u32 m0, s88, 127104
    v_mfma_f32_16x16x32_bf16 v[240:243], a[64:67], a[236:239], v[240:243]
    ds_read_b128 a[192:195], v23 offset:10240
    v_mfma_f32_16x16x32_bf16 v[244:247], a[48:51], a[216:219], v[244:247]
    buffer_load_dwordx4 v14, s[52:55], s68 offen offset:0 lds
    v_mfma_f32_16x16x32_bf16 v[244:247], a[68:71], a[236:239], v[244:247]
    ds_read_b128 a[196:199], v18 offset:14336
    v_mfma_f32_16x16x32_bf16 v[248:251], a[52:55], a[216:219], v[248:251]
    v_mfma_f32_16x16x32_bf16 v[248:251], a[72:75], a[236:239], v[248:251]
    v_mfma_f32_16x16x32_bf16 v[252:255], a[56:59], a[216:219], v[252:255]
    v_mfma_f32_16x16x32_bf16 v[252:255], a[76:79], a[236:239], v[252:255]
    s_waitcnt lgkmcnt(0)
    s_nop 0
    v_mfma_f32_16x16x32_bf16 v[156:159], a[80:83], a[160:163], v[156:159]
    ds_read_b64_tr_b16 a[0:1], v8 offset:0
    s_buffer_load_dwordx4 s[12:15], s[48:51], s9 offset:32 glc
    v_mfma_f32_16x16x32_bf16 v[156:159], a[100:103], a[180:183], v[156:159]
    v_cmp_eq_u32 vcc, 0, v0
    ds_read_b64_tr_b16 a[2:3], v8 offset:5120
    v_mfma_f32_16x16x32_bf16 v[160:163], a[84:87], a[160:163], v[160:163]
    v_mov_b32 v91, 0x7ffffff0
    s_add_u32 s68, s98, s29
    s_nop 0
    s_nop 0
    v_mfma_f32_16x16x32_bf16 v[160:163], a[104:107], a[180:183], v[160:163]
    ds_read_b64_tr_b16 a[4:5], v9 offset:32
    ds_read_b64_tr_b16 a[6:7], v9 offset:5152
    v_mfma_f32_16x16x32_bf16 v[164:167], a[88:91], a[160:163], v[164:167]
    v_lshlrev_b32_e64 v26, 1, v0
    ds_read_b64_tr_b16 a[8:9], v8 offset:64
    v_mfma_f32_16x16x32_bf16 v[164:167], a[108:111], a[180:183], v[164:167]
    s_add_u32 m0, s88, 143488
    ds_read_b64_tr_b16 a[10:11], v8 offset:5184
    v_mfma_f32_16x16x32_bf16 v[168:171], a[92:95], a[160:163], v[168:171]
    v_cndmask_b32 v24, v91, v0, vcc
    ds_read_b64_tr_b16 a[12:13], v9 offset:96
    v_mfma_f32_16x16x32_bf16 v[168:171], a[112:115], a[180:183], v[168:171]
    buffer_load_dwordx4 v10, s[52:55], s68 offen offset:0 lds
    v_lshrrev_b32_e32 v84, 2, v0
    v_mfma_f32_16x16x32_bf16 v[172:175], a[96:99], a[160:163], v[172:175]
    ds_read_b64_tr_b16 a[14:15], v9 offset:5216
    ds_read_b64_tr_b16 a[16:17], v8 offset:128
    v_mfma_f32_16x16x32_bf16 v[172:175], a[116:119], a[180:183], v[172:175]
    v_subrev_u32 v84, s65, v84
    s_nop 0
    buffer_load_dwordx4 v11, s[52:55], s68 offen offset:1024 lds
    v_mfma_f32_16x16x32_bf16 v[176:179], a[80:83], a[164:167], v[176:179]
    ds_read_b64_tr_b16 a[18:19], v8 offset:5248
    ds_read_b64_tr_b16 a[20:21], v8 offset:10240
    v_mfma_f32_16x16x32_bf16 v[176:179], a[100:103], a[184:187], v[176:179]
    v_and_b32_e64 v84, 3, v84
    buffer_load_dwordx4 v12, s[52:55], s68 offen offset:2048 lds
    v_mfma_f32_16x16x32_bf16 v[180:183], a[84:87], a[164:167], v[180:183]
    ds_read_b64_tr_b16 a[22:23], v8 offset:15360
    v_lshlrev_b32_e64 v84, 2, v84
    v_mfma_f32_16x16x32_bf16 v[180:183], a[104:107], a[184:187], v[180:183]
    ds_read_b64_tr_b16 a[24:25], v9 offset:10272
    ds_read_b64_tr_b16 a[26:27], v9 offset:15392
    v_mfma_f32_16x16x32_bf16 v[184:187], a[88:91], a[164:167], v[184:187]
    buffer_load_dwordx4 v13, s[52:55], s68 offen offset:3072 lds
    v_cmp_gt_u32 vcc, 16, v0
    s_nop 0
    v_mfma_f32_16x16x32_bf16 v[184:187], a[108:111], a[184:187], v[184:187]
    ds_read_b64_tr_b16 a[28:29], v8 offset:10304
    ds_read_b64_tr_b16 a[30:31], v8 offset:15424
    v_mfma_f32_16x16x32_bf16 v[188:191], a[92:95], a[164:167], v[188:191]
    s_add_u32 m0, s88, 147584
    v_lshl_add_u32 v85, v0, 11, v84
    v_mfma_f32_16x16x32_bf16 v[188:191], a[112:115], a[184:187], v[188:191]
    ds_read_b64_tr_b16 a[32:33], v9 offset:10336
    v_bfe_u32 v84, v0, 4, 2
    v_mfma_f32_16x16x32_bf16 v[192:195], a[96:99], a[164:167], v[192:195]
    ds_read_b64_tr_b16 a[34:35], v9 offset:15456
    buffer_load_dwordx4 v14, s[52:55], s68 offen offset:0 lds
    v_mfma_f32_16x16x32_bf16 v[192:195], a[116:119], a[184:187], v[192:195]
    ds_read_b64_tr_b16 a[36:37], v8 offset:10368
    v_cndmask_b32 v88, v91, v85, vcc
    s_nop 0
    v_mfma_f32_16x16x32_bf16 v[196:199], a[80:83], a[168:171], v[196:199]
    ds_read_b64_tr_b16 a[38:39], v8 offset:15488
    v_mfma_f32_16x16x32_bf16 v[196:199], a[100:103], a[188:191], v[196:199]
    v_mfma_f32_16x16x32_bf16 v[200:203], a[84:87], a[168:171], v[200:203]
    v_mfma_f32_16x16x32_bf16 v[200:203], a[104:107], a[188:191], v[200:203]
    v_mfma_f32_16x16x32_bf16 v[204:207], a[88:91], a[168:171], v[204:207]
    v_mfma_f32_16x16x32_bf16 v[204:207], a[108:111], a[188:191], v[204:207]
    s_waitcnt vmcnt(10) lgkmcnt(0)
    s_barrier
    s_cmp_eq_u32 s13, 1
    s_cbranch_scc1 L_ok1
    s_mov_b32 s91, 0
L_spin1:
    s_buffer_load_dwordx4 s[12:15], s[48:51], s9 offset:32 glc
    s_waitcnt lgkmcnt(0)
    s_cmp_eq_u32 s13, 1
    s_cbranch_scc1 L_ok1
    s_add_u32 s91, s91, 1
    s_cmp_lt_u32 s91, 250000
    s_cbranch_scc1 L_spin1
.p2align 3
L_ok1:
    v_mfma_f32_16x16x32_bf16 v[208:211], a[92:95], a[168:171], v[208:211]
    ds_read_b128 a[200:203], v20 offset:20480
    s_add_u32 s69, s30, 128
    v_mfma_f32_16x16x32_bf16 v[208:211], a[112:115], a[188:191], v[208:211]
    v_cmp_eq_u32_e64 s[72:73], s65, v84
    v_mfma_f32_16x16x32_bf16 v[212:215], a[96:99], a[168:171], v[212:215]
    v_lshrrev_b32_e64 v85, 6, v0
    s_add_u32 m0, s88, 128
    v_mfma_f32_16x16x32_bf16 v[212:215], a[116:119], a[188:191], v[212:215]
    ds_read_b128 a[204:207], v21 offset:20480
    v_mfma_f32_16x16x32_bf16 v[216:219], a[80:83], a[172:175], v[216:219]
    v_bfe_u32 v86, v0, 2, 2
    ds_read_b128 a[208:211], v22 offset:20480
    v_mfma_f32_16x16x32_bf16 v[216:219], a[100:103], a[192:195], v[216:219]
    buffer_load_dwordx4 v1, s[48:51], s69 offen offset:0 sc1 lds
    v_mfma_f32_16x16x32_bf16 v[220:223], a[84:87], a[172:175], v[220:223]
    v_lshl_add_u32 v87, v85, 2, v86
    v_mfma_f32_16x16x32_bf16 v[220:223], a[104:107], a[192:195], v[220:223]
    ds_read_b128 a[212:215], v23 offset:20480
    v_lshlrev_b32_e64 v87, 4, v87
    v_mfma_f32_16x16x32_bf16 v[224:227], a[88:91], a[172:175], v[224:227]
    buffer_load_dwordx4 v1, s[48:51], s69 offen offset:1024 sc1 lds
    v_mfma_f32_16x16x32_bf16 v[224:227], a[108:111], a[192:195], v[224:227]
    ds_read_b128 a[216:219], v18 offset:24576
    v_add_u32 v87, 2560, v87
    v_mfma_f32_16x16x32_bf16 v[228:231], a[92:95], a[172:175], v[228:231]
    ds_read_b128 a[220:223], v20 offset:30720
    v_mfma_f32_16x16x32_bf16 v[228:231], a[112:115], a[192:195], v[228:231]
    buffer_load_dwordx4 v1, s[48:51], s69 offen offset:2048 sc1 lds
    v_lshl_add_u32 v25, v84, 14, v87
    v_mfma_f32_16x16x32_bf16 v[232:235], a[96:99], a[172:175], v[232:235]
    v_lshl_add_u32 v27, v84, 12, v87
    v_mfma_f32_16x16x32_bf16 v[232:235], a[116:119], a[192:195], v[232:235]
    buffer_load_dwordx4 v1, s[48:51], s69 offen offset:3072 sc1 lds
    v_mfma_f32_16x16x32_bf16 v[236:239], a[80:83], a[176:179], v[236:239]
    ds_read_b128 a[224:227], v21 offset:30720
    v_cndmask_b32_e64 v25, v25, v91, s[72:73]
    v_mfma_f32_16x16x32_bf16 v[236:239], a[100:103], a[196:199], v[236:239]
    ds_read_b128 a[228:231], v22 offset:30720
    v_mfma_f32_16x16x32_bf16 v[240:243], a[84:87], a[176:179], v[240:243]
    s_add_u32 m0, s88, 4224
    v_cndmask_b32_e64 v27, v27, v91, s[72:73]
    v_mfma_f32_16x16x32_bf16 v[240:243], a[104:107], a[196:199], v[240:243]
    ds_read_b128 a[232:235], v23 offset:30720
    v_mfma_f32_16x16x32_bf16 v[244:247], a[88:91], a[176:179], v[244:247]
    s_lshl_b32 s10, s3, 12
    s_nop 0
    buffer_load_dwordx4 v2, s[48:51], s69 offen offset:0 sc1 lds
    v_mfma_f32_16x16x32_bf16 v[244:247], a[108:111], a[196:199], v[244:247]
    ds_read_b128 a[236:239], v18 offset:34816
    v_mfma_f32_16x16x32_bf16 v[248:251], a[92:95], a[176:179], v[248:251]
    s_add_u32 s10, s10, 81920
    v_mfma_f32_16x16x32_bf16 v[248:251], a[112:115], a[196:199], v[248:251]
    v_mfma_f32_16x16x32_bf16 v[252:255], a[96:99], a[176:179], v[252:255]
    v_mfma_f32_16x16x32_bf16 v[252:255], a[116:119], a[196:199], v[252:255]
    s_waitcnt lgkmcnt(0)
    s_nop 0
    s_cmp_eq_u32 s14, 1
    s_cbranch_scc1 L_ok2
    s_mov_b32 s91, 0
L_spin2:
    s_buffer_load_dwordx4 s[12:15], s[48:51], s9 offset:32 glc
    s_waitcnt lgkmcnt(0)
    s_cmp_eq_u32 s14, 1
    s_cbranch_scc1 L_ok2
    s_add_u32 s91, s91, 1
    s_cmp_lt_u32 s91, 250000
    s_cbranch_scc1 L_spin2
.p2align 3
L_ok2:
    v_mfma_f32_16x16x32_bf16 v[156:159], a[120:123], a[200:203], v[156:159]
    ds_read_b64_tr_b16 a[40:41], v8 offset:20480
    s_add_u32 s69, s31, 128
    v_mfma_f32_16x16x32_bf16 v[156:159], a[140:143], a[220:223], v[156:159]
    ds_read_b64_tr_b16 a[42:43], v8 offset:25600
    v_mfma_f32_16x16x32_bf16 v[160:163], a[124:127], a[200:203], v[160:163]
    ds_read_b64_tr_b16 a[44:45], v9 offset:20512
    v_mfma_f32_16x16x32_bf16 v[160:163], a[144:147], a[220:223], v[160:163]
    s_add_u32 m0, s88, 20608
    ds_read_b64_tr_b16 a[46:47], v9 offset:25632
    v_mfma_f32_16x16x32_bf16 v[164:167], a[128:131], a[200:203], v[164:167]
    ds_read_b64_tr_b16 a[48:49], v8 offset:20544
    v_mfma_f32_16x16x32_bf16 v[164:167], a[148:151], a[220:223], v[164:167]
    ds_read_b64_tr_b16 a[50:51], v8 offset:25664
    v_mfma_f32_16x16x32_bf16 v[168:171], a[132:135], a[200:203], v[168:171]
    buffer_load_dwordx4 v1, s[48:51], s69 offen offset:0 sc1 lds
    ds_read_b64_tr_b16 a[52:53], v9 offset:20576
    v_mfma_f32_16x16x32_bf16 v[168:171], a[152:155], a[220:223], v[168:171]
    ds_read_b64_tr_b16 a[54:55], v9 offset:25696
    v_mfma_f32_16x16x32_bf16 v[172:175], a[136:139], a[200:203], v[172:175]
    buffer_load_dwordx4 v1, s[48:51], s69 offen offset:1024 sc1 lds
    v_mfma_f32_16x16x32_bf16 v[172:175], a[156:159], a[220:223], v[172:175]
    ds_read_b64_tr_b16 a[56:57], v8 offset:20608
    ds_read_b64_tr_b16 a[58:59], v8 offset:25728
    v_mfma_f32_16x16x32_bf16 v[176:179], a[120:123], a[204:207], v[176:179]
    ds_read_b64_tr_b16 a[60:61], v8 offset:30720
    v_mfma_f32_16x16x32_bf16 v[176:179], a[140:143], a[224:227], v[176:179]
    buffer_load_dwordx4 v1, s[48:51], s69 offen offset:2048 sc1 lds
    v_mfma_f32_16x16x32_bf16 v[180:183], a[124:127], a[204:207], v[180:183]
    ds_read_b64_tr_b16 a[62:63], v8 offset:35840
    ds_read_b64_tr_b16 a[64:65], v9 offset:30752
    v_mfma_f32_16x16x32_bf16 v[180:183], a[144:147], a[224:227], v[180:183]
    buffer_load_dwordx4 v1, s[48:51], s69 offen offset:3072 sc1 lds
    v_mfma_f32_16x16x32_bf16 v[184:187], a[128:131], a[204:207], v[184:187]
    ds_read_b64_tr_b16 a[66:67], v9 offset:35872
    v_mfma_f32_16x16x32_bf16 v[184:187], a[148:151], a[224:227], v[184:187]
    ds_read_b64_tr_b16 a[68:69], v8 offset:30784
    ds_read_b64_tr_b16 a[70:71], v8 offset:35904
    v_mfma_f32_16x16x32_bf16 v[188:191], a[132:135], a[204:207], v[188:191]
    s_add_u32 m0, s88, 24704
    v_mfma_f32_16x16x32_bf16 v[188:191], a[152:155], a[224:227], v[188:191]
    ds_read_b64_tr_b16 a[72:73], v9 offset:30816
    v_mfma_f32_16x16x32_bf16 v[192:195], a[136:139], a[204:207], v[192:195]
    ds_read_b64_tr_b16 a[74:75], v9 offset:35936
    buffer_load_dwordx4 v2, s[48:51], s69 offen offset:0 sc1 lds
    v_mfma_f32_16x16x32_bf16 v[192:195], a[156:159], a[224:227], v[192:195]
    ds_read_b64_tr_b16 a[76:77], v8 offset:30848
    v_mfma_f32_16x16x32_bf16 v[196:199], a[120:123], a[208:211], v[196:199]
    ds_read_b64_tr_b16 a[78:79], v8 offset:35968
    v_mfma_f32_16x16x32_bf16 v[196:199], a[140:143], a[228:231], v[196:199]
    v_mfma_f32_16x16x32_bf16 v[200:203], a[124:127], a[208:211], v[200:203]
    v_mfma_f32_16x16x32_bf16 v[200:203], a[144:147], a[228:231], v[200:203]
    v_mfma_f32_16x16x32_bf16 v[204:207], a[128:131], a[208:211], v[204:207]
    v_mfma_f32_16x16x32_bf16 v[204:207], a[148:151], a[228:231], v[204:207]
    s_waitcnt vmcnt(5) lgkmcnt(0)
    s_barrier
    v_mfma_f32_16x16x32_bf16 v[208:211], a[132:135], a[208:211], v[208:211]
    ds_read_b128 a[160:163], v5 offset:0
    v_mfma_f32_16x16x32_bf16 v[208:211], a[152:155], a[228:231], v[208:211]
    s_add_u32 s68, s99, s29
    s_nop 0
    v_mfma_f32_16x16x32_bf16 v[212:215], a[136:139], a[208:211], v[212:215]
    ds_read_b128 a[164:167], v15 offset:0
    v_mfma_f32_16x16x32_bf16 v[212:215], a[156:159], a[228:231], v[212:215]
    s_add_u32 m0, s88, 82048
    v_mfma_f32_16x16x32_bf16 v[216:219], a[120:123], a[212:215], v[216:219]
    ds_read_b128 a[168:171], v92 offset:0
    v_mfma_f32_16x16x32_bf16 v[216:219], a[140:143], a[232:235], v[216:219]
    buffer_load_dwordx4 v10, s[52:55], s68 offen offset:0 lds
    v_mfma_f32_16x16x32_bf16 v[220:223], a[124:127], a[212:215], v[220:223]
    v_mfma_f32_16x16x32_bf16 v[220:223], a[144:147], a[232:235], v[220:223]
    ds_read_b128 a[172:175], v93 offset:0
    v_mfma_f32_16x16x32_bf16 v[224:227], a[128:131], a[212:215], v[224:227]
    buffer_load_dwordx4 v11, s[52:55], s68 offen offset:1024 lds
    v_mfma_f32_16x16x32_bf16 v[224:227], a[148:151], a[232:235], v[224:227]
    ds_read_b128 a[176:179], v7 offset:4096
    v_mfma_f32_16x16x32_bf16 v[228:231], a[132:135], a[212:215], v[228:231]
    ds_read_b128 a[180:183], v5 offset:10240
    v_mfma_f32_16x16x32_bf16 v[228:231], a[152:155], a[232:235], v[228:231]
    buffer_load_dwordx4 v12, s[52:55], s68 offen offset:2048 lds
    v_mfma_f32_16x16x32_bf16 v[232:235], a[136:139], a[212:215], v[232:235]
    ds_read_b128 a[184:187], v15 offset:10240
    v_mfma_f32_16x16x32_bf16 v[232:235], a[156:159], a[232:235], v[232:235]
    v_mfma_f32_16x16x32_bf16 v[236:239], a[120:123], a[216:219], v[236:239]
    buffer_load_dwordx4 v13, s[52:55], s68 offen offset:3072 lds
    v_mfma_f32_16x16x32_bf16 v[236:239], a[140:143], a[236:239], v[236:239]
    ds_read_b128 a[188:191], v92 offset:10240
    v_mfma_f32_16x16x32_bf16 v[240:243], a[124:127], a[216:219], v[240:243]
    s_add_u32 m0, s88, 86144
    v_mfma_f32_16x16x32_bf16 v[240:243], a[144:147], a[236:239], v[240:243]
    ds_read_b128 a[192:195], v93 offset:10240
    v_mfma_f32_16x16x32_bf16 v[244:247], a[128:131], a[216:219], v[244:247]
    buffer_load_dwordx4 v14, s[52:55], s68 offen offset:0 lds
    v_mfma_f32_16x16x32_bf16 v[244:247], a[148:151], a[236:239], v[244:247]
    ds_read_b128 a[196:199], v7 offset:14336
    v_mfma_f32_16x16x32_bf16 v[248:251], a[132:135], a[216:219], v[248:251]
    v_mfma_f32_16x16x32_bf16 v[248:251], a[152:155], a[236:239], v[248:251]
    v_mfma_f32_16x16x32_bf16 v[252:255], a[136:139], a[216:219], v[252:255]
    v_mfma_f32_16x16x32_bf16 v[252:255], a[156:159], a[236:239], v[252:255]
    s_waitcnt lgkmcnt(0)
    s_nop 0
    s_cmp_eq_u32 s15, 1
    s_cbranch_scc1 L_ok3
    s_mov_b32 s91, 0
L_spin3:
    s_buffer_load_dwordx4 s[12:15], s[48:51], s9 offset:32 glc
    s_waitcnt lgkmcnt(0)
    s_cmp_eq_u32 s15, 1
    s_cbranch_scc1 L_ok3
    s_add_u32 s91, s91, 1
    s_cmp_lt_u32 s91, 250000
    s_cbranch_scc1 L_spin3
.p2align 3
L_ok3:
    v_mfma_f32_16x16x32_bf16 v[156:159], a[0:3], a[160:163], v[156:159]
    ds_read_b64_tr_b16 a[80:81], v16 offset:0
    s_add_u32 s69, s96, 128
    v_mfma_f32_16x16x32_bf16 v[156:159], a[20:23], a[180:183], v[156:159]
    ds_read_b64_tr_b16 a[82:83], v16 offset:5120
    v_mfma_f32_16x16x32_bf16 v[160:163], a[4:7], a[160:163], v[160:163]
    ds_read_b64_tr_b16 a[84:85], v17 offset:32
    v_mfma_f32_16x16x32_bf16 v[160:163], a[24:27], a[180:183], v[160:163]
    s_add_u32 m0, s88, 41088
    ds_read_b64_tr_b16 a[86:87], v17 offset:5152
    v_mfma_f32_16x16x32_bf16 v[164:167], a[8:11], a[160:163], v[164:167]
    ds_read_b64_tr_b16 a[88:89], v16 offset:64
    v_mfma_f32_16x16x32_bf16 v[164:167], a[28:31], a[180:183], v[164:167]
    ds_read_b64_tr_b16 a[90:91], v16 offset:5184
    v_mfma_f32_16x16x32_bf16 v[168:171], a[12:15], a[160:163], v[168:171]
    buffer_load_dwordx4 v1, s[48:51], s69 offen offset:0 sc1 lds
    ds_read_b64_tr_b16 a[92:93], v17 offset:96
    v_mfma_f32_16x16x32_bf16 v[168:171], a[32:35], a[180:183], v[168:171]
    ds_read_b64_tr_b16 a[94:95], v17 offset:5216
    v_mfma_f32_16x16x32_bf16 v[172:175], a[16:19], a[160:163], v[172:175]
    buffer_load_dwordx4 v1, s[48:51], s69 offen offset:1024 sc1 lds
    v_mfma_f32_16x16x32_bf16 v[172:175], a[36:39], a[180:183], v[172:175]
    ds_read_b64_tr_b16 a[96:97], v16 offset:128
    ds_read_b64_tr_b16 a[98:99], v16 offset:5248
    v_mfma_f32_16x16x32_bf16 v[176:179], a[0:3], a[164:167], v[176:179]
    ds_read_b64_tr_b16 a[100:101], v16 offset:10240
    v_mfma_f32_16x16x32_bf16 v[176:179], a[20:23], a[184:187], v[176:179]
    buffer_load_dwordx4 v1, s[48:51], s69 offen offset:2048 sc1 lds
    v_mfma_f32_16x16x32_bf16 v[180:183], a[4:7], a[164:167], v[180:183]
    ds_read_b64_tr_b16 a[102:103], v16 offset:15360
    ds_read_b64_tr_b16 a[104:105], v17 offset:10272
    v_mfma_f32_16x16x32_bf16 v[180:183], a[24:27], a[184:187], v[180:183]
    buffer_load_dwordx4 v1, s[48:51], s69 offen offset:3072 sc1 lds
    v_mfma_f32_16x16x32_bf16 v[184:187], a[8:11], a[164:167], v[184:187]
    ds_read_b64_tr_b16 a[106:107], v17 offset:15392
    v_mfma_f32_16x16x32_bf16 v[184:187], a[28:31], a[184:187], v[184:187]
    ds_read_b64_tr_b16 a[108:109], v16 offset:10304
    ds_read_b64_tr_b16 a[110:111], v16 offset:15424
    v_mfma_f32_16x16x32_bf16 v[188:191], a[12:15], a[164:167], v[188:191]
    s_add_u32 m0, s88, 45184
    v_mfma_f32_16x16x32_bf16 v[188:191], a[32:35], a[184:187], v[188:191]
    ds_read_b64_tr_b16 a[112:113], v17 offset:10336
    v_mfma_f32_16x16x32_bf16 v[192:195], a[16:19], a[164:167], v[192:195]
    ds_read_b64_tr_b16 a[114:115], v17 offset:15456
    buffer_load_dwordx4 v2, s[48:51], s69 offen offset:0 sc1 lds
    v_mfma_f32_16x16x32_bf16 v[192:195], a[36:39], a[184:187], v[192:195]
    ds_read_b64_tr_b16 a[116:117], v16 offset:10368
    v_mfma_f32_16x16x32_bf16 v[196:199], a[0:3], a[168:171], v[196:199]
    ds_read_b64_tr_b16 a[118:119], v16 offset:15488
    v_mfma_f32_16x16x32_bf16 v[196:199], a[20:23], a[188:191], v[196:199]
    v_mfma_f32_16x16x32_bf16 v[200:203], a[4:7], a[168:171], v[200:203]
    v_mfma_f32_16x16x32_bf16 v[200:203], a[24:27], a[188:191], v[200:203]
    v_mfma_f32_16x16x32_bf16 v[204:207], a[8:11], a[168:171], v[204:207]
    v_mfma_f32_16x16x32_bf16 v[204:207], a[28:31], a[188:191], v[204:207]
    s_waitcnt vmcnt(10) lgkmcnt(0)
    s_barrier
    v_mfma_f32_16x16x32_bf16 v[208:211], a[12:15], a[168:171], v[208:211]
    ds_read_b128 a[200:203], v5 offset:20480
    v_mfma_f32_16x16x32_bf16 v[208:211], a[32:35], a[188:191], v[208:211]
    s_add_u32 s68, s100, s29
    s_nop 0
    v_mfma_f32_16x16x32_bf16 v[212:215], a[16:19], a[168:171], v[212:215]
    ds_read_b128 a[204:207], v15 offset:20480
    v_mfma_f32_16x16x32_bf16 v[212:215], a[36:39], a[188:191], v[212:215]
    s_add_u32 m0, s88, 102528
    v_mfma_f32_16x16x32_bf16 v[216:219], a[0:3], a[172:175], v[216:219]
    ds_read_b128 a[208:211], v92 offset:20480
    v_mfma_f32_16x16x32_bf16 v[216:219], a[20:23], a[192:195], v[216:219]
    buffer_load_dwordx4 v10, s[52:55], s68 offen offset:0 lds
    v_mfma_f32_16x16x32_bf16 v[220:223], a[4:7], a[172:175], v[220:223]
    v_mfma_f32_16x16x32_bf16 v[220:223], a[24:27], a[192:195], v[220:223]
    ds_read_b128 a[212:215], v93 offset:20480
    v_mfma_f32_16x16x32_bf16 v[224:227], a[8:11], a[172:175], v[224:227]
    buffer_load_dwordx4 v11, s[52:55], s68 offen offset:1024 lds
    v_mfma_f32_16x16x32_bf16 v[224:227], a[28:31], a[192:195], v[224:227]
    ds_read_b128 a[216:219], v7 offset:24576
    v_mfma_f32_16x16x32_bf16 v[228:231], a[12:15], a[172:175], v[228:231]
    ds_read_b128 a[220:223], v5 offset:30720
    v_mfma_f32_16x16x32_bf16 v[228:231], a[32:35], a[192:195], v[228:231]
    buffer_load_dwordx4 v12, s[52:55], s68 offen offset:2048 lds
    v_mfma_f32_16x16x32_bf16 v[232:235], a[16:19], a[172:175], v[232:235]
    ds_read_b128 a[224:227], v15 offset:30720
    v_mfma_f32_16x16x32_bf16 v[232:235], a[36:39], a[192:195], v[232:235]
    v_mfma_f32_16x16x32_bf16 v[236:239], a[0:3], a[176:179], v[236:239]
    buffer_load_dwordx4 v13, s[52:55], s68 offen offset:3072 lds
    v_mfma_f32_16x16x32_bf16 v[236:239], a[20:23], a[196:199], v[236:239]
    ds_read_b128 a[228:231], v92 offset:30720
    v_mfma_f32_16x16x32_bf16 v[240:243], a[4:7], a[176:179], v[240:243]
    s_add_u32 m0, s88, 106624
    v_mfma_f32_16x16x32_bf16 v[240:243], a[24:27], a[196:199], v[240:243]
    ds_read_b128 a[232:235], v93 offset:30720
    v_mfma_f32_16x16x32_bf16 v[244:247], a[8:11], a[176:179], v[244:247]
    buffer_load_dwordx4 v14, s[52:55], s68 offen offset:0 lds
    v_mfma_f32_16x16x32_bf16 v[244:247], a[28:31], a[196:199], v[244:247]
    ds_read_b128 a[236:239], v7 offset:34816
    v_mfma_f32_16x16x32_bf16 v[248:251], a[12:15], a[176:179], v[248:251]
    v_mfma_f32_16x16x32_bf16 v[248:251], a[32:35], a[196:199], v[248:251]
    v_mfma_f32_16x16x32_bf16 v[252:255], a[16:19], a[176:179], v[252:255]
    v_mfma_f32_16x16x32_bf16 v[252:255], a[36:39], a[196:199], v[252:255]
    s_waitcnt lgkmcnt(0)
    s_nop 0
    v_mfma_f32_16x16x32_bf16 v[156:159], a[40:43], a[200:203], v[156:159]
    ds_read_b64_tr_b16 a[120:121], v16 offset:20480
    s_add_u32 s69, s30, 5248
    v_mfma_f32_16x16x32_bf16 v[156:159], a[60:63], a[220:223], v[156:159]
    ds_read_b64_tr_b16 a[122:123], v16 offset:25600
    v_mfma_f32_16x16x32_bf16 v[160:163], a[44:47], a[200:203], v[160:163]
    ds_read_b64_tr_b16 a[124:125], v17 offset:20512
    v_mfma_f32_16x16x32_bf16 v[160:163], a[64:67], a[220:223], v[160:163]
    s_add_u32 m0, s88, 61568
    ds_read_b64_tr_b16 a[126:127], v17 offset:25632
    v_mfma_f32_16x16x32_bf16 v[164:167], a[48:51], a[200:203], v[164:167]
    ds_read_b64_tr_b16 a[128:129], v16 offset:20544
    v_mfma_f32_16x16x32_bf16 v[164:167], a[68:71], a[220:223], v[164:167]
    ds_read_b64_tr_b16 a[130:131], v16 offset:25664
    v_mfma_f32_16x16x32_bf16 v[168:171], a[52:55], a[200:203], v[168:171]
    buffer_load_dwordx4 v1, s[48:51], s69 offen offset:0 sc1 lds
    ds_read_b64_tr_b16 a[132:133], v17 offset:20576
    v_mfma_f32_16x16x32_bf16 v[168:171], a[72:75], a[220:223], v[168:171]
    ds_read_b64_tr_b16 a[134:135], v17 offset:25696
    v_mfma_f32_16x16x32_bf16 v[172:175], a[56:59], a[200:203], v[172:175]
    buffer_load_dwordx4 v1, s[48:51], s69 offen offset:1024 sc1 lds
    v_mfma_f32_16x16x32_bf16 v[172:175], a[76:79], a[220:223], v[172:175]
    ds_read_b64_tr_b16 a[136:137], v16 offset:20608
    ds_read_b64_tr_b16 a[138:139], v16 offset:25728
    v_mfma_f32_16x16x32_bf16 v[176:179], a[40:43], a[204:207], v[176:179]
    ds_read_b64_tr_b16 a[140:141], v16 offset:30720
    v_mfma_f32_16x16x32_bf16 v[176:179], a[60:63], a[224:227], v[176:179]
    buffer_load_dwordx4 v1, s[48:51], s69 offen offset:2048 sc1 lds
    v_mfma_f32_16x16x32_bf16 v[180:183], a[44:47], a[204:207], v[180:183]
    ds_read_b64_tr_b16 a[142:143], v16 offset:35840
    ds_read_b64_tr_b16 a[144:145], v17 offset:30752
    v_mfma_f32_16x16x32_bf16 v[180:183], a[64:67], a[224:227], v[180:183]
    buffer_load_dwordx4 v1, s[48:51], s69 offen offset:3072 sc1 lds
    v_mfma_f32_16x16x32_bf16 v[184:187], a[48:51], a[204:207], v[184:187]
    ds_read_b64_tr_b16 a[146:147], v17 offset:35872
    v_mfma_f32_16x16x32_bf16 v[184:187], a[68:71], a[224:227], v[184:187]
    ds_read_b64_tr_b16 a[148:149], v16 offset:30784
    ds_read_b64_tr_b16 a[150:151], v16 offset:35904
    v_mfma_f32_16x16x32_bf16 v[188:191], a[52:55], a[204:207], v[188:191]
    s_add_u32 m0, s88, 65664
    v_mfma_f32_16x16x32_bf16 v[188:191], a[72:75], a[224:227], v[188:191]
    ds_read_b64_tr_b16 a[152:153], v17 offset:30816
    v_mfma_f32_16x16x32_bf16 v[192:195], a[56:59], a[204:207], v[192:195]
    ds_read_b64_tr_b16 a[154:155], v17 offset:35936
    buffer_load_dwordx4 v2, s[48:51], s69 offen offset:0 sc1 lds
    v_mfma_f32_16x16x32_bf16 v[192:195], a[76:79], a[224:227], v[192:195]
    ds_read_b64_tr_b16 a[156:157], v16 offset:30848
    v_mfma_f32_16x16x32_bf16 v[196:199], a[40:43], a[208:211], v[196:199]
    ds_read_b64_tr_b16 a[158:159], v16 offset:35968
    v_mfma_f32_16x16x32_bf16 v[196:199], a[60:63], a[228:231], v[196:199]
    v_mfma_f32_16x16x32_bf16 v[200:203], a[44:47], a[208:211], v[200:203]
    v_mfma_f32_16x16x32_bf16 v[200:203], a[64:67], a[228:231], v[200:203]
    v_mfma_f32_16x16x32_bf16 v[204:207], a[48:51], a[208:211], v[204:207]
    v_mfma_f32_16x16x32_bf16 v[204:207], a[68:71], a[228:231], v[204:207]
    s_waitcnt vmcnt(10) lgkmcnt(0)
    s_barrier
    v_mfma_f32_16x16x32_bf16 v[208:211], a[52:55], a[208:211], v[208:211]
    ds_read_b128 a[160:163], v20 offset:0
    v_mfma_f32_16x16x32_bf16 v[208:211], a[72:75], a[228:231], v[208:211]
    s_add_u32 s68, s98, s78
    s_nop 0
    v_mfma_f32_16x16x32_bf16 v[212:215], a[56:59], a[208:211], v[212:215]
    ds_read_b128 a[164:167], v21 offset:0
    v_mfma_f32_16x16x32_bf16 v[212:215], a[76:79], a[228:231], v[212:215]
    s_add_u32 m0, s88, 123008
    v_mfma_f32_16x16x32_bf16 v[216:219], a[40:43], a[212:215], v[216:219]
    ds_read_b128 a[168:171], v22 offset:0
    v_mfma_f32_16x16x32_bf16 v[216:219], a[60:63], a[232:235], v[216:219]
    buffer_load_dwordx4 v10, s[52:55], s68 offen offset:0 lds
    v_mfma_f32_16x16x32_bf16 v[220:223], a[44:47], a[212:215], v[220:223]
    v_mfma_f32_16x16x32_bf16 v[220:223], a[64:67], a[232:235], v[220:223]
    ds_read_b128 a[172:175], v23 offset:0
    v_mfma_f32_16x16x32_bf16 v[224:227], a[48:51], a[212:215], v[224:227]
    buffer_load_dwordx4 v11, s[52:55], s68 offen offset:1024 lds
    v_mfma_f32_16x16x32_bf16 v[224:227], a[68:71], a[232:235], v[224:227]
L_pad5:
    s_cbranch_execz L_back
    s_nop 0
    ds_read_b128 a[176:179], v18 offset:4096
    v_mfma_f32_16x16x32_bf16 v[228:231], a[52:55], a[212:215], v[228:231]
    ds_read_b128 a[180:183], v20 offset:10240
    v_mfma_f32_16x16x32_bf16 v[228:231], a[72:75], a[232:235], v[228:231]
    buffer_load_dwordx4 v12, s[52:55], s68 offen offset:2048 lds
    v_mfma_f32_16x16x32_bf16 v[232:235], a[56:59], a[212:215], v[232:235]
    ds_read_b128 a[184:187], v21 offset:10240
    v_mfma_f32_16x16x32_bf16 v[232:235], a[76:79], a[232:235], v[232:235]
    v_mfma_f32_16x16x32_bf16 v[236:239], a[40:43], a[216:219], v[236:239]
    buffer_load_dwordx4 v13, s[52:55], s68 offen offset:3072 lds
    v_mfma_f32_16x16x32_bf16 v[236:239], a[60:63], a[236:239], v[236:239]
    ds_read_b128 a[188:191], v22 offset:10240
    v_mfma_f32_16x16x32_bf16 v[240:243], a[44:47], a[216:219], v[240:243]
    s_add_u32 m0, s88, 127104
    v_mfma_f32_16x16x32_bf16 v[240:243], a[64:67], a[236:239], v[240:243]
    ds_read_b128 a[192:195], v23 offset:10240
    v_mfma_f32_16x16x32_bf16 v[244:247], a[48:51], a[216:219], v[244:247]
    buffer_load_dwordx4 v14, s[52:55], s68 offen offset:0 lds
    v_mfma_f32_16x16x32_bf16 v[244:247], a[68:71], a[236:239], v[244:247]
    ds_read_b128 a[196:199], v18 offset:14336
    v_mfma_f32_16x16x32_bf16 v[248:251], a[52:55], a[216:219], v[248:251]
    v_mfma_f32_16x16x32_bf16 v[248:251], a[72:75], a[236:239], v[248:251]
    v_mfma_f32_16x16x32_bf16 v[252:255], a[56:59], a[216:219], v[252:255]
    v_mfma_f32_16x16x32_bf16 v[252:255], a[76:79], a[236:239], v[252:255]
    s_waitcnt lgkmcnt(0)
    s_nop 0
    v_mfma_f32_16x16x32_bf16 v[156:159], a[80:83], a[160:163], v[156:159]
    ds_read_b64_tr_b16 a[0:1], v8 offset:0
    s_add_u32 s69, s31, 5248
    v_mfma_f32_16x16x32_bf16 v[156:159], a[100:103], a[180:183], v[156:159]
    ds_read_b64_tr_b16 a[2:3], v8 offset:5120
    v_mfma_f32_16x16x32_bf16 v[160:163], a[84:87], a[160:163], v[160:163]
    ds_read_b64_tr_b16 a[4:5], v9 offset:32
    v_mfma_f32_16x16x32_bf16 v[160:163], a[104:107], a[180:183], v[160:163]
    s_add_u32 m0, s88, 128
    ds_read_b64_tr_b16 a[6:7], v9 offset:5152
    v_mfma_f32_16x16x32_bf16 v[164:167], a[88:91], a[160:163], v[164:167]
    ds_read_b64_tr_b16 a[8:9], v8 offset:64
    v_mfma_f32_16x16x32_bf16 v[164:167], a[108:111], a[180:183], v[164:167]
    ds_read_b64_tr_b16 a[10:11], v8 offset:5184
    v_mfma_f32_16x16x32_bf16 v[168:171], a[92:95], a[160:163], v[168:171]
    buffer_load_dwordx4 v1, s[48:51], s69 offen offset:0 sc1 lds
    ds_read_b64_tr_b16 a[12:13], v9 offset:96
    v_mfma_f32_16x16x32_bf16 v[168:171], a[112:115], a[180:183], v[168:171]
    ds_read_b64_tr_b16 a[14:15], v9 offset:5216
    v_mfma_f32_16x16x32_bf16 v[172:175], a[96:99], a[160:163], v[172:175]
    buffer_load_dwordx4 v1, s[48:51], s69 offen offset:1024 sc1 lds
    v_mfma_f32_16x16x32_bf16 v[172:175], a[116:119], a[180:183], v[172:175]
    ds_read_b64_tr_b16 a[16:17], v8 offset:128
    ds_read_b64_tr_b16 a[18:19], v8 offset:5248
    v_mfma_f32_16x16x32_bf16 v[176:179], a[80:83], a[164:167], v[176:179]
    ds_read_b64_tr_b16 a[20:21], v8 offset:10240
    v_mfma_f32_16x16x32_bf16 v[176:179], a[100:103], a[184:187], v[176:179]
    buffer_load_dwordx4 v1, s[48:51], s69 offen offset:2048 sc1 lds
    v_mfma_f32_16x16x32_bf16 v[180:183], a[84:87], a[164:167], v[180:183]
    ds_read_b64_tr_b16 a[22:23], v8 offset:15360
    ds_read_b64_tr_b16 a[24:25], v9 offset:10272
    v_mfma_f32_16x16x32_bf16 v[180:183], a[104:107], a[184:187], v[180:183]
    buffer_load_dwordx4 v1, s[48:51], s69 offen offset:3072 sc1 lds
    v_mfma_f32_16x16x32_bf16 v[184:187], a[88:91], a[164:167], v[184:187]
    ds_read_b64_tr_b16 a[26:27], v9 offset:15392
    v_mfma_f32_16x16x32_bf16 v[184:187], a[108:111], a[184:187], v[184:187]
    ds_read_b64_tr_b16 a[28:29], v8 offset:10304
    ds_read_b64_tr_b16 a[30:31], v8 offset:15424
    v_mfma_f32_16x16x32_bf16 v[188:191], a[92:95], a[164:167], v[188:191]
    s_add_u32 m0, s88, 4224
    v_mfma_f32_16x16x32_bf16 v[188:191], a[112:115], a[184:187], v[188:191]
    ds_read_b64_tr_b16 a[32:33], v9 offset:10336
    v_mfma_f32_16x16x32_bf16 v[192:195], a[96:99], a[164:167], v[192:195]
    ds_read_b64_tr_b16 a[34:35], v9 offset:15456
    buffer_load_dwordx4 v2, s[48:51], s69 offen offset:0 sc1 lds
    v_mfma_f32_16x16x32_bf16 v[192:195], a[116:119], a[184:187], v[192:195]
    ds_read_b64_tr_b16 a[36:37], v8 offset:10368
    v_mfma_f32_16x16x32_bf16 v[196:199], a[80:83], a[168:171], v[196:199]
    ds_read_b64_tr_b16 a[38:39], v8 offset:15488
    v_mfma_f32_16x16x32_bf16 v[196:199], a[100:103], a[188:191], v[196:199]
    v_mfma_f32_16x16x32_bf16 v[200:203], a[84:87], a[168:171], v[200:203]
    v_mfma_f32_16x16x32_bf16 v[200:203], a[104:107], a[188:191], v[200:203]
    v_mfma_f32_16x16x32_bf16 v[204:207], a[88:91], a[168:171], v[204:207]
    v_mfma_f32_16x16x32_bf16 v[204:207], a[108:111], a[188:191], v[204:207]
    s_waitcnt vmcnt(10) lgkmcnt(0)
    s_barrier
    v_mfma_f32_16x16x32_bf16 v[208:211], a[92:95], a[168:171], v[208:211]
    ds_read_b128 a[200:203], v20 offset:20480
    v_mfma_f32_16x16x32_bf16 v[208:211], a[112:115], a[188:191], v[208:211]
    s_add_u32 s68, s99, s78
    s_nop 0
    v_mfma_f32_16x16x32_bf16 v[212:215], a[96:99], a[168:171], v[212:215]
    ds_read_b128 a[204:207], v21 offset:20480
    v_mfma_f32_16x16x32_bf16 v[212:215], a[116:119], a[188:191], v[212:215]
    s_add_u32 m0, s88, 143488
    v_mfma_f32_16x16x32_bf16 v[216:219], a[80:83], a[172:175], v[216:219]
    ds_read_b128 a[208:211], v22 offset:20480
    v_mfma_f32_16x16x32_bf16 v[216:219], a[100:103], a[192:195], v[216:219]
    buffer_load_dwordx4 v10, s[52:55], s68 offen offset:0 lds
    v_mfma_f32_16x16x32_bf16 v[220:223], a[84:87], a[172:175], v[220:223]
    v_mfma_f32_16x16x32_bf16 v[220:223], a[104:107], a[192:195], v[220:223]
    ds_read_b128 a[212:215], v23 offset:20480
    v_mfma_f32_16x16x32_bf16 v[224:227], a[88:91], a[172:175], v[224:227]
    buffer_load_dwordx4 v11, s[52:55], s68 offen offset:1024 lds
    v_mfma_f32_16x16x32_bf16 v[224:227], a[108:111], a[192:195], v[224:227]
    ds_read_b128 a[216:219], v18 offset:24576
    v_mfma_f32_16x16x32_bf16 v[228:231], a[92:95], a[172:175], v[228:231]
    ds_read_b128 a[220:223], v20 offset:30720
    v_mfma_f32_16x16x32_bf16 v[228:231], a[112:115], a[192:195], v[228:231]
    buffer_load_dwordx4 v12, s[52:55], s68 offen offset:2048 lds
    v_mfma_f32_16x16x32_bf16 v[232:235], a[96:99], a[172:175], v[232:235]
    ds_read_b128 a[224:227], v21 offset:30720
    v_mfma_f32_16x16x32_bf16 v[232:235], a[116:119], a[192:195], v[232:235]
    v_mfma_f32_16x16x32_bf16 v[236:239], a[80:83], a[176:179], v[236:239]
    buffer_load_dwordx4 v13, s[52:55], s68 offen offset:3072 lds
    v_mfma_f32_16x16x32_bf16 v[236:239], a[100:103], a[196:199], v[236:239]
    ds_read_b128 a[228:231], v22 offset:30720
    v_mfma_f32_16x16x32_bf16 v[240:243], a[84:87], a[176:179], v[240:243]
    s_add_u32 m0, s88, 147584
    v_mfma_f32_16x16x32_bf16 v[240:243], a[104:107], a[196:199], v[240:243]
    ds_read_b128 a[232:235], v23 offset:30720
    v_mfma_f32_16x16x32_bf16 v[244:247], a[88:91], a[176:179], v[244:247]
    buffer_load_dwordx4 v14, s[52:55], s68 offen offset:0 lds
    v_mfma_f32_16x16x32_bf16 v[244:247], a[108:111], a[196:199], v[244:247]
    ds_read_b128 a[236:239], v18 offset:34816
    v_mfma_f32_16x16x32_bf16 v[248:251], a[92:95], a[176:179], v[248:251]
    v_mfma_f32_16x16x32_bf16 v[248:251], a[112:115], a[196:199], v[248:251]
    v_mfma_f32_16x16x32_bf16 v[252:255], a[96:99], a[176:179], v[252:255]
    v_mfma_f32_16x16x32_bf16 v[252:255], a[116:119], a[196:199], v[252:255]
    s_waitcnt lgkmcnt(0)
    s_nop 0
    v_mfma_f32_16x16x32_bf16 v[156:159], a[120:123], a[200:203], v[156:159]
    ds_read_b64_tr_b16 a[40:41], v8 offset:20480
    s_add_u32 s69, s96, 5248
    v_mfma_f32_16x16x32_bf16 v[156:159], a[140:143], a[220:223], v[156:159]
    ds_read_b64_tr_b16 a[42:43], v8 offset:25600
    v_mfma_f32_16x16x32_bf16 v[160:163], a[124:127], a[200:203], v[160:163]
    ds_read_b64_tr_b16 a[44:45], v9 offset:20512
    v_mfma_f32_16x16x32_bf16 v[160:163], a[144:147], a[220:223], v[160:163]
    s_add_u32 m0, s88, 20608
    ds_read_b64_tr_b16 a[46:47], v9 offset:25632
    v_mfma_f32_16x16x32_bf16 v[164:167], a[128:131], a[200:203], v[164:167]
    ds_read_b64_tr_b16 a[48:49], v8 offset:20544
    v_mfma_f32_16x16x32_bf16 v[164:167], a[148:151], a[220:223], v[164:167]
    ds_read_b64_tr_b16 a[50:51], v8 offset:25664
    v_mfma_f32_16x16x32_bf16 v[168:171], a[132:135], a[200:203], v[168:171]
    buffer_load_dwordx4 v1, s[48:51], s69 offen offset:0 sc1 lds
    ds_read_b64_tr_b16 a[52:53], v9 offset:20576
    v_mfma_f32_16x16x32_bf16 v[168:171], a[152:155], a[220:223], v[168:171]
    ds_read_b64_tr_b16 a[54:55], v9 offset:25696
    v_mfma_f32_16x16x32_bf16 v[172:175], a[136:139], a[200:203], v[172:175]
    buffer_load_dwordx4 v1, s[48:51], s69 offen offset:1024 sc1 lds
    v_mfma_f32_16x16x32_bf16 v[172:175], a[156:159], a[220:223], v[172:175]
    ds_read_b64_tr_b16 a[56:57], v8 offset:20608
    ds_read_b64_tr_b16 a[58:59], v8 offset:25728
    v_mfma_f32_16x16x32_bf16 v[176:179], a[120:123], a[204:207], v[176:179]
    ds_read_b64_tr_b16 a[60:61], v8 offset:30720
    v_mfma_f32_16x16x32_bf16 v[176:179], a[140:143], a[224:227], v[176:179]
    buffer_load_dwordx4 v1, s[48:51], s69 offen offset:2048 sc1 lds
    v_mfma_f32_16x16x32_bf16 v[180:183], a[124:127], a[204:207], v[180:183]
    ds_read_b64_tr_b16 a[62:63], v8 offset:35840
    ds_read_b64_tr_b16 a[64:65], v9 offset:30752
    v_mfma_f32_16x16x32_bf16 v[180:183], a[144:147], a[224:227], v[180:183]
    buffer_load_dwordx4 v1, s[48:51], s69 offen offset:3072 sc1 lds
    v_mfma_f32_16x16x32_bf16 v[184:187], a[128:131], a[204:207], v[184:187]
    ds_read_b64_tr_b16 a[66:67], v9 offset:35872
    v_mfma_f32_16x16x32_bf16 v[184:187], a[148:151], a[224:227], v[184:187]
    ds_read_b64_tr_b16 a[68:69], v8 offset:30784
    ds_read_b64_tr_b16 a[70:71], v8 offset:35904
    v_mfma_f32_16x16x32_bf16 v[188:191], a[132:135], a[204:207], v[188:191]
    s_add_u32 m0, s88, 24704
    v_mfma_f32_16x16x32_bf16 v[188:191], a[152:155], a[224:227], v[188:191]
    ds_read_b64_tr_b16 a[72:73], v9 offset:30816
    v_mfma_f32_16x16x32_bf16 v[192:195], a[136:139], a[204:207], v[192:195]
    ds_read_b64_tr_b16 a[74:75], v9 offset:35936
    buffer_load_dwordx4 v2, s[48:51], s69 offen offset:0 sc1 lds
    v_mfma_f32_16x16x32_bf16 v[192:195], a[156:159], a[224:227], v[192:195]
    ds_read_b64_tr_b16 a[76:77], v8 offset:30848
    v_mfma_f32_16x16x32_bf16 v[196:199], a[120:123], a[208:211], v[196:199]
    ds_read_b64_tr_b16 a[78:79], v8 offset:35968
    v_mfma_f32_16x16x32_bf16 v[196:199], a[140:143], a[228:231], v[196:199]
    v_mfma_f32_16x16x32_bf16 v[200:203], a[124:127], a[208:211], v[200:203]
    v_mfma_f32_16x16x32_bf16 v[200:203], a[144:147], a[228:231], v[200:203]
    v_mfma_f32_16x16x32_bf16 v[204:207], a[128:131], a[208:211], v[204:207]
    v_mfma_f32_16x16x32_bf16 v[204:207], a[148:151], a[228:231], v[204:207]
    s_waitcnt vmcnt(10) lgkmcnt(0)
    s_barrier
    v_mfma_f32_16x16x32_bf16 v[208:211], a[132:135], a[208:211], v[208:211]
    ds_read_b128 a[160:163], v5 offset:0
    v_mfma_f32_16x16x32_bf16 v[208:211], a[152:155], a[228:231], v[208:211]
    s_add_u32 s68, s100, s78
    s_nop 0
    v_mfma_f32_16x16x32_bf16 v[212:215], a[136:139], a[208:211], v[212:215]
    ds_read_b128 a[164:167], v15 offset:0
    v_mfma_f32_16x16x32_bf16 v[212:215], a[156:159], a[228:231], v[212:215]
    s_add_u32 m0, s88, 82048
    v_mfma_f32_16x16x32_bf16 v[216:219], a[120:123], a[212:215], v[216:219]
    ds_read_b128 a[168:171], v92 offset:0
    v_mfma_f32_16x16x32_bf16 v[216:219], a[140:143], a[232:235], v[216:219]
    buffer_load_dwordx4 v10, s[52:55], s68 offen offset:0 lds
    v_mfma_f32_16x16x32_bf16 v[220:223], a[124:127], a[212:215], v[220:223]
    v_mfma_f32_16x16x32_bf16 v[220:223], a[144:147], a[232:235], v[220:223]
    ds_read_b128 a[172:175], v93 offset:0
    v_mfma_f32_16x16x32_bf16 v[224:227], a[128:131], a[212:215], v[224:227]
    buffer_load_dwordx4 v11, s[52:55], s68 offen offset:1024 lds
    v_mfma_f32_16x16x32_bf16 v[224:227], a[148:151], a[232:235], v[224:227]
    ds_read_b128 a[176:179], v7 offset:4096
    v_mfma_f32_16x16x32_bf16 v[228:231], a[132:135], a[212:215], v[228:231]
    ds_read_b128 a[180:183], v5 offset:10240
    v_mfma_f32_16x16x32_bf16 v[228:231], a[152:155], a[232:235], v[228:231]
    buffer_load_dwordx4 v12, s[52:55], s68 offen offset:2048 lds
    v_mfma_f32_16x16x32_bf16 v[232:235], a[136:139], a[212:215], v[232:235]
    ds_read_b128 a[184:187], v15 offset:10240
    v_mfma_f32_16x16x32_bf16 v[232:235], a[156:159], a[232:235], v[232:235]
    v_mfma_f32_16x16x32_bf16 v[236:239], a[120:123], a[216:219], v[236:239]
    buffer_load_dwordx4 v13, s[52:55], s68 offen offset:3072 lds
    v_mfma_f32_16x16x32_bf16 v[236:239], a[140:143], a[236:239], v[236:239]
    ds_read_b128 a[188:191], v92 offset:10240
    v_mfma_f32_16x16x32_bf16 v[240:243], a[124:127], a[216:219], v[240:243]
    s_add_u32 m0, s88, 86144
    v_mfma_f32_16x16x32_bf16 v[240:243], a[144:147], a[236:239], v[240:243]
    ds_read_b128 a[192:195], v93 offset:10240
    v_mfma_f32_16x16x32_bf16 v[244:247], a[128:131], a[216:219], v[244:247]
    buffer_load_dwordx4 v14, s[52:55], s68 offen offset:0 lds
    v_mfma_f32_16x16x32_bf16 v[244:247], a[148:151], a[236:239], v[244:247]
    ds_read_b128 a[196:199], v7 offset:14336
    v_mfma_f32_16x16x32_bf16 v[248:251], a[132:135], a[216:219], v[248:251]
    v_mfma_f32_16x16x32_bf16 v[248:251], a[152:155], a[236:239], v[248:251]
    v_mfma_f32_16x16x32_bf16 v[252:255], a[136:139], a[216:219], v[252:255]
    v_mfma_f32_16x16x32_bf16 v[252:255], a[156:159], a[236:239], v[252:255]
    s_waitcnt lgkmcnt(0)
    s_nop 0
    v_mfma_f32_16x16x32_bf16 v[156:159], a[0:3], a[160:163], v[156:159]
    ds_read_b64_tr_b16 a[80:81], v16 offset:0
    s_add_u32 s69, s30, 10368
    v_mfma_f32_16x16x32_bf16 v[156:159], a[20:23], a[180:183], v[156:159]
    ds_read_b64_tr_b16 a[82:83], v16 offset:5120
    v_mfma_f32_16x16x32_bf16 v[160:163], a[4:7], a[160:163], v[160:163]
    ds_read_b64_tr_b16 a[84:85], v17 offset:32
    v_mfma_f32_16x16x32_bf16 v[160:163], a[24:27], a[180:183], v[160:163]
    s_add_u32 m0, s88, 41088
    ds_read_b64_tr_b16 a[86:87], v17 offset:5152
    v_mfma_f32_16x16x32_bf16 v[164:167], a[8:11], a[160:163], v[164:167]
    ds_read_b64_tr_b16 a[88:89], v16 offset:64
    v_mfma_f32_16x16x32_bf16 v[164:167], a[28:31], a[180:183], v[164:167]
    ds_read_b64_tr_b16 a[90:91], v16 offset:5184
    v_mfma_f32_16x16x32_bf16 v[168:171], a[12:15], a[160:163], v[168:171]
    buffer_load_dwordx4 v1, s[48:51], s69 offen offset:0 sc1 lds
    ds_read_b64_tr_b16 a[92:93], v17 offset:96
    v_mfma_f32_16x16x32_bf16 v[168:171], a[32:35], a[180:183], v[168:171]
    ds_read_b64_tr_b16 a[94:95], v17 offset:5216
    v_mfma_f32_16x16x32_bf16 v[172:175], a[16:19], a[160:163], v[172:175]
    buffer_load_dwordx4 v1, s[48:51], s69 offen offset:1024 sc1 lds
    v_mfma_f32_16x16x32_bf16 v[172:175], a[36:39], a[180:183], v[172:175]
    ds_read_b64_tr_b16 a[96:97], v16 offset:128
    ds_read_b64_tr_b16 a[98:99], v16 offset:5248
    v_mfma_f32_16x16x32_bf16 v[176:179], a[0:3], a[164:167], v[176:179]
    ds_read_b64_tr_b16 a[100:101], v16 offset:10240
    v_mfma_f32_16x16x32_bf16 v[176:179], a[20:23], a[184:187], v[176:179]
    buffer_load_dwordx4 v1, s[48:51], s69 offen offset:2048 sc1 lds
    v_mfma_f32_16x16x32_bf16 v[180:183], a[4:7], a[164:167], v[180:183]
    ds_read_b64_tr_b16 a[102:103], v16 offset:15360
    ds_read_b64_tr_b16 a[104:105], v17 offset:10272
    v_mfma_f32_16x16x32_bf16 v[180:183], a[24:27], a[184:187], v[180:183]
    buffer_load_dwordx4 v1, s[48:51], s69 offen offset:3072 sc1 lds
    v_mfma_f32_16x16x32_bf16 v[184:187], a[8:11], a[164:167], v[184:187]
    ds_read_b64_tr_b16 a[106:107], v17 offset:15392
    v_mfma_f32_16x16x32_bf16 v[184:187], a[28:31], a[184:187], v[184:187]
    ds_read_b64_tr_b16 a[108:109], v16 offset:10304
    ds_read_b64_tr_b16 a[110:111], v16 offset:15424
    v_mfma_f32_16x16x32_bf16 v[188:191], a[12:15], a[164:167], v[188:191]
    s_add_u32 m0, s88, 45184
    v_mfma_f32_16x16x32_bf16 v[188:191], a[32:35], a[184:187], v[188:191]
    ds_read_b64_tr_b16 a[112:113], v17 offset:10336
    v_mfma_f32_16x16x32_bf16 v[192:195], a[16:19], a[164:167], v[192:195]
    ds_read_b64_tr_b16 a[114:115], v17 offset:15456
    buffer_load_dwordx4 v2, s[48:51], s69 offen offset:0 sc1 lds
    v_mfma_f32_16x16x32_bf16 v[192:195], a[36:39], a[184:187], v[192:195]
    ds_read_b64_tr_b16 a[116:117], v16 offset:10368
    v_mfma_f32_16x16x32_bf16 v[196:199], a[0:3], a[168:171], v[196:199]
    ds_read_b64_tr_b16 a[118:119], v16 offset:15488
    v_mfma_f32_16x16x32_bf16 v[196:199], a[20:23], a[188:191], v[196:199]
    v_mfma_f32_16x16x32_bf16 v[200:203], a[4:7], a[168:171], v[200:203]
    v_mfma_f32_16x16x32_bf16 v[200:203], a[24:27], a[188:191], v[200:203]
    v_mfma_f32_16x16x32_bf16 v[204:207], a[8:11], a[168:171], v[204:207]
    v_mfma_f32_16x16x32_bf16 v[204:207], a[28:31], a[188:191], v[204:207]
    s_waitcnt vmcnt(10) lgkmcnt(0)
    s_barrier
    v_mfma_f32_16x16x32_bf16 v[208:211], a[12:15], a[168:171], v[208:211]
    ds_read_b128 a[200:203], v5 offset:20480
    v_mfma_f32_16x16x32_bf16 v[208:211], a[32:35], a[188:191], v[208:211]
    s_add_u32 s68, s98, s79
    s_nop 0
    v_mfma_f32_16x16x32_bf16 v[212:215], a[16:19], a[168:171], v[212:215]
    ds_read_b128 a[204:207], v15 offset:20480
    v_mfma_f32_16x16x32_bf16 v[212:215], a[36:39], a[188:191], v[212:215]
    s_add_u32 m0, s88, 102528
    v_mfma_f32_16x16x32_bf16 v[216:219], a[0:3], a[172:175], v[216:219]
    ds_read_b128 a[208:211], v92 offset:20480
    v_mfma_f32_16x16x32_bf16 v[216:219], a[20:23], a[192:195], v[216:219]
    buffer_load_dwordx4 v10, s[52:55], s68 offen offset:0 lds
    v_mfma_f32_16x16x32_bf16 v[220:223], a[4:7], a[172:175], v[220:223]
    v_mfma_f32_16x16x32_bf16 v[220:223], a[24:27], a[192:195], v[220:223]
    ds_read_b128 a[212:215], v93 offset:20480
    v_mfma_f32_16x16x32_bf16 v[224:227], a[8:11], a[172:175], v[224:227]
    buffer_load_dwordx4 v11, s[52:55], s68 offen offset:1024 lds
    v_mfma_f32_16x16x32_bf16 v[224:227], a[28:31], a[192:195], v[224:227]
    ds_read_b128 a[216:219], v7 offset:24576
    v_mfma_f32_16x16x32_bf16 v[228:231], a[12:15], a[172:175], v[228:231]
    ds_read_b128 a[220:223], v5 offset:30720
    v_mfma_f32_16x16x32_bf16 v[228:231], a[32:35], a[192:195], v[228:231]
    buffer_load_dwordx4 v12, s[52:55], s68 offen offset:2048 lds
    v_mfma_f32_16x16x32_bf16 v[232:235], a[16:19], a[172:175], v[232:235]
    ds_read_b128 a[224:227], v15 offset:30720
    v_mfma_f32_16x16x32_bf16 v[232:235], a[36:39], a[192:195], v[232:235]
    v_mfma_f32_16x16x32_bf16 v[236:239], a[0:3], a[176:179], v[236:239]
    buffer_load_dwordx4 v13, s[52:55], s68 offen offset:3072 lds
    v_mfma_f32_16x16x32_bf16 v[236:239], a[20:23], a[196:199], v[236:239]
    ds_read_b128 a[228:231], v92 offset:30720
    v_mfma_f32_16x16x32_bf16 v[240:243], a[4:7], a[176:179], v[240:243]
    s_add_u32 m0, s88, 106624
    v_mfma_f32_16x16x32_bf16 v[240:243], a[24:27], a[196:199], v[240:243]
    ds_read_b128 a[232:235], v93 offset:30720
    v_mfma_f32_16x16x32_bf16 v[244:247], a[8:11], a[176:179], v[244:247]
    buffer_load_dwordx4 v14, s[52:55], s68 offen offset:0 lds
    v_mfma_f32_16x16x32_bf16 v[244:247], a[28:31], a[196:199], v[244:247]
    ds_read_b128 a[236:239], v7 offset:34816
    v_mfma_f32_16x16x32_bf16 v[248:251], a[12:15], a[176:179], v[248:251]
    v_mfma_f32_16x16x32_bf16 v[248:251], a[32:35], a[196:199], v[248:251]
    v_mfma_f32_16x16x32_bf16 v[252:255], a[16:19], a[176:179], v[252:255]
    v_mfma_f32_16x16x32_bf16 v[252:255], a[36:39], a[196:199], v[252:255]
    s_waitcnt lgkmcnt(0)
    s_nop 0
    v_mfma_f32_16x16x32_bf16 v[156:159], a[40:43], a[200:203], v[156:159]
    ds_read_b64_tr_b16 a[120:121], v16 offset:20480
    s_add_u32 s69, s31, 10368
    v_mfma_f32_16x16x32_bf16 v[156:159], a[60:63], a[220:223], v[156:159]
    ds_read_b64_tr_b16 a[122:123], v16 offset:25600
    v_mfma_f32_16x16x32_bf16 v[160:163], a[44:47], a[200:203], v[160:163]
    ds_read_b64_tr_b16 a[124:125], v17 offset:20512
    v_mfma_f32_16x16x32_bf16 v[160:163], a[64:67], a[220:223], v[160:163]
    s_add_u32 m0, s88, 61568
    ds_read_b64_tr_b16 a[126:127], v17 offset:25632
    v_mfma_f32_16x16x32_bf16 v[164:167], a[48:51], a[200:203], v[164:167]
    ds_read_b64_tr_b16 a[128:129], v16 offset:20544
    v_mfma_f32_16x16x32_bf16 v[164:167], a[68:71], a[220:223], v[164:167]
    ds_read_b64_tr_b16 a[130:131], v16 offset:25664
    v_mfma_f32_16x16x32_bf16 v[168:171], a[52:55], a[200:203], v[168:171]
    buffer_load_dwordx4 v1, s[48:51], s69 offen offset:0 sc1 lds
    ds_read_b64_tr_b16 a[132:133], v17 offset:20576
    v_mfma_f32_16x16x32_bf16 v[168:171], a[72:75], a[220:223], v[168:171]
    ds_read_b64_tr_b16 a[134:135], v17 offset:25696
    v_mfma_f32_16x16x32_bf16 v[172:175], a[56:59], a[200:203], v[172:175]
    buffer_load_dwordx4 v1, s[48:51], s69 offen offset:1024 sc1 lds
    v_mfma_f32_16x16x32_bf16 v[172:175], a[76:79], a[220:223], v[172:175]
    ds_read_b64_tr_b16 a[136:137], v16 offset:20608
    ds_read_b64_tr_b16 a[138:139], v16 offset:25728
    v_mfma_f32_16x16x32_bf16 v[176:179], a[40:43], a[204:207], v[176:179]
    ds_read_b64_tr_b16 a[140:141], v16 offset:30720
    v_mfma_f32_16x16x32_bf16 v[176:179], a[60:63], a[224:227], v[176:179]
    buffer_load_dwordx4 v1, s[48:51], s69 offen offset:2048 sc1 lds
    v_mfma_f32_16x16x32_bf16 v[180:183], a[44:47], a[204:207], v[180:183]
    ds_read_b64_tr_b16 a[142:143], v16 offset:35840
    ds_read_b64_tr_b16 a[144:145], v17 offset:30752
    v_mfma_f32_16x16x32_bf16 v[180:183], a[64:67], a[224:227], v[180:183]
    buffer_load_dwordx4 v1, s[48:51], s69 offen offset:3072 sc1 lds
    v_mfma_f32_16x16x32_bf16 v[184:187], a[48:51], a[204:207], v[184:187]
    ds_read_b64_tr_b16 a[146:147], v17 offset:35872
    v_mfma_f32_16x16x32_bf16 v[184:187], a[68:71], a[224:227], v[184:187]
    ds_read_b64_tr_b16 a[148:149], v16 offset:30784
    ds_read_b64_tr_b16 a[150:151], v16 offset:35904
    v_mfma_f32_16x16x32_bf16 v[188:191], a[52:55], a[204:207], v[188:191]
    s_add_u32 m0, s88, 65664
    v_mfma_f32_16x16x32_bf16 v[188:191], a[72:75], a[224:227], v[188:191]
    ds_read_b64_tr_b16 a[152:153], v17 offset:30816
    v_mfma_f32_16x16x32_bf16 v[192:195], a[56:59], a[204:207], v[192:195]
    ds_read_b64_tr_b16 a[154:155], v17 offset:35936
    buffer_load_dwordx4 v2, s[48:51], s69 offen offset:0 sc1 lds
    v_mfma_f32_16x16x32_bf16 v[192:195], a[76:79], a[224:227], v[192:195]
    ds_read_b64_tr_b16 a[156:157], v16 offset:30848
    v_mfma_f32_16x16x32_bf16 v[196:199], a[40:43], a[208:211], v[196:199]
    ds_read_b64_tr_b16 a[158:159], v16 offset:35968
    v_mfma_f32_16x16x32_bf16 v[196:199], a[60:63], a[228:231], v[196:199]
    v_mfma_f32_16x16x32_bf16 v[200:203], a[44:47], a[208:211], v[200:203]
    v_mfma_f32_16x16x32_bf16 v[200:203], a[64:67], a[228:231], v[200:203]
    v_mfma_f32_16x16x32_bf16 v[204:207], a[48:51], a[208:211], v[204:207]
    v_mfma_f32_16x16x32_bf16 v[204:207], a[68:71], a[228:231], v[204:207]
    s_waitcnt vmcnt(10) lgkmcnt(0)
    s_barrier
    v_mfma_f32_16x16x32_bf16 v[208:211], a[52:55], a[208:211], v[208:211]
    ds_read_b128 a[160:163], v20 offset:0
    v_mfma_f32_16x16x32_bf16 v[208:211], a[72:75], a[228:231], v[208:211]
    s_add_u32 s68, s99, s79
    s_nop 0
    v_mfma_f32_16x16x32_bf16 v[212:215], a[56:59], a[208:211], v[212:215]
    ds_read_b128 a[164:167], v21 offset:0
    v_mfma_f32_16x16x32_bf16 v[212:215], a[76:79], a[228:231], v[212:215]
    s_add_u32 m0, s88, 123008
    v_mfma_f32_16x16x32_bf16 v[216:219], a[40:43], a[212:215], v[216:219]
    ds_read_b128 a[168:171], v22 offset:0
    v_mfma_f32_16x16x32_bf16 v[216:219], a[60:63], a[232:235], v[216:219]
    buffer_load_dwordx4 v10, s[52:55], s68 offen offset:0 lds
    v_mfma_f32_16x16x32_bf16 v[220:223], a[44:47], a[212:215], v[220:223]
    v_mfma_f32_16x16x32_bf16 v[220:223], a[64:67], a[232:235], v[220:223]
    ds_read_b128 a[172:175], v23 offset:0
    v_mfma_f32_16x16x32_bf16 v[224:227], a[48:51], a[212:215], v[224:227]
    buffer_load_dwordx4 v11, s[52:55], s68 offen offset:1024 lds
    v_mfma_f32_16x16x32_bf16 v[224:227], a[68:71], a[232:235], v[224:227]
    ds_read_b128 a[176:179], v18 offset:4096
    v_mfma_f32_16x16x32_bf16 v[228:231], a[52:55], a[212:215], v[228:231]
    ds_read_b128 a[180:183], v20 offset:10240
    v_mfma_f32_16x16x32_bf16 v[228:231], a[72:75], a[232:235], v[228:231]
    buffer_load_dwordx4 v12, s[52:55], s68 offen offset:2048 lds
    v_mfma_f32_16x16x32_bf16 v[232:235], a[56:59], a[212:215], v[232:235]
    ds_read_b128 a[184:187], v21 offset:10240
    v_mfma_f32_16x16x32_bf16 v[232:235], a[76:79], a[232:235], v[232:235]
    v_mfma_f32_16x16x32_bf16 v[236:239], a[40:43], a[216:219], v[236:239]
    buffer_load_dwordx4 v13, s[52:55], s68 offen offset:3072 lds
    v_mfma_f32_16x16x32_bf16 v[236:239], a[60:63], a[236:239], v[236:239]
    ds_read_b128 a[188:191], v22 offset:10240
    v_mfma_f32_16x16x32_bf16 v[240:243], a[44:47], a[216:219], v[240:243]
    s_add_u32 m0, s88, 127104
    v_mfma_f32_16x16x32_bf16 v[240:243], a[64:67], a[236:239], v[240:243]
    ds_read_b128 a[192:195], v23 offset:10240
    v_mfma_f32_16x16x32_bf16 v[244:247], a[48:51], a[216:219], v[244:247]
    buffer_load_dwordx4 v14, s[52:55], s68 offen offset:0 lds
    v_mfma_f32_16x16x32_bf16 v[244:247], a[68:71], a[236:239], v[244:247]
    ds_read_b128 a[196:199], v18 offset:14336
    v_mfma_f32_16x16x32_bf16 v[248:251], a[52:55], a[216:219], v[248:251]
    v_mfma_f32_16x16x32_bf16 v[248:251], a[72:75], a[236:239], v[248:251]
    v_mfma_f32_16x16x32_bf16 v[252:255], a[56:59], a[216:219], v[252:255]
    v_mfma_f32_16x16x32_bf16 v[252:255], a[76:79], a[236:239], v[252:255]
    s_waitcnt lgkmcnt(0)
    s_nop 0
    v_mfma_f32_16x16x32_bf16 v[156:159], a[80:83], a[160:163], v[156:159]
    ds_read_b64_tr_b16 a[0:1], v8 offset:0
    s_add_u32 s69, s96, 10368
    v_mfma_f32_16x16x32_bf16 v[156:159], a[100:103], a[180:183], v[156:159]
    ds_read_b64_tr_b16 a[2:3], v8 offset:5120
    v_mfma_f32_16x16x32_bf16 v[160:163], a[84:87], a[160:163], v[160:163]
    ds_read_b64_tr_b16 a[4:5], v9 offset:32
    v_mfma_f32_16x16x32_bf16 v[160:163], a[104:107], a[180:183], v[160:163]
    s_add_u32 m0, s88, 128
    ds_read_b64_tr_b16 a[6:7], v9 offset:5152
    v_mfma_f32_16x16x32_bf16 v[164:167], a[88:91], a[160:163], v[164:167]
    ds_read_b64_tr_b16 a[8:9], v8 offset:64
    v_mfma_f32_16x16x32_bf16 v[164:167], a[108:111], a[180:183], v[164:167]
    ds_read_b64_tr_b16 a[10:11], v8 offset:5184
    v_mfma_f32_16x16x32_bf16 v[168:171], a[92:95], a[160:163], v[168:171]
    buffer_load_dwordx4 v1, s[48:51], s69 offen offset:0 sc1 lds
    ds_read_b64_tr_b16 a[12:13], v9 offset:96
    v_mfma_f32_16x16x32_bf16 v[168:171], a[112:115], a[180:183], v[168:171]
    ds_read_b64_tr_b16 a[14:15], v9 offset:5216
    v_mfma_f32_16x16x32_bf16 v[172:175], a[96:99], a[160:163], v[172:175]
    buffer_load_dwordx4 v1, s[48:51], s69 offen offset:1024 sc1 lds
    v_mfma_f32_16x16x32_bf16 v[172:175], a[116:119], a[180:183], v[172:175]
    ds_read_b64_tr_b16 a[16:17], v8 offset:128
    ds_read_b64_tr_b16 a[18:19], v8 offset:5248
    v_mfma_f32_16x16x32_bf16 v[176:179], a[80:83], a[164:167], v[176:179]
    ds_read_b64_tr_b16 a[20:21], v8 offset:10240
    v_mfma_f32_16x16x32_bf16 v[176:179], a[100:103], a[184:187], v[176:179]
    buffer_load_dwordx4 v1, s[48:51], s69 offen offset:2048 sc1 lds
    v_mfma_f32_16x16x32_bf16 v[180:183], a[84:87], a[164:167], v[180:183]
    ds_read_b64_tr_b16 a[22:23], v8 offset:15360
    ds_read_b64_tr_b16 a[24:25], v9 offset:10272
    v_mfma_f32_16x16x32_bf16 v[180:183], a[104:107], a[184:187], v[180:183]
    buffer_load_dwordx4 v1, s[48:51], s69 offen offset:3072 sc1 lds
    v_mfma_f32_16x16x32_bf16 v[184:187], a[88:91], a[164:167], v[184:187]
    ds_read_b64_tr_b16 a[26:27], v9 offset:15392
    v_mfma_f32_16x16x32_bf16 v[184:187], a[108:111], a[184:187], v[184:187]
    ds_read_b64_tr_b16 a[28:29], v8 offset:10304
    ds_read_b64_tr_b16 a[30:31], v8 offset:15424
    v_mfma_f32_16x16x32_bf16 v[188:191], a[92:95], a[164:167], v[188:191]
    s_add_u32 m0, s88, 4224
    v_mfma_f32_16x16x32_bf16 v[188:191], a[112:115], a[184:187], v[188:191]
    ds_read_b64_tr_b16 a[32:33], v9 offset:10336
    v_mfma_f32_16x16x32_bf16 v[192:195], a[96:99], a[164:167], v[192:195]
    ds_read_b64_tr_b16 a[34:35], v9 offset:15456
    buffer_load_dwordx4 v2, s[48:51], s69 offen offset:0 sc1 lds
    v_mfma_f32_16x16x32_bf16 v[192:195], a[116:119], a[184:187], v[192:195]
    ds_read_b64_tr_b16 a[36:37], v8 offset:10368
    v_mfma_f32_16x16x32_bf16 v[196:199], a[80:83], a[168:171], v[196:199]
    ds_read_b64_tr_b16 a[38:39], v8 offset:15488
    v_mfma_f32_16x16x32_bf16 v[196:199], a[100:103], a[188:191], v[196:199]
    v_mfma_f32_16x16x32_bf16 v[200:203], a[84:87], a[168:171], v[200:203]
    v_mfma_f32_16x16x32_bf16 v[200:203], a[104:107], a[188:191], v[200:203]
    v_mfma_f32_16x16x32_bf16 v[204:207], a[88:91], a[168:171], v[204:207]
    v_mfma_f32_16x16x32_bf16 v[204:207], a[108:111], a[188:191], v[204:207]
    s_waitcnt vmcnt(10) lgkmcnt(0)
    s_barrier
    v_mfma_f32_16x16x32_bf16 v[208:211], a[92:95], a[168:171], v[208:211]
    ds_read_b128 a[200:203], v20 offset:20480
    v_mfma_f32_16x16x32_bf16 v[208:211], a[112:115], a[188:191], v[208:211]
    s_add_u32 s69, s30, 15488
    v_mfma_f32_16x16x32_bf16 v[212:215], a[96:99], a[168:171], v[212:215]
    ds_read_b128 a[204:207], v21 offset:20480
    v_mfma_f32_16x16x32_bf16 v[212:215], a[116:119], a[188:191], v[212:215]
    s_add_u32 m0, s88, 20608
    v_mfma_f32_16x16x32_bf16 v[216:219], a[80:83], a[172:175], v[216:219]
    ds_read_b128 a[208:211], v22 offset:20480
    v_mfma_f32_16x16x32_bf16 v[216:219], a[100:103], a[192:195], v[216:219]
    buffer_load_dwordx4 v1, s[48:51], s69 offen offset:0 sc1 lds
    v_mfma_f32_16x16x32_bf16 v[220:223], a[84:87], a[172:175], v[220:223]
    v_mfma_f32_16x16x32_bf16 v[220:223], a[104:107], a[192:195], v[220:223]
    ds_read_b128 a[212:215], v23 offset:20480
    v_mfma_f32_16x16x32_bf16 v[224:227], a[88:91], a[172:175], v[224:227]
    buffer_load_dwordx4 v1, s[48:51], s69 offen offset:1024 sc1 lds
    v_mfma_f32_16x16x32_bf16 v[224:227], a[108:111], a[192:195], v[224:227]
    ds_read_b128 a[216:219], v18 offset:24576
    v_mfma_f32_16x16x32_bf16 v[228:231], a[92:95], a[172:175], v[228:231]
    ds_read_b128 a[220:223], v20 offset:30720
    v_mfma_f32_16x16x32_bf16 v[228:231], a[112:115], a[192:195], v[228:231]
    buffer_load_dwordx4 v1, s[48:51], s69 offen offset:2048 sc1 lds
    v_mfma_f32_16x16x32_bf16 v[232:235], a[96:99], a[172:175], v[232:235]
    ds_read_b128 a[224:227], v21 offset:30720
    v_mfma_f32_16x16x32_bf16 v[232:235], a[116:119], a[192:195], v[232:235]
    v_mfma_f32_16x16x32_bf16 v[236:239], a[80:83], a[176:179], v[236:239]
    buffer_load_dwordx4 v1, s[48:51], s69 offen offset:3072 sc1 lds
    v_mfma_f32_16x16x32_bf16 v[236:239], a[100:103], a[196:199], v[236:239]
    ds_read_b128 a[228:231], v22 offset:30720
    v_mfma_f32_16x16x32_bf16 v[240:243], a[84:87], a[176:179], v[240:243]
    s_add_u32 m0, s88, 24704
    v_mfma_f32_16x16x32_bf16 v[240:243], a[104:107], a[196:199], v[240:243]
    ds_read_b128 a[232:235], v23 offset:30720
    v_mfma_f32_16x16x32_bf16 v[244:247], a[88:91], a[176:179], v[244:247]
    buffer_load_dwordx4 v2, s[48:51], s69 offen offset:0 sc1 lds
    v_mfma_f32_16x16x32_bf16 v[244:247], a[108:111], a[196:199], v[244:247]
    ds_read_b128 a[236:239], v18 offset:34816
    v_mfma_f32_16x16x32_bf16 v[248:251], a[92:95], a[176:179], v[248:251]
L_pad6:
    s_cbranch_execz L_back
    s_nop 0
    v_mfma_f32_16x16x32_bf16 v[248:251], a[112:115], a[196:199], v[248:251]
    v_mfma_f32_16x16x32_bf16 v[252:255], a[96:99], a[176:179], v[252:255]
    v_mfma_f32_16x16x32_bf16 v[252:255], a[116:119], a[196:199], v[252:255]
    s_waitcnt lgkmcnt(0)
    s_nop 0
    v_mfma_f32_16x16x32_bf16 v[156:159], a[120:123], a[200:203], v[156:159]
    ds_read_b64_tr_b16 a[40:41], v8 offset:20480
    s_add_u32 s68, s100, s79
    s_nop 0
    v_mfma_f32_16x16x32_bf16 v[156:159], a[140:143], a[220:223], v[156:159]
    ds_read_b64_tr_b16 a[42:43], v8 offset:25600
    v_mfma_f32_16x16x32_bf16 v[160:163], a[124:127], a[200:203], v[160:163]
    ds_read_b64_tr_b16 a[44:45], v9 offset:20512
    v_mfma_f32_16x16x32_bf16 v[160:163], a[144:147], a[220:223], v[160:163]
    s_add_u32 m0, s88, 143488
    ds_read_b64_tr_b16 a[46:47], v9 offset:25632
    v_mfma_f32_16x16x32_bf16 v[164:167], a[128:131], a[200:203], v[164:167]
    ds_read_b64_tr_b16 a[48:49], v8 offset:20544
    v_mfma_f32_16x16x32_bf16 v[164:167], a[148:151], a[220:223], v[164:167]
    ds_read_b64_tr_b16 a[50:51], v8 offset:25664
    v_mfma_f32_16x16x32_bf16 v[168:171], a[132:135], a[200:203], v[168:171]
    buffer_load_dwordx4 v10, s[52:55], s68 offen offset:0 lds
    ds_read_b64_tr_b16 a[52:53], v9 offset:20576
    v_mfma_f32_16x16x32_bf16 v[168:171], a[152:155], a[220:223], v[168:171]
    ds_read_b64_tr_b16 a[54:55], v9 offset:25696
    v_mfma_f32_16x16x32_bf16 v[172:175], a[136:139], a[200:203], v[172:175]
    buffer_load_dwordx4 v11, s[52:55], s68 offen offset:1024 lds
    v_mfma_f32_16x16x32_bf16 v[172:175], a[156:159], a[220:223], v[172:175]
    ds_read_b64_tr_b16 a[56:57], v8 offset:20608
    ds_read_b64_tr_b16 a[58:59], v8 offset:25728
    v_mfma_f32_16x16x32_bf16 v[176:179], a[120:123], a[204:207], v[176:179]
    ds_read_b64_tr_b16 a[60:61], v8 offset:30720
    v_mfma_f32_16x16x32_bf16 v[176:179], a[140:143], a[224:227], v[176:179]
    buffer_load_dwordx4 v12, s[52:55], s68 offen offset:2048 lds
    v_mfma_f32_16x16x32_bf16 v[180:183], a[124:127], a[204:207], v[180:183]
    ds_read_b64_tr_b16 a[62:63], v8 offset:35840
    ds_read_b64_tr_b16 a[64:65], v9 offset:30752
    v_mfma_f32_16x16x32_bf16 v[180:183], a[144:147], a[224:227], v[180:183]
    buffer_load_dwordx4 v13, s[52:55], s68 offen offset:3072 lds
    v_mfma_f32_16x16x32_bf16 v[184:187], a[128:131], a[204:207], v[184:187]
    ds_read_b64_tr_b16 a[66:67], v9 offset:35872
    v_mfma_f32_16x16x32_bf16 v[184:187], a[148:151], a[224:227], v[184:187]
    ds_read_b64_tr_b16 a[68:69], v8 offset:30784
    ds_read_b64_tr_b16 a[70:71], v8 offset:35904
    v_mfma_f32_16x16x32_bf16 v[188:191], a[132:135], a[204:207], v[188:191]
    s_add_u32 m0, s88, 147584
    v_mfma_f32_16x16x32_bf16 v[188:191], a[152:155], a[224:227], v[188:191]
    ds_read_b64_tr_b16 a[72:73], v9 offset:30816
    v_mfma_f32_16x16x32_bf16 v[192:195], a[136:139], a[204:207], v[192:195]
    ds_read_b64_tr_b16 a[74:75], v9 offset:35936
    buffer_load_dwordx4 v14, s[52:55], s68 offen offset:0 lds
    v_mfma_f32_16x16x32_bf16 v[192:195], a[156:159], a[224:227], v[192:195]
    ds_read_b64_tr_b16 a[76:77], v8 offset:30848
    v_mfma_f32_16x16x32_bf16 v[196:199], a[120:123], a[208:211], v[196:199]
    ds_read_b64_tr_b16 a[78:79], v8 offset:35968
    v_mfma_f32_16x16x32_bf16 v[196:199], a[140:143], a[228:231], v[196:199]
    v_mfma_f32_16x16x32_bf16 v[200:203], a[124:127], a[208:211], v[200:203]
    v_mfma_f32_16x16x32_bf16 v[200:203], a[144:147], a[228:231], v[200:203]
    v_mfma_f32_16x16x32_bf16 v[204:207], a[128:131], a[208:211], v[204:207]
    v_mfma_f32_16x16x32_bf16 v[204:207], a[148:151], a[228:231], v[204:207]
    s_waitcnt vmcnt(10) lgkmcnt(0)
    s_barrier
    v_mfma_f32_16x16x32_bf16 v[208:211], a[132:135], a[208:211], v[208:211]
    ds_read_b128 v[96:99], v7 offset:4096
    v_mfma_f32_16x16x32_bf16 v[208:211], a[152:155], a[228:231], v[208:211]
    s_add_u32 s69, s31, 15488
    v_mfma_f32_16x16x32_bf16 v[212:215], a[136:139], a[208:211], v[212:215]
    v_mfma_f32_16x16x32_bf16 v[212:215], a[156:159], a[228:231], v[212:215]
    s_add_u32 m0, s88, 41088
    v_mfma_f32_16x16x32_bf16 v[216:219], a[120:123], a[212:215], v[216:219]
    ds_read_b128 a[160:163], v15 offset:0
    v_mfma_f32_16x16x32_bf16 v[216:219], a[140:143], a[232:235], v[216:219]
    v_mfma_f32_16x16x32_bf16 v[220:223], a[124:127], a[212:215], v[220:223]
    buffer_load_dwordx4 v1, s[48:51], s69 offen offset:0 sc1 lds
    v_mfma_f32_16x16x32_bf16 v[220:223], a[144:147], a[232:235], v[220:223]
    ds_read_b128 v[128:131], v92 offset:0
    v_mfma_f32_16x16x32_bf16 v[224:227], a[128:131], a[212:215], v[224:227]
    v_mfma_f32_16x16x32_bf16 v[224:227], a[148:151], a[232:235], v[224:227]
    buffer_load_dwordx4 v1, s[48:51], s69 offen offset:1024 sc1 lds
    v_mfma_f32_16x16x32_bf16 v[228:231], a[132:135], a[212:215], v[228:231]
    ds_read_b128 v[100:103], v7 offset:14336
    v_mfma_f32_16x16x32_bf16 v[228:231], a[152:155], a[232:235], v[228:231]
    v_mfma_f32_16x16x32_bf16 v[232:235], a[136:139], a[212:215], v[232:235]
    buffer_load_dwordx4 v1, s[48:51], s69 offen offset:2048 sc1 lds
    v_mfma_f32_16x16x32_bf16 v[232:235], a[156:159], a[232:235], v[232:235]
    buffer_load_dwordx4 v1, s[48:51], s69 offen offset:3072 sc1 lds
    v_mfma_f32_16x16x32_bf16 v[236:239], a[120:123], a[216:219], v[236:239]
    v_mfma_f32_16x16x32_bf16 v[236:239], a[140:143], a[236:239], v[236:239]
    ds_read_b128 a[164:167], v15 offset:10240
    v_mfma_f32_16x16x32_bf16 v[240:243], a[124:127], a[216:219], v[240:243]
    s_add_u32 m0, s88, 45184
    v_mfma_f32_16x16x32_bf16 v[240:243], a[144:147], a[236:239], v[240:243]
    v_mfma_f32_16x16x32_bf16 v[244:247], a[128:131], a[216:219], v[244:247]
    ds_read_b128 v[132:135], v92 offset:10240
    v_mfma_f32_16x16x32_bf16 v[244:247], a[148:151], a[236:239], v[244:247]
    buffer_load_dwordx4 v2, s[48:51], s69 offen offset:0 sc1 lds
    v_mfma_f32_16x16x32_bf16 v[248:251], a[132:135], a[216:219], v[248:251]
    v_mfma_f32_16x16x32_bf16 v[248:251], a[152:155], a[236:239], v[248:251]
    v_mfma_f32_16x16x32_bf16 v[252:255], a[136:139], a[216:219], v[252:255]
    v_mfma_f32_16x16x32_bf16 v[252:255], a[156:159], a[236:239], v[252:255]
    s_waitcnt vmcnt(5) lgkmcnt(0)
    s_barrier
    v_mfma_f32_16x16x32_bf16 v[236:239], a[0:3], v[96:99], v[236:239]
    s_add_u32 s69, s96, 15488
    s_add_u32 m0, s88, 61568
    v_mfma_f32_16x16x32_bf16 v[236:239], a[20:23], v[100:103], v[236:239]
    buffer_load_dwordx4 v1, s[48:51], s69 offen offset:0 sc1 lds
    ds_read_b128 v[104:107], v7 offset:24576
    v_mfma_f32_16x16x32_bf16 v[240:243], a[4:7], v[96:99], v[240:243]
    ds_read_b128 v[108:111], v7 offset:34816
    ds_read_b128 a[168:171], v15 offset:20480
    v_mfma_f32_16x16x32_bf16 v[240:243], a[24:27], v[100:103], v[240:243]
    ds_read_b128 a[172:175], v15 offset:30720
    ds_read_b128 v[136:139], v92 offset:20480
    v_mfma_f32_16x16x32_bf16 v[244:247], a[8:11], v[96:99], v[244:247]
    ds_read_b128 v[140:143], v92 offset:30720
    ds_read_b64_tr_b16 a[80:81], v16 offset:0
    v_mfma_f32_16x16x32_bf16 v[244:247], a[28:31], v[100:103], v[244:247]
    buffer_load_dwordx4 v1, s[48:51], s69 offen offset:1024 sc1 lds
    ds_read_b64_tr_b16 a[82:83], v16 offset:5120
    v_mfma_f32_16x16x32_bf16 v[248:251], a[12:15], v[96:99], v[248:251]
    ds_read_b64_tr_b16 a[84:85], v17 offset:32
    ds_read_b64_tr_b16 a[86:87], v17 offset:5152
    v_mfma_f32_16x16x32_bf16 v[248:251], a[32:35], v[100:103], v[248:251]
    ds_read_b64_tr_b16 a[88:89], v16 offset:64
    ds_read_b64_tr_b16 a[90:91], v16 offset:5184
    v_mfma_f32_16x16x32_bf16 v[252:255], a[16:19], v[96:99], v[252:255]
    ds_read_b64_tr_b16 a[92:93], v17 offset:96
    ds_read_b64_tr_b16 a[94:95], v17 offset:5216
    v_mfma_f32_16x16x32_bf16 v[252:255], a[36:39], v[100:103], v[252:255]
    buffer_load_dwordx4 v1, s[48:51], s69 offen offset:2048 sc1 lds
    ds_read_b64_tr_b16 a[96:97], v16 offset:128
    v_mfma_f32_16x16x32_bf16 v[176:179], a[0:3], a[160:163], v[176:179]
    ds_read_b64_tr_b16 a[98:99], v16 offset:5248
    ds_read_b64_tr_b16 a[100:101], v16 offset:10240
    v_mfma_f32_16x16x32_bf16 v[176:179], a[20:23], a[164:167], v[176:179]
    ds_read_b64_tr_b16 a[102:103], v16 offset:15360
    ds_read_b64_tr_b16 a[104:105], v17 offset:10272
    v_mfma_f32_16x16x32_bf16 v[180:183], a[4:7], a[160:163], v[180:183]
    ds_read_b64_tr_b16 a[106:107], v17 offset:15392
    ds_read_b64_tr_b16 a[108:109], v16 offset:10304
    v_mfma_f32_16x16x32_bf16 v[180:183], a[24:27], a[164:167], v[180:183]
    buffer_load_dwordx4 v1, s[48:51], s69 offen offset:3072 sc1 lds
    s_add_u32 m0, s88, 65664
    v_mfma_f32_16x16x32_bf16 v[184:187], a[8:11], a[160:163], v[184:187]
    ds_read_b64_tr_b16 a[110:111], v16 offset:15424
    ds_read_b64_tr_b16 a[112:113], v17 offset:10336
    v_mfma_f32_16x16x32_bf16 v[184:187], a[28:31], a[164:167], v[184:187]
    ds_read_b64_tr_b16 a[114:115], v17 offset:15456
    ds_read_b64_tr_b16 a[116:117], v16 offset:10368
    v_mfma_f32_16x16x32_bf16 v[188:191], a[12:15], a[160:163], v[188:191]
    ds_read_b64_tr_b16 a[118:119], v16 offset:15488
    s_add_u32 s68, s65, 1
    v_mfma_f32_16x16x32_bf16 v[188:191], a[32:35], a[164:167], v[188:191]
    buffer_load_dwordx4 v2, s[48:51], s69 offen offset:0 sc1 lds
    s_and_b32 s68, s68, 3
    v_mfma_f32_16x16x32_bf16 v[192:195], a[16:19], a[160:163], v[192:195]
    s_lshl_b32 s74, s68, 14
    s_add_u32 s21, s74, s0
    v_mfma_f32_16x16x32_bf16 v[192:195], a[36:39], a[164:167], v[192:195]
    s_lshl_b32 s74, s68, 12
    s_add_u32 s26, s74, s1
    v_mfma_f32_16x16x32_bf16 v[196:199], a[0:3], v[128:131], v[196:199]
    s_add_u32 s68, s65, 2
    s_and_b32 s68, s68, 3
    v_mfma_f32_16x16x32_bf16 v[196:199], a[20:23], v[132:135], v[196:199]
    s_lshl_b32 s74, s68, 14
    s_add_u32 s22, s74, s0
    v_mfma_f32_16x16x32_bf16 v[200:203], a[4:7], v[128:131], v[200:203]
    s_lshl_b32 s74, s68, 12
    s_add_u32 s25, s74, s1
    v_mfma_f32_16x16x32_bf16 v[200:203], a[24:27], v[132:135], v[200:203]
    ds_read_b64_tr_b16 a[120:121], v16 offset:20480
    ds_read_b64_tr_b16 a[122:123], v16 offset:25600
    v_mfma_f32_16x16x32_bf16 v[204:207], a[8:11], v[128:131], v[204:207]
    ds_read_b64_tr_b16 a[124:125], v17 offset:20512
    ds_read_b64_tr_b16 a[126:127], v17 offset:25632
    v_mfma_f32_16x16x32_bf16 v[204:207], a[28:31], v[132:135], v[204:207]
    ds_read_b64_tr_b16 a[128:129], v16 offset:20544
    ds_read_b64_tr_b16 a[130:131], v16 offset:25664
    v_mfma_f32_16x16x32_bf16 v[208:211], a[12:15], v[128:131], v[208:211]
    ds_read_b64_tr_b16 a[132:133], v17 offset:20576
    ds_read_b64_tr_b16 a[134:135], v17 offset:25696
    v_mfma_f32_16x16x32_bf16 v[208:211], a[32:35], v[132:135], v[208:211]
    ds_read_b64_tr_b16 a[136:137], v16 offset:20608
    ds_read_b64_tr_b16 a[138:139], v16 offset:25728
    v_mfma_f32_16x16x32_bf16 v[212:215], a[16:19], v[128:131], v[212:215]
    ds_read_b64_tr_b16 a[140:141], v16 offset:30720
    ds_read_b64_tr_b16 a[142:143], v16 offset:35840
    v_mfma_f32_16x16x32_bf16 v[212:215], a[36:39], v[132:135], v[212:215]
    ds_read_b64_tr_b16 a[144:145], v17 offset:30752
    ds_read_b64_tr_b16 a[146:147], v17 offset:35872
    s_waitcnt lgkmcnt(14)
    s_nop 0
    v_mfma_f32_16x16x32_bf16 v[236:239], a[40:43], v[104:107], v[236:239]
    ds_read_b64_tr_b16 a[148:149], v16 offset:30784
    ds_read_b64_tr_b16 a[150:151], v16 offset:35904
    v_mfma_f32_16x16x32_bf16 v[236:239], a[60:63], v[108:111], v[236:239]
    ds_read_b64_tr_b16 a[152:153], v17 offset:30816
    ds_read_b64_tr_b16 a[154:155], v17 offset:35936
    v_mfma_f32_16x16x32_bf16 v[240:243], a[44:47], v[104:107], v[240:243]
    ds_read_b64_tr_b16 a[156:157], v16 offset:30848
    ds_read_b64_tr_b16 a[158:159], v16 offset:35968
    v_mfma_f32_16x16x32_bf16 v[240:243], a[64:67], v[108:111], v[240:243]
    s_lshl_b32 s74, s68, 13
    s_add_u32 s20, s74, s5
    v_mfma_f32_16x16x32_bf16 v[244:247], a[48:51], v[104:107], v[244:247]
    s_add_u32 s68, s65, 3
    s_and_b32 s68, s68, 3
    v_mfma_f32_16x16x32_bf16 v[244:247], a[68:71], v[108:111], v[244:247]
    s_lshl_b32 s74, s68, 14
    s_add_u32 s23, s74, s0
    v_mfma_f32_16x16x32_bf16 v[248:251], a[52:55], v[104:107], v[248:251]
    s_lshl_b32 s74, s68, 12
    s_add_u32 s24, s74, s1
    v_mfma_f32_16x16x32_bf16 v[248:251], a[72:75], v[108:111], v[248:251]
    s_lshl_b32 s68, s68, 13
    s_add_u32 s27, s68, s5
    v_mfma_f32_16x16x32_bf16 v[252:255], a[56:59], v[104:107], v[252:255]
    v_mov_b32_e32 v42, 0
    v_mov_b32_e32 v43, 0
    v_mfma_f32_16x16x32_bf16 v[252:255], a[76:79], v[108:111], v[252:255]
    s_lshl_b32 s11, s82, 5
    s_nop 0
    v_lshl_add_u32 v85, v85, 3, s10
    v_mfma_f32_16x16x32_bf16 v[176:179], a[40:43], a[168:171], v[176:179]
    v_bfe_u32 v30, v0, 2, 4
    v_mul_u32_u24 v30, 176, v30
    v_mfma_f32_16x16x32_bf16 v[176:179], a[60:63], a[172:175], v[176:179]
    s_waitcnt vmcnt(0)
    s_barrier
    v_mfma_f32_16x16x32_bf16 v[180:183], a[44:47], a[168:171], v[180:183]
    ds_read_b128 v[112:115], v18 offset:4096
    ds_read_b128 v[116:119], v18 offset:14336
    v_mfma_f32_16x16x32_bf16 v[180:183], a[64:67], a[172:175], v[180:183]
    ds_read_b128 v[120:123], v18 offset:24576
    ds_read_b128 v[124:127], v18 offset:34816
    v_mfma_f32_16x16x32_bf16 v[184:187], a[48:51], a[168:171], v[184:187]
    ds_read_b128 a[176:179], v21 offset:0
    ds_read_b128 a[180:183], v21 offset:10240
    v_mfma_f32_16x16x32_bf16 v[184:187], a[68:71], a[172:175], v[184:187]
    ds_read_b128 a[184:187], v21 offset:20480
    ds_read_b128 a[188:191], v21 offset:30720
    v_mfma_f32_16x16x32_bf16 v[188:191], a[52:55], a[168:171], v[188:191]
    v_add_u32_e64 v30, v30, v85
    v_mul_u32_u24 v10, 176, v86
    v_mfma_f32_16x16x32_bf16 v[188:191], a[72:75], a[172:175], v[188:191]
    v_add_u32_e32 v10, v10, v85
    v_lshrrev_b32_e32 v84, 4, v0
    v_mfma_f32_16x16x32_bf16 v[192:195], a[56:59], a[168:171], v[192:195]
    v_lshlrev_b32_e64 v86, 4, v86
    v_mul_u32_u24 v31, 176, v84
    v_mfma_f32_16x16x32_bf16 v[192:195], a[76:79], a[172:175], v[192:195]
    v_add3_u32 v87, v31, v86, s10
    v_add_u32_e64 v31, s11, v87
    v_mul_u32_u24 v28, 2560, v84
    v_add_u32_e32 v28, v28, v86
    s_waitcnt lgkmcnt(7)
    v_mfma_f32_16x16x32_bf16 v[236:239], a[80:83], v[112:115], v[236:239]
    v_add_u32_e64 v29, s11, v28
    s_lshl_b32 s11, s82, 7
    s_waitcnt lgkmcnt(6)
    v_mfma_f32_16x16x32_bf16 v[236:239], a[100:103], v[116:119], v[236:239]
    s_sub_u32 s11, 128, s11
    v_cmp_gt_u32 vcc, 32, v86
    s_waitcnt lgkmcnt(5)
    v_mfma_f32_16x16x32_bf16 v[236:239], a[120:123], v[120:123], v[236:239]
    v_add_u32_e64 v87, s11, v87
    v_add_u32_e32 v28, s11, v28
    s_waitcnt lgkmcnt(4)
    v_mfma_f32_16x16x32_bf16 v[236:239], a[140:143], v[124:127], v[236:239]
    v_cndmask_b32 v28, v91, v28, vcc
    v_mul_u32_u24 v84, 1639, v0
    v_mfma_f32_16x16x32_bf16 v[240:243], a[84:87], v[112:115], v[240:243]
    v_lshrrev_b32_e64 v84, 16, v84
    v_mul_u32_u24 v85, 40, v84
    v_mfma_f32_16x16x32_bf16 v[240:243], a[104:107], v[116:119], v[240:243]
    ds_read_b128 v[144:147], v22 offset:0
    ds_read_b128 v[148:151], v22 offset:10240
    v_mfma_f32_16x16x32_bf16 v[240:243], a[124:127], v[120:123], v[240:243]
    v_cvt_pk_bf16_f32 v32, v236, v237
    v_cvt_pk_bf16_f32 v33, v238, v239
    v_mfma_f32_16x16x32_bf16 v[240:243], a[144:147], v[124:127], v[240:243]
    ds_read_b128 v[152:155], v22 offset:20480
    ds_read_b128 v[80:83], v22 offset:30720
    v_mfma_f32_16x16x32_bf16 v[244:247], a[88:91], v[112:115], v[244:247]
    v_sub_u32 v85, v0, v85
    v_cmp_gt_u32 vcc, 4, v84
    v_mfma_f32_16x16x32_bf16 v[244:247], a[108:111], v[116:119], v[244:247]
    v_mul_u32_u24 v11, 2560, v84
    v_lshl_add_u32 v11, v85, 2, v11
    v_mfma_f32_16x16x32_bf16 v[244:247], a[128:131], v[120:123], v[244:247]
    v_cvt_pk_bf16_f32 v34, v240, v241
    v_cvt_pk_bf16_f32 v35, v242, v243
    v_mfma_f32_16x16x32_bf16 v[244:247], a[148:151], v[124:127], v[244:247]
    buffer_store_dwordx4 v[32:35], v25, s[48:51], s0 offen offset:0 sc1
    v_cndmask_b32 v11, v91, v11, vcc
    v_mfma_f32_16x16x32_bf16 v[248:251], a[92:95], v[112:115], v[248:251]
    v_and_b32_e32 v84, 3, v84
    v_mul_u32_u24 v12, 176, v84
    v_mfma_f32_16x16x32_bf16 v[248:251], a[112:115], v[116:119], v[248:251]
    v_lshl_add_u32 v12, v85, 2, v12
    v_add_u32_e64 v12, s10, v12
    v_mfma_f32_16x16x32_bf16 v[248:251], a[132:135], v[120:123], v[248:251]
    v_cvt_pk_bf16_f32 v36, v244, v245
    v_cvt_pk_bf16_f32 v37, v246, v247
    v_mfma_f32_16x16x32_bf16 v[248:251], a[152:155], v[124:127], v[248:251]
    s_mov_b32 s75, 0xffff0000
    s_nop 0
    v_mfma_f32_16x16x32_bf16 v[252:255], a[96:99], v[112:115], v[252:255]
    s_nop 0
    s_nop 0
    v_mfma_f32_16x16x32_bf16 v[252:255], a[116:119], v[116:119], v[252:255]
    s_nop 0
    s_nop 0
    s_nop 0
    v_mfma_f32_16x16x32_bf16 v[252:255], a[136:139], v[120:123], v[252:255]
    v_cvt_pk_bf16_f32 v38, v248, v249
    v_cvt_pk_bf16_f32 v39, v250, v251
    v_mfma_f32_16x16x32_bf16 v[252:255], a[156:159], v[124:127], v[252:255]
    buffer_store_dwordx4 v[36:39], v25, s[48:51], s0 offen offset:256 sc1
    s_nop 0
    s_waitcnt lgkmcnt(0)
    v_mfma_f32_16x16x32_bf16 v[176:179], a[80:83], a[176:179], v[176:179]
    s_nop 0
    s_nop 0
    v_mfma_f32_16x16x32_bf16 v[176:179], a[100:103], a[180:183], v[176:179]
    s_nop 0
    s_nop 0
    v_mfma_f32_16x16x32_bf16 v[176:179], a[120:123], a[184:187], v[176:179]
    v_cvt_pk_bf16_f32 v40, v252, v253
    v_cvt_pk_bf16_f32 v41, v254, v255
    v_mfma_f32_16x16x32_bf16 v[176:179], a[140:143], a[188:191], v[176:179]
    s_nop 0
    s_nop 0
    v_mfma_f32_16x16x32_bf16 v[180:183], a[84:87], a[176:179], v[180:183]
    s_nop 0
    s_nop 0
    v_mfma_f32_16x16x32_bf16 v[180:183], a[104:107], a[180:183], v[180:183]
    ds_read_b128 a[192:195], v93 offset:0
    buffer_store_dwordx4 v[40:43], v25, s[48:51], s0 offen offset:512 sc1
    v_mfma_f32_16x16x32_bf16 v[180:183], a[124:127], a[184:187], v[180:183]
    v_cvt_pk_bf16_f32 v44, v176, v177
    v_cvt_pk_bf16_f32 v45, v178, v179
    v_mfma_f32_16x16x32_bf16 v[180:183], a[144:147], a[188:191], v[180:183]
    ds_read_b128 a[196:199], v93 offset:10240
    ds_read_b128 a[200:203], v93 offset:20480
    v_mfma_f32_16x16x32_bf16 v[184:187], a[88:91], a[176:179], v[184:187]
    ds_read_b128 a[204:207], v93 offset:30720
    ds_read_b128 a[208:211], v23 offset:0
    v_mfma_f32_16x16x32_bf16 v[184:187], a[108:111], a[180:183], v[184:187]
    ds_read_b128 a[212:215], v23 offset:10240
    ds_read_b128 a[216:219], v23 offset:20480
    v_mfma_f32_16x16x32_bf16 v[184:187], a[128:131], a[184:187], v[184:187]
    v_cvt_pk_bf16_f32 v46, v180, v181
    v_cvt_pk_bf16_f32 v47, v182, v183
    v_mfma_f32_16x16x32_bf16 v[184:187], a[148:151], a[188:191], v[184:187]
    ds_read_b128 a[220:223], v23 offset:30720
    s_nop 0
    v_mfma_f32_16x16x32_bf16 v[188:191], a[92:95], a[176:179], v[188:191]
    buffer_store_dwordx4 v[44:47], v1, s[48:51], s21 offen offset:0 sc1
    s_nop 0
    v_mfma_f32_16x16x32_bf16 v[188:191], a[112:115], a[180:183], v[188:191]
    s_nop 0
    s_nop 0
    v_mfma_f32_16x16x32_bf16 v[188:191], a[132:135], a[184:187], v[188:191]
    v_cvt_pk_bf16_f32 v48, v184, v185
    v_cvt_pk_bf16_f32 v49, v186, v187
    v_mfma_f32_16x16x32_bf16 v[188:191], a[152:155], a[188:191], v[188:191]
    s_nop 0
    s_nop 0
    v_mfma_f32_16x16x32_bf16 v[192:195], a[96:99], a[176:179], v[192:195]
    s_nop 0
    s_nop 0
    v_mfma_f32_16x16x32_bf16 v[192:195], a[116:119], a[180:183], v[192:195]
    s_nop 0
    s_nop 0
    v_mfma_f32_16x16x32_bf16 v[192:195], a[136:139], a[184:187], v[192:195]
    v_cvt_pk_bf16_f32 v50, v188, v189
    v_cvt_pk_bf16_f32 v51, v190, v191
    v_mfma_f32_16x16x32_bf16 v[192:195], a[156:159], a[188:191], v[192:195]
    buffer_store_dwordx4 v[48:51], v1, s[48:51], s21 offen offset:1024 sc1
    s_nop 0
    v_mfma_f32_16x16x32_bf16 v[196:199], a[40:43], v[136:139], v[196:199]
    s_nop 0
    s_nop 0
    v_mfma_f32_16x16x32_bf16 v[196:199], a[60:63], v[140:143], v[196:199]
    s_nop 0
    s_nop 0
    s_nop 0
    v_mfma_f32_16x16x32_bf16 v[196:199], a[80:83], v[144:147], v[196:199]
    v_cvt_pk_bf16_f32 v52, v192, v193
    v_cvt_pk_bf16_f32 v53, v194, v195
    v_mfma_f32_16x16x32_bf16 v[196:199], a[100:103], v[148:151], v[196:199]
    v_mfma_f32_16x16x32_bf16 v[196:199], a[120:123], v[152:155], v[196:199]
    v_mfma_f32_16x16x32_bf16 v[196:199], a[140:143], v[80:83], v[196:199]
    s_nop 0
    buffer_store_dwordx2 v[52:53], v26, s[48:51], s21 offen offset:2048 sc1
    v_mfma_f32_16x16x32_bf16 v[200:203], a[44:47], v[136:139], v[200:203]
    s_nop 0
    s_nop 0
    v_mfma_f32_16x16x32_bf16 v[200:203], a[64:67], v[140:143], v[200:203]
    s_nop 0
    s_nop 0
    s_nop 0
    v_mfma_f32_16x16x32_bf16 v[200:203], a[84:87], v[144:147], v[200:203]
    v_cvt_pk_bf16_f32 v56, v196, v197
    v_cvt_pk_bf16_f32 v57, v198, v199
    v_mfma_f32_16x16x32_bf16 v[200:203], a[104:107], v[148:151], v[200:203]
    v_mfma_f32_16x16x32_bf16 v[200:203], a[124:127], v[152:155], v[200:203]
    v_mfma_f32_16x16x32_bf16 v[200:203], a[144:147], v[80:83], v[200:203]
    s_nop 0
    s_nop 0
    v_mfma_f32_16x16x32_bf16 v[204:207], a[48:51], v[136:139], v[204:207]
    s_nop 0
    s_nop 0
    v_mfma_f32_16x16x32_bf16 v[204:207], a[68:71], v[140:143], v[204:207]
    ds_read_b128 a[224:227], v5 offset:0
    ds_read_b128 a[228:231], v5 offset:10240
    v_mfma_f32_16x16x32_bf16 v[204:207], a[88:91], v[144:147], v[204:207]
    v_cvt_pk_bf16_f32 v58, v200, v201
    v_cvt_pk_bf16_f32 v59, v202, v203
    v_mfma_f32_16x16x32_bf16 v[204:207], a[108:111], v[148:151], v[204:207]
    buffer_store_dwordx4 v[56:59], v1, s[48:51], s22 offen offset:0 sc1
    ds_read_b128 a[232:235], v5 offset:20480
    v_mfma_f32_16x16x32_bf16 v[204:207], a[128:131], v[152:155], v[204:207]
    ds_read_b128 a[236:239], v5 offset:30720
    ds_read_b128 a[240:243], v20 offset:0
    v_mfma_f32_16x16x32_bf16 v[204:207], a[148:151], v[80:83], v[204:207]
    ds_read_b128 a[244:247], v20 offset:10240
    ds_read_b128 a[248:251], v20 offset:20480
    v_mfma_f32_16x16x32_bf16 v[208:211], a[52:55], v[136:139], v[208:211]
    ds_read_b128 a[252:255], v20 offset:30720
    s_nop 0
    v_mfma_f32_16x16x32_bf16 v[208:211], a[72:75], v[140:143], v[208:211]
    s_nop 0
    s_nop 0
    s_nop 0
    v_mfma_f32_16x16x32_bf16 v[208:211], a[92:95], v[144:147], v[208:211]
    v_cvt_pk_bf16_f32 v60, v204, v205
    v_cvt_pk_bf16_f32 v61, v206, v207
    v_mfma_f32_16x16x32_bf16 v[208:211], a[112:115], v[148:151], v[208:211]
    v_mfma_f32_16x16x32_bf16 v[208:211], a[132:135], v[152:155], v[208:211]
    v_mfma_f32_16x16x32_bf16 v[208:211], a[152:155], v[80:83], v[208:211]
    s_nop 0
    s_nop 0
    v_mfma_f32_16x16x32_bf16 v[212:215], a[56:59], v[136:139], v[212:215]
    s_nop 0
    s_nop 0
    v_mfma_f32_16x16x32_bf16 v[212:215], a[76:79], v[140:143], v[212:215]
    s_nop 0
    s_nop 0
    v_mfma_f32_16x16x32_bf16 v[212:215], a[96:99], v[144:147], v[212:215]
    v_cvt_pk_bf16_f32 v62, v208, v209
    v_cvt_pk_bf16_f32 v63, v210, v211
    v_mfma_f32_16x16x32_bf16 v[212:215], a[116:119], v[148:151], v[212:215]
    buffer_store_dwordx4 v[60:63], v1, s[48:51], s22 offen offset:1024 sc1
    v_mfma_f32_16x16x32_bf16 v[212:215], a[136:139], v[152:155], v[212:215]
    v_mfma_f32_16x16x32_bf16 v[212:215], a[156:159], v[80:83], v[212:215]
    s_nop 0
    s_nop 0
    s_waitcnt lgkmcnt(0)
    v_mfma_f32_16x16x32_bf16 v[216:219], a[0:3], a[192:195], v[216:219]
    s_nop 0
    s_nop 0
    v_mfma_f32_16x16x32_bf16 v[216:219], a[20:23], a[196:199], v[216:219]
    s_nop 0
    s_nop 0
    s_nop 0
    v_mfma_f32_16x16x32_bf16 v[216:219], a[40:43], a[200:203], v[216:219]
    v_cvt_pk_bf16_f32 v64, v212, v213
    v_cvt_pk_bf16_f32 v65, v214, v215
    v_mfma_f32_16x16x32_bf16 v[216:219], a[60:63], a[204:207], v[216:219]
    buffer_store_dwordx2 v[64:65], v26, s[48:51], s22 offen offset:2048 sc1
    v_mfma_f32_16x16x32_bf16 v[216:219], a[80:83], a[208:211], v[216:219]
    v_mfma_f32_16x16x32_bf16 v[216:219], a[100:103], a[212:215], v[216:219]
    v_mfma_f32_16x16x32_bf16 v[216:219], a[120:123], a[216:219], v[216:219]
    v_mfma_f32_16x16x32_bf16 v[216:219], a[140:143], a[220:223], v[216:219]
    s_nop 0
    s_nop 0
    v_mfma_f32_16x16x32_bf16 v[220:223], a[4:7], a[192:195], v[220:223]
    s_nop 0
    s_nop 0
    v_mfma_f32_16x16x32_bf16 v[220:223], a[24:27], a[196:199], v[220:223]
    s_nop 0
    s_nop 0
    v_mfma_f32_16x16x32_bf16 v[220:223], a[44:47], a[200:203], v[220:223]
    v_cvt_pk_bf16_f32 v68, v216, v217
    v_cvt_pk_bf16_f32 v69, v218, v219
    v_mfma_f32_16x16x32_bf16 v[220:223], a[64:67], a[204:207], v[220:223]
    v_mfma_f32_16x16x32_bf16 v[220:223], a[84:87], a[208:211], v[220:223]
    v_mfma_f32_16x16x32_bf16 v[220:223], a[104:107], a[212:215], v[220:223]
    v_mfma_f32_16x16x32_bf16 v[220:223], a[124:127], a[216:219], v[220:223]
    v_mfma_f32_16x16x32_bf16 v[220:223], a[144:147], a[220:223], v[220:223]
    s_nop 0
    s_nop 0
    v_mfma_f32_16x16x32_bf16 v[224:227], a[8:11], a[192:195], v[224:227]
    s_nop 0
    s_nop 0
    v_mfma_f32_16x16x32_bf16 v[224:227], a[28:31], a[196:199], v[224:227]
    s_nop 0
    s_nop 0
    v_mfma_f32_16x16x32_bf16 v[224:227], a[48:51], a[200:203], v[224:227]
    v_cvt_pk_bf16_f32 v70, v220, v221
    v_cvt_pk_bf16_f32 v71, v222, v223
    v_mfma_f32_16x16x32_bf16 v[224:227], a[68:71], a[204:207], v[224:227]
    buffer_store_dwordx4 v[68:71], v1, s[48:51], s23 offen offset:0 sc1
    v_mfma_f32_16x16x32_bf16 v[224:227], a[88:91], a[208:211], v[224:227]
    v_mfma_f32_16x16x32_bf16 v[224:227], a[108:111], a[212:215], v[224:227]
    v_mfma_f32_16x16x32_bf16 v[224:227], a[128:131], a[216:219], v[224:227]
    v_mfma_f32_16x16x32_bf16 v[224:227], a[148:151], a[220:223], v[224:227]
    s_nop 0
    s_nop 0
    v_mfma_f32_16x16x32_bf16 v[228:231], a[12:15], a[192:195], v[228:231]
    s_nop 0
    s_nop 0
    v_mfma_f32_16x16x32_bf16 v[228:231], a[32:35], a[196:199], v[228:231]
    s_waitcnt vmcnt(4)
    s_nop 0
    buffer_store_dword v6, v88, s[48:51], s5 offen sc1
    v_mfma_f32_16x16x32_bf16 v[228:231], a[52:55], a[200:203], v[228:231]
    v_cvt_pk_bf16_f32 v72, v224, v225
    v_cvt_pk_bf16_f32 v73, v226, v227
    v_mfma_f32_16x16x32_bf16 v[228:231], a[72:75], a[204:207], v[228:231]
    v_mfma_f32_16x16x32_bf16 v[228:231], a[92:95], a[208:211], v[228:231]
    v_mfma_f32_16x16x32_bf16 v[228:231], a[112:115], a[212:215], v[228:231]
    v_mfma_f32_16x16x32_bf16 v[228:231], a[132:135], a[216:219], v[228:231]
    v_mfma_f32_16x16x32_bf16 v[228:231], a[152:155], a[220:223], v[228:231]
    s_nop 0
    s_nop 0
    v_mfma_f32_16x16x32_bf16 v[232:235], a[16:19], a[192:195], v[232:235]
    s_nop 0
    s_nop 0
    v_mfma_f32_16x16x32_bf16 v[232:235], a[36:39], a[196:199], v[232:235]
    s_nop 0
    s_nop 0
    v_mfma_f32_16x16x32_bf16 v[232:235], a[56:59], a[200:203], v[232:235]
    v_cvt_pk_bf16_f32 v74, v228, v229
    v_cvt_pk_bf16_f32 v75, v230, v231
    v_mfma_f32_16x16x32_bf16 v[232:235], a[76:79], a[204:207], v[232:235]
    buffer_store_dwordx4 v[72:75], v1, s[48:51], s23 offen offset:1024 sc1
    v_mfma_f32_16x16x32_bf16 v[232:235], a[96:99], a[208:211], v[232:235]
    v_mfma_f32_16x16x32_bf16 v[232:235], a[116:119], a[212:215], v[232:235]
    v_mfma_f32_16x16x32_bf16 v[232:235], a[136:139], a[216:219], v[232:235]
    v_mfma_f32_16x16x32_bf16 v[232:235], a[156:159], a[220:223], v[232:235]
    s_nop 0
    s_nop 0
    v_mfma_f32_16x16x32_bf16 v[156:159], a[0:3], a[224:227], v[156:159]
    s_nop 0
    s_nop 0
    v_mfma_f32_16x16x32_bf16 v[156:159], a[20:23], a[228:231], v[156:159]
    s_nop 0
    s_nop 0
    v_mfma_f32_16x16x32_bf16 v[156:159], a[40:43], a[232:235], v[156:159]
    v_cvt_pk_bf16_f32 v76, v232, v233
    v_cvt_pk_bf16_f32 v77, v234, v235
    v_mfma_f32_16x16x32_bf16 v[156:159], a[60:63], a[236:239], v[156:159]
    buffer_store_dwordx2 v[76:77], v26, s[48:51], s23 offen offset:2048 sc1
    v_mfma_f32_16x16x32_bf16 v[156:159], a[80:83], a[240:243], v[156:159]
    v_mfma_f32_16x16x32_bf16 v[156:159], a[100:103], a[244:247], v[156:159]
    v_mfma_f32_16x16x32_bf16 v[156:159], a[120:123], a[248:251], v[156:159]
    v_mfma_f32_16x16x32_bf16 v[156:159], a[140:143], a[252:255], v[156:159]
    v_mfma_f32_16x16x32_bf16 v[160:163], a[4:7], a[224:227], v[160:163]
    v_mfma_f32_16x16x32_bf16 v[160:163], a[24:27], a[228:231], v[160:163]
    v_mfma_f32_16x16x32_bf16 v[160:163], a[44:47], a[232:235], v[160:163]
    v_mfma_f32_16x16x32_bf16 v[160:163], a[64:67], a[236:239], v[160:163]
    v_mfma_f32_16x16x32_bf16 v[160:163], a[84:87], a[240:243], v[160:163]
    v_mfma_f32_16x16x32_bf16 v[160:163], a[104:107], a[244:247], v[160:163]
    v_mfma_f32_16x16x32_bf16 v[160:163], a[124:127], a[248:251], v[160:163]
    v_mfma_f32_16x16x32_bf16 v[160:163], a[144:147], a[252:255], v[160:163]
    v_mfma_f32_16x16x32_bf16 v[164:167], a[8:11], a[224:227], v[164:167]
    v_mfma_f32_16x16x32_bf16 v[164:167], a[28:31], a[228:231], v[164:167]
    v_mfma_f32_16x16x32_bf16 v[164:167], a[48:51], a[232:235], v[164:167]
    v_mfma_f32_16x16x32_bf16 v[164:167], a[68:71], a[236:239], v[164:167]
    v_mfma_f32_16x16x32_bf16 v[164:167], a[88:91], a[240:243], v[164:167]
    v_mfma_f32_16x16x32_bf16 v[164:167], a[108:111], a[244:247], v[164:167]
    v_mfma_f32_16x16x32_bf16 v[164:167], a[128:131], a[248:251], v[164:167]
    v_mfma_f32_16x16x32_bf16 v[164:167], a[148:151], a[252:255], v[164:167]
    v_mfma_f32_16x16x32_bf16 v[168:171], a[12:15], a[224:227], v[168:171]
    v_mfma_f32_16x16x32_bf16 v[168:171], a[32:35], a[228:231], v[168:171]
    v_mfma_f32_16x16x32_bf16 v[168:171], a[52:55], a[232:235], v[168:171]
    v_mfma_f32_16x16x32_bf16 v[168:171], a[72:75], a[236:239], v[168:171]
    v_mfma_f32_16x16x32_bf16 v[168:171], a[92:95], a[240:243], v[168:171]
L_pad7:
    s_cbranch_execz L_back
    s_nop 0
    v_mfma_f32_16x16x32_bf16 v[168:171], a[112:115], a[244:247], v[168:171]
    v_mfma_f32_16x16x32_bf16 v[168:171], a[132:135], a[248:251], v[168:171]
    v_mfma_f32_16x16x32_bf16 v[168:171], a[152:155], a[252:255], v[168:171]
    v_mfma_f32_16x16x32_bf16 v[172:175], a[16:19], a[224:227], v[172:175]
    v_mfma_f32_16x16x32_bf16 v[172:175], a[36:39], a[228:231], v[172:175]
    v_mfma_f32_16x16x32_bf16 v[172:175], a[56:59], a[232:235], v[172:175]
    v_mfma_f32_16x16x32_bf16 v[172:175], a[76:79], a[236:239], v[172:175]
    v_mfma_f32_16x16x32_bf16 v[172:175], a[96:99], a[240:243], v[172:175]
    v_mfma_f32_16x16x32_bf16 v[172:175], a[116:119], a[244:247], v[172:175]
    v_mfma_f32_16x16x32_bf16 v[172:175], a[136:139], a[248:251], v[172:175]
    v_mfma_f32_16x16x32_bf16 v[172:175], a[156:159], a[252:255], v[172:175]
    s_buffer_load_dwordx8 s[12:19], s[48:51], s9 glc
    s_waitcnt vmcnt(4)
    buffer_store_dword v6, v24, s[48:51], s20 offen offset:24 sc1
    s_waitcnt vmcnt(1)
    buffer_store_dword v6, v24, s[48:51], s27 offen offset:28 sc1
    s_waitcnt lgkmcnt(0)
    s_cmp_eq_u32 s13, 1
    s_cbranch_scc1 L_ok4
    s_mov_b32 s91, 0
L_spin4:
    s_buffer_load_dwordx8 s[12:19], s[48:51], s9 glc
    s_waitcnt lgkmcnt(0)
    s_cmp_eq_u32 s13, 1
    s_cbranch_scc1 L_ok4
    s_add_u32 s91, s91, 1
    s_cmp_lt_u32 s91, 250000
    s_cbranch_scc1 L_spin4
.p2align 3
L_ok4:
    buffer_load_dwordx4 v[96:99], v1, s[48:51], s24 offen offset:0 sc1
    buffer_load_dwordx4 v[100:103], v1, s[48:51], s24 offen offset:1024 sc1
    buffer_load_dwordx2 v[104:105], v26, s[48:51], s24 offen offset:2048 sc1
    s_cmp_eq_u32 s14, 1
    s_cbranch_scc1 L_ok5
    s_mov_b32 s91, 0
L_spin5:
    s_buffer_load_dwordx8 s[12:19], s[48:51], s9 glc
    s_waitcnt lgkmcnt(0)
    s_cmp_eq_u32 s14, 1
    s_cbranch_scc1 L_ok5
    s_add_u32 s91, s91, 1
    s_cmp_lt_u32 s91, 250000
    s_cbranch_scc1 L_spin5
.p2align 3
L_ok5:
    s_cmp_eq_u32 s15, 1
    s_cbranch_scc1 L_ok6
    s_mov_b32 s91, 0
L_spin6:
    s_buffer_load_dwordx8 s[12:19], s[48:51], s9 glc
    s_waitcnt lgkmcnt(0)
    s_cmp_eq_u32 s15, 1
    s_cbranch_scc1 L_ok6
    s_add_u32 s91, s91, 1
    s_cmp_lt_u32 s91, 250000
    s_cbranch_scc1 L_spin6
.p2align 3
L_ok6:
    buffer_load_dwordx4 v[132:135], v27, s[48:51], s1 offen offset:0 sc1
    buffer_load_dwordx4 v[136:139], v27, s[48:51], s1 offen offset:256 sc1
    buffer_load_dwordx2 v[140:141], v27, s[48:51], s1 offen offset:512 sc1
    s_cmp_eq_u32 s18, 1
    s_cbranch_scc1 L_ok7
    s_mov_b32 s91, 0
L_spin7:
    s_buffer_load_dwordx8 s[12:19], s[48:51], s9 glc
    s_waitcnt lgkmcnt(0)
    s_cmp_eq_u32 s18, 1
    s_cbranch_scc1 L_ok7
    s_add_u32 s91, s91, 1
    s_cmp_lt_u32 s91, 250000
    s_cbranch_scc1 L_spin7
.p2align 3
L_ok7:
    buffer_load_dwordx4 v[108:111], v1, s[48:51], s25 offen offset:0 sc1
    buffer_load_dwordx4 v[112:115], v1, s[48:51], s25 offen offset:1024 sc1
    buffer_load_dwordx2 v[116:117], v26, s[48:51], s25 offen offset:2048 sc1
    s_cmp_eq_u32 s19, 1
    s_cbranch_scc1 L_ok8
    s_mov_b32 s91, 0
L_spin8:
    s_buffer_load_dwordx8 s[12:19], s[48:51], s9 glc
    s_waitcnt lgkmcnt(0)
    s_cmp_eq_u32 s19, 1
    s_cbranch_scc1 L_ok8
    s_add_u32 s91, s91, 1
    s_cmp_lt_u32 s91, 250000
    s_cbranch_scc1 L_spin8
.p2align 3
L_ok8:
    buffer_load_dwordx4 v[120:123], v1, s[48:51], s26 offen offset:0 sc1
    buffer_load_dwordx4 v[124:127], v1, s[48:51], s26 offen offset:1024 sc1
    buffer_load_dwordx2 v[128:129], v26, s[48:51], s26 offen offset:2048 sc1
    s_waitcnt vmcnt(9)
    v_lshlrev_b32_e32 v44, 16, v96
    v_and_b32_e64 v45, s75, v96
    v_pk_add_f32 v[156:157], v[156:157], v[44:45]
    v_lshlrev_b32_e32 v46, 16, v97
    v_and_b32_e32 v47, s75, v97
    v_pk_add_f32 v[158:159], v[158:159], v[46:47]
    v_lshlrev_b32_e32 v48, 16, v98
    v_and_b32_e32 v49, s75, v98
    v_pk_add_f32 v[160:161], v[160:161], v[48:49]
    v_lshlrev_b32_e32 v50, 16, v99
    v_and_b32_e32 v51, s75, v99
    v_pk_add_f32 v[162:163], v[162:163], v[50:51]
    v_lshlrev_b32_e32 v44, 16, v100
    v_and_b32_e32 v45, s75, v100
    v_pk_add_f32 v[164:165], v[164:165], v[44:45]
    v_lshlrev_b32_e32 v46, 16, v101
    v_and_b32_e32 v47, s75, v101
    v_pk_add_f32 v[166:167], v[166:167], v[46:47]
    v_lshlrev_b32_e32 v48, 16, v102
    v_and_b32_e32 v49, s75, v102
    v_pk_add_f32 v[168:169], v[168:169], v[48:49]
    v_lshlrev_b32_e32 v50, 16, v103
    v_and_b32_e32 v51, s75, v103
    v_pk_add_f32 v[170:171], v[170:171], v[50:51]
    v_lshlrev_b32_e32 v44, 16, v104
    v_and_b32_e32 v45, s75, v104
    v_pk_add_f32 v[172:173], v[172:173], v[44:45]
    v_lshlrev_b32_e32 v46, 16, v105
    v_and_b32_e32 v47, s75, v105
    v_pk_add_f32 v[174:175], v[174:175], v[46:47]
    s_waitcnt vmcnt(6)
    v_lshlrev_b32_e32 v32, 16, v132
    v_and_b32_e64 v33, s75, v132
    v_cndmask_b32_e64 v236, v32, v236, s[72:73]
    v_cndmask_b32_e64 v237, v33, v237, s[72:73]
    v_lshlrev_b32_e64 v34, 16, v133
    v_add_f32_dpp v32, v236, v236 row_ror:8 row_mask:0xf bank_mask:0xf
    v_add_f32_dpp v33, v237, v237 row_ror:8 row_mask:0xf bank_mask:0xf
    v_and_b32_e64 v35, s75, v133
    v_add_f32_dpp v236, v32, v32 row_ror:4 row_mask:0xf bank_mask:0xf
    v_add_f32_dpp v237, v33, v33 row_ror:4 row_mask:0xf bank_mask:0xf
    v_cvt_pk_bf16_f32 v62, v236, v237
    v_cndmask_b32_e64 v238, v34, v238, s[72:73]
    v_cndmask_b32_e64 v239, v35, v239, s[72:73]
    v_lshlrev_b32_e64 v36, 16, v134
    v_add_f32_dpp v34, v238, v238 row_ror:8 row_mask:0xf bank_mask:0xf
    v_add_f32_dpp v35, v239, v239 row_ror:8 row_mask:0xf bank_mask:0xf
    v_and_b32_e64 v37, s75, v134
    v_add_f32_dpp v238, v34, v34 row_ror:4 row_mask:0xf bank_mask:0xf
    v_add_f32_dpp v239, v35, v35 row_ror:4 row_mask:0xf bank_mask:0xf
    v_cvt_pk_bf16_f32 v63, v238, v239
    ds_write_b64 v10, v[62:63] offset:3072
    v_cndmask_b32_e64 v240, v36, v240, s[72:73]
    v_cndmask_b32_e64 v241, v37, v241, s[72:73]
    v_lshlrev_b32_e64 v38, 16, v135
    v_add_f32_dpp v36, v240, v240 row_ror:8 row_mask:0xf bank_mask:0xf
    v_add_f32_dpp v37, v241, v241 row_ror:8 row_mask:0xf bank_mask:0xf
    v_and_b32_e64 v39, s75, v135
    v_add_f32_dpp v240, v36, v36 row_ror:4 row_mask:0xf bank_mask:0xf
    v_add_f32_dpp v241, v37, v37 row_ror:4 row_mask:0xf bank_mask:0xf
    v_cvt_pk_bf16_f32 v64, v240, v241
    v_cndmask_b32_e64 v242, v38, v242, s[72:73]
    v_cndmask_b32_e64 v243, v39, v243, s[72:73]
    v_lshlrev_b32_e64 v40, 16, v136
    v_add_f32_dpp v38, v242, v242 row_ror:8 row_mask:0xf bank_mask:0xf
    v_add_f32_dpp v39, v243, v243 row_ror:8 row_mask:0xf bank_mask:0xf
    v_and_b32_e64 v41, s75, v136
    v_add_f32_dpp v242, v38, v38 row_ror:4 row_mask:0xf bank_mask:0xf
    v_add_f32_dpp v243, v39, v39 row_ror:4 row_mask:0xf bank_mask:0xf
    v_cvt_pk_bf16_f32 v65, v242, v243
    ds_write_b64 v10, v[64:65] offset:3104
    v_cndmask_b32_e64 v244, v40, v244, s[72:73]
    v_cndmask_b32_e64 v245, v41, v245, s[72:73]
    v_lshlrev_b32_e64 v42, 16, v137
    v_add_f32_dpp v40, v244, v244 row_ror:8 row_mask:0xf bank_mask:0xf
    v_add_f32_dpp v41, v245, v245 row_ror:8 row_mask:0xf bank_mask:0xf
    v_and_b32_e64 v43, s75, v137
    v_add_f32_dpp v244, v40, v40 row_ror:4 row_mask:0xf bank_mask:0xf
    v_add_f32_dpp v245, v41, v41 row_ror:4 row_mask:0xf bank_mask:0xf
    v_cvt_pk_bf16_f32 v66, v244, v245
    v_cndmask_b32_e64 v246, v42, v246, s[72:73]
    v_cndmask_b32_e64 v247, v43, v247, s[72:73]
    v_lshlrev_b32_e64 v32, 16, v138
    v_add_f32_dpp v42, v246, v246 row_ror:8 row_mask:0xf bank_mask:0xf
    v_add_f32_dpp v43, v247, v247 row_ror:8 row_mask:0xf bank_mask:0xf
    v_and_b32_e64 v33, s75, v138
    v_add_f32_dpp v246, v42, v42 row_ror:4 row_mask:0xf bank_mask:0xf
    v_add_f32_dpp v247, v43, v43 row_ror:4 row_mask:0xf bank_mask:0xf
    v_cvt_pk_bf16_f32 v67, v246, v247
    ds_write_b64 v10, v[66:67] offset:3136
    v_cndmask_b32_e64 v248, v32, v248, s[72:73]
    v_cndmask_b32_e64 v249, v33, v249, s[72:73]
    v_lshlrev_b32_e64 v34, 16, v139
    v_add_f32_dpp v32, v248, v248 row_ror:8 row_mask:0xf bank_mask:0xf
    v_add_f32_dpp v33, v249, v249 row_ror:8 row_mask:0xf bank_mask:0xf
    v_and_b32_e64 v35, s75, v139
    v_add_f32_dpp v248, v32, v32 row_ror:4 row_mask:0xf bank_mask:0xf
    v_add_f32_dpp v249, v33, v33 row_ror:4 row_mask:0xf bank_mask:0xf
    v_cvt_pk_bf16_f32 v68, v248, v249
    v_cndmask_b32_e64 v250, v34, v250, s[72:73]
    v_cndmask_b32_e64 v251, v35, v251, s[72:73]
    v_lshlrev_b32_e64 v36, 16, v140
    v_add_f32_dpp v34, v250, v250 row_ror:8 row_mask:0xf bank_mask:0xf
    v_add_f32_dpp v35, v251, v251 row_ror:8 row_mask:0xf bank_mask:0xf
    v_and_b32_e64 v37, s75, v140
    v_add_f32_dpp v250, v34, v34 row_ror:4 row_mask:0xf bank_mask:0xf
    v_add_f32_dpp v251, v35, v35 row_ror:4 row_mask:0xf bank_mask:0xf
    v_cvt_pk_bf16_f32 v69, v250, v251
    ds_write_b64 v10, v[68:69] offset:3168
    v_cndmask_b32_e64 v252, v36, v252, s[72:73]
    v_cndmask_b32_e64 v253, v37, v253, s[72:73]
    v_lshlrev_b32_e64 v38, 16, v141
    v_add_f32_dpp v36, v252, v252 row_ror:8 row_mask:0xf bank_mask:0xf
    v_add_f32_dpp v37, v253, v253 row_ror:8 row_mask:0xf bank_mask:0xf
    v_and_b32_e64 v39, s75, v141
    v_add_f32_dpp v252, v36, v36 row_ror:4 row_mask:0xf bank_mask:0xf
    v_add_f32_dpp v253, v37, v37 row_ror:4 row_mask:0xf bank_mask:0xf
    v_cvt_pk_bf16_f32 v70, v252, v253
    v_cndmask_b32_e64 v254, v38, v254, s[72:73]
    v_cndmask_b32_e64 v255, v39, v255, s[72:73]
    s_nop 0
    v_add_f32_dpp v38, v254, v254 row_ror:8 row_mask:0xf bank_mask:0xf
    v_add_f32_dpp v39, v255, v255 row_ror:8 row_mask:0xf bank_mask:0xf
    s_nop 0
    v_add_f32_dpp v254, v38, v38 row_ror:4 row_mask:0xf bank_mask:0xf
    v_add_f32_dpp v255, v39, v39 row_ror:4 row_mask:0xf bank_mask:0xf
    v_cvt_pk_bf16_f32 v71, v254, v255
    ds_write_b64 v10, v[70:71] offset:3200
    ds_read_b128 v[144:147], v12 offset:3072
    s_waitcnt vmcnt(3)
    v_lshlrev_b32_e32 v44, 16, v108
    v_and_b32_e64 v45, s75, v108
    v_pk_add_f32 v[156:157], v[156:157], v[44:45]
    v_lshlrev_b32_e32 v46, 16, v109
    v_and_b32_e32 v47, s75, v109
    v_pk_add_f32 v[158:159], v[158:159], v[46:47]
    v_lshlrev_b32_e32 v48, 16, v110
    v_and_b32_e32 v49, s75, v110
    v_pk_add_f32 v[160:161], v[160:161], v[48:49]
    v_lshlrev_b32_e32 v50, 16, v111
    v_and_b32_e32 v51, s75, v111
    v_pk_add_f32 v[162:163], v[162:163], v[50:51]
    v_lshlrev_b32_e32 v44, 16, v112
    v_and_b32_e32 v45, s75, v112
    v_pk_add_f32 v[164:165], v[164:165], v[44:45]
    v_lshlrev_b32_e32 v46, 16, v113
    v_and_b32_e32 v47, s75, v113
    v_pk_add_f32 v[166:167], v[166:167], v[46:47]
    v_lshlrev_b32_e32 v48, 16, v114
    v_and_b32_e32 v49, s75, v114
    v_pk_add_f32 v[168:169], v[168:169], v[48:49]
    v_lshlrev_b32_e32 v50, 16, v115
    v_and_b32_e32 v51, s75, v115
    v_pk_add_f32 v[170:171], v[170:171], v[50:51]
    v_lshlrev_b32_e32 v44, 16, v116
    v_and_b32_e32 v45, s75, v116
    v_pk_add_f32 v[172:173], v[172:173], v[44:45]
    v_lshlrev_b32_e32 v46, 16, v117
    v_and_b32_e32 v47, s75, v117
    v_pk_add_f32 v[174:175], v[174:175], v[46:47]
    s_waitcnt vmcnt(2)
    v_lshlrev_b32_e32 v44, 16, v120
    v_and_b32_e64 v45, s75, v120
    v_pk_add_f32 v[156:157], v[156:157], v[44:45]
    v_cvt_pk_bf16_f32 v52, v156, v157
    v_lshlrev_b32_e32 v46, 16, v121
    v_and_b32_e32 v47, s75, v121
    v_pk_add_f32 v[158:159], v[158:159], v[46:47]
    v_cvt_pk_bf16_f32 v53, v158, v159
    ds_write_b64 v30, v[52:53] offset:0
    v_lshlrev_b32_e32 v48, 16, v122
    v_and_b32_e32 v49, s75, v122
    v_pk_add_f32 v[160:161], v[160:161], v[48:49]
    v_cvt_pk_bf16_f32 v54, v160, v161
    v_lshlrev_b32_e32 v50, 16, v123
    v_and_b32_e32 v51, s75, v123
    v_pk_add_f32 v[162:163], v[162:163], v[50:51]
    v_cvt_pk_bf16_f32 v55, v162, v163
    ds_write_b64 v30, v[54:55] offset:32
    s_waitcnt vmcnt(1)
    v_lshlrev_b32_e32 v44, 16, v124
    v_and_b32_e64 v45, s75, v124
    v_pk_add_f32 v[164:165], v[164:165], v[44:45]
    v_cvt_pk_bf16_f32 v56, v164, v165
    v_lshlrev_b32_e32 v46, 16, v125
    v_and_b32_e32 v47, s75, v125
    v_pk_add_f32 v[166:167], v[166:167], v[46:47]
    v_cvt_pk_bf16_f32 v57, v166, v167
    ds_write_b64 v30, v[56:57] offset:64
    ds_read_b128 v[72:75], v31
    v_lshlrev_b32_e32 v48, 16, v126
    v_and_b32_e32 v49, s75, v126
    v_pk_add_f32 v[168:169], v[168:169], v[48:49]
    v_cvt_pk_bf16_f32 v58, v168, v169
    v_lshlrev_b32_e32 v50, 16, v127
    v_and_b32_e32 v51, s75, v127
    v_pk_add_f32 v[170:171], v[170:171], v[50:51]
    v_cvt_pk_bf16_f32 v59, v170, v171
    ds_write_b64 v30, v[58:59] offset:96
    s_waitcnt vmcnt(0)
    v_lshlrev_b32_e32 v44, 16, v128
    v_and_b32_e64 v45, s75, v128
    v_pk_add_f32 v[172:173], v[172:173], v[44:45]
    v_cvt_pk_bf16_f32 v60, v172, v173
    v_lshlrev_b32_e32 v46, 16, v129
    v_and_b32_e32 v47, s75, v129
    v_pk_add_f32 v[174:175], v[174:175], v[46:47]
    v_cvt_pk_bf16_f32 v61, v174, v175
    ds_write_b64 v30, v[60:61] offset:128
    ds_read_b128 v[76:79], v31 offset:64
    ds_read_b128 v[80:83], v87
    s_waitcnt lgkmcnt(4)
    buffer_store_dwordx4 v[144:147], v11, s[56:59], s7 offen
    buffer_store_dwordx4 v[72:75], v29, s[56:59], s6 offen
    s_waitcnt lgkmcnt(1)
    buffer_store_dwordx4 v[76:79], v29, s[56:59], s6 offen offset:64
    s_waitcnt lgkmcnt(0)
    buffer_store_dwordx4 v[80:83], v28, s[56:59], s6 offen
L_end:
    s_endpgm
.section .rodata,"a"
.p2align 6
.amdhsa_kernel concat_heads__gqa_block_cached__gqa_block_cached__near_ridge_kernel
  .amdhsa_next_free_vgpr 512
  .amdhsa_next_free_sgpr 102
  .amdhsa_accum_offset 256
  .amdhsa_group_segment_fixed_size 0
  .amdhsa_kernarg_size 104
  .amdhsa_user_sgpr_count 2
  .amdhsa_user_sgpr_kernarg_segment_ptr 1
  .amdhsa_system_sgpr_workgroup_id_x 1
.end_amdhsa_kernel
```
